```python
import torch

def _softmax(x, axis=-1):
    return torch.softmax(x, dim=axis)
def _gelu(x):
    return torch.nn.functional.gelu(x, approximate="tanh")
def _silu(x):
    return torch.nn.functional.silu(x)
def _sigmoid(x):
    return torch.sigmoid(x)
def _layernorm(x, axis=-1, eps=1e-5):
    m = x.mean(dim=axis, keepdim=True)
    v = x.var(dim=axis, keepdim=True, unbiased=False)
    return (x - m) / torch.sqrt(v + eps)
def _scatter_add(tgt, idx, src, axis=0):
    return tgt.clone().index_add_(axis, idx, src)
def _segment_sum(src, seg, n):
    out = torch.zeros((n,) + src.shape[1:], dtype=src.dtype)
    return out.index_add_(0, seg, src)
def _pad(x, pw):
    flat = tuple(v for pair in reversed(pw) for v in pair)
    return torch.nn.functional.pad(x, flat)

kernel_name = 'standalone__mha_block_cached__near_ridge'

def setup_inputs():

    _w = (lambda a: (lambda t: t.to(torch.bfloat16) if t.is_floating_point() else t)(torch.as_tensor(a)))
    B, Sq, D = 8, 192, 576
    H, Sk, Dh = 32, 512, 128
    return {
        "x": _w((lambda *s: torch.randn(*s, dtype=torch.bfloat16) * 0.8)(B, Sq, D)),
        "k_cache": _w((lambda *s: torch.randn(*s, dtype=torch.bfloat16) * 0.8)(B, H, Sk, Dh)),
        "v_cache": _w((lambda *s: torch.randn(*s, dtype=torch.bfloat16) * 0.05)(B, H, Sk, Dh)),
        "wq": _w((lambda *s: torch.randn(*s, dtype=torch.bfloat16) * 0.8)(D, H * Dh) * (D ** -0.5)),
        "wo": _w((lambda *s: torch.randn(*s, dtype=torch.bfloat16) * 0.05)(H * Dh, D) * ((H * Dh) ** -0.5)),
    }

def reference(x, k_cache, v_cache, wq, wo):
    B, Sq, D = x.shape
    H, Dh = 32, 128
    q = (lambda x, *d: x.permute(*d))((x @ wq).reshape(B, Sq, H, Dh), 0, 2, 1, 3)
    scores = torch.einsum("bhqd,bhkd->bhqk", q, k_cache) * (Dh ** -0.5)
    p = _softmax(scores, axis=-1)
    o = torch.einsum("bhqk,bhkd->bhqd", p, v_cache)
    return (lambda x, *d: x.permute(*d))(o, 0, 2, 1, 3).reshape(B, Sq, H * Dh) @ wo
```

```asm
; @launch grid=(256,1,1) block=(768,1,1) lds=163840
.amdgcn_target "amdgcn-amd-amdhsa--gfx950"
.text
.globl standalone__mha_block_cached__near_ridge_kernel
.p2align 8
.type standalone__mha_block_cached__near_ridge_kernel,@function
standalone__mha_block_cached__near_ridge_kernel:
    s_load_dwordx16 s[4:19], s[0:1], 0
    s_memrealtime s[36:37]
    s_cmp_ge_u32 s2, 256
    s_cbranch_scc1 L_end
    s_bfe_u32 s21, s2, 0x20003
    s_and_b32 s20, s2, 3
    s_lshl_b32 s20, s20, 1
    s_bfe_u32 s25, s2, 0x10005
    s_add_u32 s20, s20, s25
    s_and_b32 s22, s2, 4
    s_lshr_b32 s25, s2, 6
    s_add_u32 s22, s22, s25
    s_lshl_b32 s23, s20, 2
    s_add_u32 s23, s23, s21
    v_lshrrev_b32 v1, 6, v0
    v_and_b32 v0, 63, v0
    v_readfirstlane_b32 s24, v1
    s_mov_b32 s3, 0
    s_getpc_b64 s[32:33]
L_pc:
    s_bfe_u32 s25, s2, 0x10003
    s_mul_i32 s25, s25, 12
    s_add_u32 s25, s25, s24
    s_mul_i32 s25, s25, 12*128
    v_lshl_add_u32 v2, v0, 7, s25
    v_min_u32 v2, L_end-L_pc, v2
    v_mov_b32 v3, s33
    v_add_co_u32 v2, vcc, s32, v2
    s_nop 1
    v_addc_co_u32 v3, vcc, 0, v3, vcc
    s_mov_b64 exec, 0xfff
    global_load_dword v167, v[2:3], off
    s_mov_b64 exec, -1
    s_waitcnt lgkmcnt(0)
    s_nop 0
L_start:
    s_cmp_lt_u32 s24, 4
    s_cbranch_scc1 L_qc
    s_sub_u32 s26, s24, 4
    s_lshl_b32 s27, s26, 10
    v_lshrrev_b32 v1, 4, v0
    v_lshlrev_b32 v2, 2, v1
    v_and_b32 v3, 15, v0
    v_xor_b32 v2, v2, v3
    v_lshlrev_b32 v2, 4, v2
    v_mul_u32_u24 v1, 8192, v1
    s_mul_i32 s25, s26, 32768
    v_add3_u32 v13, v1, v2, s25
    s_lshl_b32 s31, s23, 8
    s_add_u32 s44, s10, s31
    s_addc_u32 s45, s11, 0
    s_mov_b32 s46, 4710656
    s_mov_b32 s47, 0x20000
    s_and_b32 s25, s22, 3
    s_lshl_b32 s25, s25, 1
    s_bfe_u32 s31, s2, 0x30003
    s_add_u32 s25, s25, s31
    s_cmp_ge_u32 s25, 9
    s_cselect_b32 s31, 9, 0
    s_sub_u32 s25, s25, s31
    s_lshl_b32 s34, s25, 7
    s_lshl_b32 s35, s25, 19
    s_add_u32 m0, s27, 32768
    s_add_u32 s28, s35, 0
    buffer_load_dwordx4 v13, s[44:47], s28 offen lds
    v_lshrrev_b32 v1, 4, v0
    s_and_b32 s25, s26, 1
    s_lshl_b32 s25, s25, 2
    v_add_u32 v1, s25, v1
    v_and_b32 v2, 7, v0
    v_xor_b32 v1, v1, v2
    v_lshlrev_b32 v1, 4, v1
    v_lshrrev_b32 v2, 3, v0
    v_mul_u32_u24 v2, 1152, v2
    s_mul_i32 s25, s26, 9216
    v_add3_u32 v12, v1, v2, s25
    s_mul_i32 s25, s22, 221184
    s_add_u32 s40, s4, s25
    s_addc_u32 s41, s5, 0
    s_mov_b32 s42, 221184
    s_mov_b32 s43, 0x20000
    s_add_u32 m0, s27, 49152
    s_add_u32 s28, s34, 0
    buffer_load_dwordx4 v12, s[40:43], s28 offen lds
    s_add_u32 m0, s27, 57344
    s_add_u32 s28, s34, 73728
    buffer_load_dwordx4 v12, s[40:43], s28 offen lds
    s_add_u32 m0, s27, 65536
    s_add_u32 s28, s34, 147456
    buffer_load_dwordx4 v12, s[40:43], s28 offen lds
    s_add_u32 s34, s34, 128
    s_cmp_eq_u32 s34, 1152
    s_cselect_b32 s34, 0, s34
    s_add_u32 m0, s27, 40960
    s_add_u32 s28, s35, 262144
    buffer_load_dwordx4 v13, s[44:47], s28 offen lds
    s_add_u32 s35, s35, 524288
    s_cmp_eq_u32 s35, 4718592
    s_cselect_b32 s35, 0, s35
    s_add_u32 m0, s27, 131072
    s_add_u32 s28, s34, 0
    buffer_load_dwordx4 v12, s[40:43], s28 offen lds
    s_add_u32 m0, s27, 139264
    s_add_u32 s28, s34, 73728
    buffer_load_dwordx4 v12, s[40:43], s28 offen lds
    s_add_u32 m0, s27, 147456
    s_add_u32 s28, s34, 147456
    buffer_load_dwordx4 v12, s[40:43], s28 offen lds
    s_add_u32 s34, s34, 128
    s_cmp_eq_u32 s34, 1152
    s_cselect_b32 s34, 0, s34
    s_add_u32 m0, s27, 114688
    s_add_u32 s28, s35, 0
    buffer_load_dwordx4 v13, s[44:47], s28 offen lds
    v_lshrrev_b32 v1, 4, v0
    s_and_b32 s25, s26, 1
    s_lshl_b32 s25, s25, 2
    v_add_u32 v1, s25, v1
    v_and_b32 v2, 7, v0
    v_xor_b32 v1, v1, v2
    v_lshlrev_b32 v1, 4, v1
    v_lshrrev_b32 v2, 3, v0
    v_mul_u32_u24 v2, 256, v2
    s_mul_i32 s25, s26, 2048
    v_add3_u32 v14, v1, v2, s25
    v_lshrrev_b32 v1, 4, v0
    v_lshlrev_b32 v2, 2, v1
    v_and_b32 v3, 15, v0
    v_xor_b32 v2, v2, v3
    v_lshlrev_b32 v2, 4, v2
    v_mul_u32_u24 v1, 256, v1
    s_mul_i32 s25, s26, 1024
    v_add3_u32 v15, v1, v2, s25
    s_lshl_b32 s25, s22, 5
    s_add_u32 s25, s25, s23
    s_lshl_b32 s26, s25, 17
    s_add_u32 s48, s6, s26
    s_addc_u32 s49, s7, 0
    s_mov_b32 s50, 131072
    s_mov_b32 s51, 0x20000
    s_add_u32 s52, s8, s26
    s_addc_u32 s53, s9, 0
    s_mov_b32 s54, 131072
    s_mov_b32 s55, 0x20000
    s_waitcnt vmcnt(4)
    s_barrier
    s_add_u32 m0, s27, 122880
    s_add_u32 s28, s35, 262144
    buffer_load_dwordx4 v13, s[44:47], s28 offen lds
    s_add_u32 s35, s35, 524288
    s_cmp_eq_u32 s35, 4718592
    s_cselect_b32 s35, 0, s35
    s_add_u32 m0, s27, 90112
    s_add_u32 s28, s34, 0
    buffer_load_dwordx4 v12, s[40:43], s28 offen lds
    s_add_u32 m0, s27, 98304
    s_add_u32 s28, s34, 73728
    buffer_load_dwordx4 v12, s[40:43], s28 offen lds
    s_add_u32 m0, s27, 106496
    s_add_u32 s28, s34, 147456
    buffer_load_dwordx4 v12, s[40:43], s28 offen lds
    s_add_u32 s34, s34, 128
    s_cmp_eq_u32 s34, 1152
    s_cselect_b32 s34, 0, s34
    s_add_u32 m0, s27, 73728
    s_add_u32 s28, s35, 0
    buffer_load_dwordx4 v13, s[44:47], s28 offen lds
    s_and_b32 s25, s21, 1
    s_mul_i32 s25, s25, 576
    s_add_u32 s56, s12, s25
    s_addc_u32 s57, s13, 0
    s_mov_b32 s58, 4718016
    s_mov_b32 s59, 0x20000
    s_mov_b32 s60, s18
    s_mov_b32 s61, s19
    s_mov_b32 s62, 268435456
    s_mov_b32 s63, 0x20000
    s_mul_i32 s72, s23, 147456
    s_and_b32 s25, s22, 3
    s_cmp_eq_u32 s25, 3
    s_cselect_b32 s25, 0, s25
    s_lshr_b32 s31, s21, 1
    s_mul_i32 s31, s31, 24576
    s_add_u32 s26, s25, 0
    s_cmp_ge_u32 s26, 3
    s_cselect_b32 s39, 3, 0
    s_sub_u32 s26, s26, s39
    s_add_u32 s26, s26, s21
    s_add_u32 s26, s26, 1
    s_and_b32 s26, s26, 3
    s_lshl_b32 s39, s20, 2
    s_add_u32 s26, s26, s39
    s_mul_i32 s73, s26, 147456
    s_lshl_b32 s39, s22, 5
    s_add_u32 s26, s26, s39
    s_mul_i32 s26, s26, 49152
    s_add_u32 s76, s26, s31
    s_add_u32 s26, s25, 1
    s_cmp_ge_u32 s26, 3
    s_cselect_b32 s39, 3, 0
    s_sub_u32 s26, s26, s39
    s_add_u32 s26, s26, s21
    s_add_u32 s26, s26, 1
    s_and_b32 s26, s26, 3
    s_lshl_b32 s39, s20, 2
    s_add_u32 s26, s26, s39
    s_mul_i32 s74, s26, 147456
    s_lshl_b32 s39, s22, 5
    s_add_u32 s26, s26, s39
    s_mul_i32 s26, s26, 49152
    s_add_u32 s77, s26, s31
    s_add_u32 s26, s25, 2
    s_cmp_ge_u32 s26, 3
    s_cselect_b32 s39, 3, 0
    s_sub_u32 s26, s26, s39
    s_add_u32 s26, s26, s21
    s_add_u32 s26, s26, 1
    s_and_b32 s26, s26, 3
    s_lshl_b32 s39, s20, 2
    s_add_u32 s26, s26, s39
    s_mul_i32 s75, s26, 147456
    s_lshl_b32 s39, s22, 5
    s_add_u32 s26, s26, s39
    s_mul_i32 s26, s26, 49152
    s_add_u32 s78, s26, s31
    s_mul_i32 s25, s24, 43
    s_lshr_b32 s25, s25, 7
    s_mul_i32 s26, s25, 3
    s_sub_u32 s26, s24, s26
    s_mul_i32 s79, s24, 3072
    s_mul_i32 s26, s26, 192
    s_mul_i32 s25, s25, 18432
    v_add_u32 v1, s26, v0
    v_mul_u32_u24 v2, 1821, v1
    v_lshrrev_b32 v2, 16, v2
    v_mul_u32_u24 v3, 36, v2
    v_sub_u32 v1, v1, v3
    v_bfe_u32 v3, v2, 2, 1
    v_lshlrev_b32 v3, 1, v3
    v_xor_b32 v1, v1, v3
    v_mul_u32_u24 v2, 1152, v2
    v_lshl_add_u32 v1, v1, 4, v2
    v_add_u32 v160, s25, v1
    v_add_u32 v1, s26, v0
    v_add_u32 v1, 64, v1
    v_mul_u32_u24 v2, 1821, v1
    v_lshrrev_b32 v2, 16, v2
    v_mul_u32_u24 v3, 36, v2
    v_sub_u32 v1, v1, v3
    v_bfe_u32 v3, v2, 2, 1
    v_lshlrev_b32 v3, 1, v3
    v_xor_b32 v1, v1, v3
    v_mul_u32_u24 v2, 1152, v2
    v_lshl_add_u32 v1, v1, 4, v2
    v_add_u32 v161, s25, v1
    v_add_u32 v1, s26, v0
    v_add_u32 v1, 128, v1
    v_mul_u32_u24 v2, 1821, v1
    v_lshrrev_b32 v2, 16, v2
    v_mul_u32_u24 v3, 36, v2
    v_sub_u32 v1, v1, v3
    v_bfe_u32 v3, v2, 2, 1
    v_lshlrev_b32 v3, 1, v3
    v_xor_b32 v1, v1, v3
    v_mul_u32_u24 v2, 1152, v2
    v_lshl_add_u32 v1, v1, 4, v2
    v_add_u32 v162, s25, v1
    s_and_b32 s29, s24, 1
    s_lshr_b32 s30, s24, 1
    s_lshl_b32 s25, s29, 12
    v_and_b32 v1, 31, v0
    v_lshrrev_b32 v2, 1, v1
    v_and_b32 v2, 7, v2
    v_lshrrev_b32 v3, 5, v0
    v_xor_b32 v2, v2, v3
    v_lshlrev_b32 v2, 4, v2
    v_lshlrev_b32 v1, 7, v1
    v_add3_u32 v4, v1, v2, s25
    v_xor_b32 v5, 32, v4
    v_xor_b32 v6, 64, v4
    v_xor_b32 v7, 96, v4
    v_bfe_u32 v1, v0, 2, 2
    v_lshrrev_b32 v2, 5, v0
    v_lshl_add_u32 v2, v2, 2, v1
    v_lshlrev_b32 v2, 8, v2
    v_lshl_add_u32 v2, v1, 6, v2
    v_bfe_u32 v1, v0, 4, 1
    v_lshl_add_u32 v2, v1, 5, v2
    v_and_b32 v1, 3, v0
    v_lshl_add_u32 v2, v1, 3, v2
    s_lshl_b32 s25, s29, 13
    s_add_u32 s25, s25, 16384
    v_add_u32 v8, s25, v2
    v_xor_b32 v9, 64, v8
    v_xor_b32 v10, 128, v8
    v_xor_b32 v11, 192, v8
    s_add_u32 s25, s30, 11
    s_add_u32 s26, s30, 14
    s_cmp_lt_u32 s30, 3
    s_cselect_b32 s25, s25, s26
    s_cmp_eq_u32 s30, 3
    s_cselect_b32 s25, 4, s25
    s_lshl_b32 s25, s25, 13
    v_lshl_add_u32 v3, v0, 4, s25
    s_and_b32 s25, s22, 3
    s_lshl_b32 s25, s25, 3
    s_add_u32 s25, s25, s24
    s_sub_u32 s25, s25, 4
    s_mul_i32 s25, s25, 4608
    v_bfe_u32 v1, v0, 2, 2
    v_mul_u32_u24 v1, 1152, v1
    v_and_b32 v2, 3, v0
    v_lshl_add_u32 v1, v2, 7, v1
    v_add_u32 v164, s25, v1
    s_bitcmp1_b32 s21, 0
    s_cselect_b32 s39, 1216, 0
    s_sub_u32 s39, s72, s39
    s_add_u32 s39, s39, 640
    v_mov_b32 v166, s76
    v_writelane_b32 v166, s77, 1
    v_writelane_b32 v166, s78, 2
    s_cmp_ge_u32 s24, 6
    s_cselect_b32 s25, 6, 0
    s_sub_u32 s25, s24, s25
    s_lshl_b32 s25, s25, 7
    s_add_u32 s25, s25, 42991616
    v_lshrrev_b32 v166, 5, v166
    v_add_u32 v166, s25, v166
    s_waitcnt vmcnt(4)
    s_barrier
    s_add_u32 m0, s27, 81920
    s_add_u32 s28, s35, 262144
    buffer_load_dwordx4 v13, s[44:47], s28 offen lds
    s_add_u32 s35, s35, 524288
    s_cmp_eq_u32 s35, 4718592
    s_cselect_b32 s35, 0, s35
    s_add_u32 m0, s27, 49152
    s_add_u32 s28, s34, 0
    buffer_load_dwordx4 v12, s[40:43], s28 offen lds
    s_add_u32 m0, s27, 57344
    s_add_u32 s28, s34, 73728
    buffer_load_dwordx4 v12, s[40:43], s28 offen lds
    s_add_u32 m0, s27, 65536
    s_add_u32 s28, s34, 147456
    buffer_load_dwordx4 v12, s[40:43], s28 offen lds
    s_add_u32 s34, s34, 128
    s_cmp_eq_u32 s34, 1152
    s_cselect_b32 s34, 0, s34
    s_add_u32 m0, s27, 32768
    s_add_u32 s28, s35, 0
    buffer_load_dwordx4 v13, s[44:47], s28 offen lds
    s_waitcnt vmcnt(4)
    s_barrier
    s_add_u32 m0, s27, 40960
    s_add_u32 s28, s35, 262144
    buffer_load_dwordx4 v13, s[44:47], s28 offen lds
    s_add_u32 s35, s35, 524288
    s_cmp_eq_u32 s35, 4718592
    s_cselect_b32 s35, 0, s35
    s_add_u32 m0, s27, 131072
    s_add_u32 s28, s34, 0
    buffer_load_dwordx4 v12, s[40:43], s28 offen lds
    s_add_u32 m0, s27, 139264
    s_add_u32 s28, s34, 73728
    buffer_load_dwordx4 v12, s[40:43], s28 offen lds
    s_add_u32 m0, s27, 147456
    s_add_u32 s28, s34, 147456
    buffer_load_dwordx4 v12, s[40:43], s28 offen lds
    s_add_u32 s34, s34, 128
    s_cmp_eq_u32 s34, 1152
    s_cselect_b32 s34, 0, s34
    s_add_u32 m0, s27, 114688
    s_add_u32 s28, s35, 0
    buffer_load_dwordx4 v13, s[44:47], s28 offen lds
    s_waitcnt vmcnt(4)
    s_barrier
    s_add_u32 m0, s27, 122880
    s_add_u32 s28, s35, 262144
    buffer_load_dwordx4 v13, s[44:47], s28 offen lds
    s_add_u32 s35, s35, 524288
    s_cmp_eq_u32 s35, 4718592
    s_cselect_b32 s35, 0, s35
    s_add_u32 m0, s27, 90112
    s_add_u32 s28, s34, 0
    buffer_load_dwordx4 v12, s[40:43], s28 offen lds
    s_add_u32 m0, s27, 98304
    s_add_u32 s28, s34, 73728
    buffer_load_dwordx4 v12, s[40:43], s28 offen lds
    s_add_u32 m0, s27, 106496
    s_add_u32 s28, s34, 147456
    buffer_load_dwordx4 v12, s[40:43], s28 offen lds
    s_add_u32 s34, s34, 128
    s_cmp_eq_u32 s34, 1152
    s_cselect_b32 s34, 0, s34
    s_add_u32 m0, s27, 73728
    s_add_u32 s28, s35, 0
    buffer_load_dwordx4 v13, s[44:47], s28 offen lds
    s_waitcnt vmcnt(4)
    s_barrier
    s_add_u32 m0, s27, 81920
    s_add_u32 s28, s35, 262144
    buffer_load_dwordx4 v13, s[44:47], s28 offen lds
    s_add_u32 s35, s35, 524288
    s_cmp_eq_u32 s35, 4718592
    s_cselect_b32 s35, 0, s35
    s_add_u32 m0, s27, 49152
    s_add_u32 s28, s34, 0
    buffer_load_dwordx4 v12, s[40:43], s28 offen lds
    s_add_u32 m0, s27, 57344
    s_add_u32 s28, s34, 73728
    buffer_load_dwordx4 v12, s[40:43], s28 offen lds
    s_add_u32 m0, s27, 65536
    s_add_u32 s28, s34, 147456
    buffer_load_dwordx4 v12, s[40:43], s28 offen lds
    s_add_u32 s34, s34, 128
    s_cmp_eq_u32 s34, 1152
    s_cselect_b32 s34, 0, s34
    s_add_u32 m0, s27, 32768
    s_add_u32 s28, s35, 0
    buffer_load_dwordx4 v13, s[44:47], s28 offen lds
    s_waitcnt vmcnt(4)
    s_barrier
    s_add_u32 m0, s27, 40960
    s_add_u32 s28, s35, 262144
    buffer_load_dwordx4 v13, s[44:47], s28 offen lds
    s_add_u32 s35, s35, 524288
    s_cmp_eq_u32 s35, 4718592
    s_cselect_b32 s35, 0, s35
    s_add_u32 m0, s27, 131072
    s_add_u32 s28, s34, 0
    buffer_load_dwordx4 v12, s[40:43], s28 offen lds
    s_add_u32 m0, s27, 139264
    s_add_u32 s28, s34, 73728
    buffer_load_dwordx4 v12, s[40:43], s28 offen lds
    s_add_u32 m0, s27, 147456
    s_add_u32 s28, s34, 147456
    buffer_load_dwordx4 v12, s[40:43], s28 offen lds
    s_add_u32 s34, s34, 128
    s_cmp_eq_u32 s34, 1152
    s_cselect_b32 s34, 0, s34
    s_add_u32 m0, s27, 114688
    s_add_u32 s28, s35, 0
    buffer_load_dwordx4 v13, s[44:47], s28 offen lds
    s_waitcnt vmcnt(4)
    s_barrier
    s_add_u32 m0, s27, 122880
    s_add_u32 s28, s35, 262144
    buffer_load_dwordx4 v13, s[44:47], s28 offen lds
    s_add_u32 s35, s35, 524288
    s_cmp_eq_u32 s35, 4718592
    s_cselect_b32 s35, 0, s35
    s_add_u32 m0, s27, 90112
    s_add_u32 s28, s34, 0
    buffer_load_dwordx4 v12, s[40:43], s28 offen lds
    s_add_u32 m0, s27, 98304
    s_add_u32 s28, s34, 73728
    buffer_load_dwordx4 v12, s[40:43], s28 offen lds
    s_add_u32 m0, s27, 106496
    s_add_u32 s28, s34, 147456
    buffer_load_dwordx4 v12, s[40:43], s28 offen lds
    s_add_u32 s34, s34, 128
    s_cmp_eq_u32 s34, 1152
    s_cselect_b32 s34, 0, s34
    s_add_u32 m0, s27, 73728
    s_add_u32 s28, s35, 0
    buffer_load_dwordx4 v13, s[44:47], s28 offen lds
    s_add_u32 m0, s27, 81920
    s_add_u32 s28, s35, 262144
    buffer_load_dwordx4 v13, s[44:47], s28 offen lds
    s_add_u32 s35, s35, 524288
    s_cmp_eq_u32 s35, 4718592
    s_cselect_b32 s35, 0, s35
    s_waitcnt vmcnt(5)
    s_barrier
    s_add_u32 m0, s27, 0
    s_mov_b32 s28, 0
    buffer_load_dwordx4 v14, s[48:51], s28 offen nt lds
    s_add_u32 m0, s27, 8192
    s_mov_b32 s28, 128
    buffer_load_dwordx4 v14, s[48:51], s28 offen nt lds
    s_add_u32 m0, s27, 16384
    s_mov_b32 s28, 0
    buffer_load_dwordx4 v15, s[52:55], s28 offen nt lds
    s_add_u32 m0, s27, 24576
    s_mov_b32 s28, 8192
    buffer_load_dwordx4 v15, s[52:55], s28 offen nt lds
    s_waitcnt vmcnt(4)
    s_barrier
    s_add_u32 m0, s27, 40960
    s_mov_b32 s28, 16384
    buffer_load_dwordx4 v14, s[48:51], s28 offen nt lds
    s_add_u32 m0, s27, 49152
    s_mov_b32 s28, 16512
    buffer_load_dwordx4 v14, s[48:51], s28 offen nt lds
    s_barrier
    s_add_u32 m0, s27, 57344
    s_mov_b32 s28, 16384
    buffer_load_dwordx4 v15, s[52:55], s28 offen nt lds
    s_add_u32 m0, s27, 65536
    s_mov_b32 s28, 24576
    buffer_load_dwordx4 v15, s[52:55], s28 offen nt lds
    s_add_u32 m0, s27, 114688
    s_mov_b32 s28, 32768
    buffer_load_dwordx4 v14, s[48:51], s28 offen nt lds
    s_waitcnt vmcnt(5)
    s_barrier
    s_cmp_lg_u32 s3, 0
    s_cbranch_scc1 L_slow_l
    ds_read_b128 v[16:19], v3 offset:0
    ds_read_b128 v[48:51], v4 offset:0
    ds_read_b128 v[20:23], v3 offset:1024
    ds_read_b128 v[52:55], v5 offset:0
    ds_read_b128 v[24:27], v3 offset:2048
    ds_read_b128 v[56:59], v6 offset:0
    ds_read_b128 v[28:31], v3 offset:3072
    ds_read_b128 v[60:63], v7 offset:0
    ds_read_b128 v[32:35], v3 offset:4096
    ds_read_b128 v[64:67], v4 offset:8192
    ds_read_b128 v[36:39], v3 offset:5120
    ds_read_b128 v[68:71], v5 offset:8192
    ds_read_b128 v[40:43], v3 offset:6144
    ds_read_b128 v[72:75], v6 offset:8192
    ds_read_b128 v[44:47], v3 offset:7168
    ds_read_b128 v[76:79], v7 offset:8192
    v_mov_b32 v12, 0
    v_mov_b32 v13, 0
    s_setprio 1
    s_waitcnt lgkmcnt(14)
    v_mfma_f32_32x32x16_bf16 v[80:95], v[48:51], v[16:19], 0
    ds_read_b64_tr_b16 v[48:49], v8 offset:0
    ds_read_b64_tr_b16 v[50:51], v8 offset:2048
    s_waitcnt lgkmcnt(14)
    v_mfma_f32_32x32x16_bf16 v[80:95], v[52:55], v[20:23], v[80:95]
    ds_read_b64_tr_b16 v[52:53], v9 offset:0
    ds_read_b64_tr_b16 v[54:55], v9 offset:2048
    s_add_u32 m0, s27, 122880
    s_mov_b32 s28, 32896
    buffer_load_dwordx4 v14, s[48:51], s28 offen nt lds
    s_waitcnt lgkmcnt(14)
    v_mfma_f32_32x32x16_bf16 v[80:95], v[56:59], v[24:27], v[80:95]
    ds_read_b64_tr_b16 v[56:57], v10 offset:0
    ds_read_b64_tr_b16 v[58:59], v10 offset:2048
    s_waitcnt lgkmcnt(14)
    v_mfma_f32_32x32x16_bf16 v[80:95], v[60:63], v[28:31], v[80:95]
    ds_read_b64_tr_b16 v[60:61], v11 offset:0
    ds_read_b64_tr_b16 v[62:63], v11 offset:2048
    s_waitcnt lgkmcnt(14)
    v_mfma_f32_32x32x16_bf16 v[80:95], v[64:67], v[32:35], v[80:95]
    ds_read_b64_tr_b16 v[64:65], v8 offset:4096
    ds_read_b64_tr_b16 v[66:67], v8 offset:6144
    s_waitcnt lgkmcnt(14)
    v_mfma_f32_32x32x16_bf16 v[80:95], v[68:71], v[36:39], v[80:95]
    ds_read_b64_tr_b16 v[68:69], v9 offset:4096
    ds_read_b64_tr_b16 v[70:71], v9 offset:6144
    s_add_u32 m0, s27, 131072
    s_mov_b32 s28, 32768
    buffer_load_dwordx4 v15, s[52:55], s28 offen nt lds
    s_waitcnt lgkmcnt(14)
    v_mfma_f32_32x32x16_bf16 v[80:95], v[72:75], v[40:43], v[80:95]
    ds_read_b64_tr_b16 v[72:73], v10 offset:4096
    ds_read_b64_tr_b16 v[74:75], v10 offset:6144
    s_waitcnt lgkmcnt(14)
    v_mfma_f32_32x32x16_bf16 v[80:95], v[76:79], v[44:47], v[80:95]
    ds_read_b64_tr_b16 v[76:77], v11 offset:4096
    ds_read_b64_tr_b16 v[78:79], v11 offset:6144
    s_setprio 0
    s_nop 8
    v_exp_f32 v80, v80
    v_exp_f32 v81, v81
    v_exp_f32 v82, v82
    v_exp_f32 v83, v83
    v_exp_f32 v84, v84
    v_exp_f32 v85, v85
    v_exp_f32 v86, v86
    v_exp_f32 v87, v87
    v_add_f32 v12, v12, v80
    v_add_f32 v13, v13, v81
    v_add_f32 v12, v12, v82
    v_add_f32 v13, v13, v83
    v_add_f32 v12, v12, v84
    v_add_f32 v13, v13, v85
    v_add_f32 v12, v12, v86
    v_add_f32 v13, v13, v87
    v_cvt_pk_bf16_f32 v80, v80, v81
    v_cvt_pk_bf16_f32 v81, v82, v83
    v_cvt_pk_bf16_f32 v82, v84, v85
    v_cvt_pk_bf16_f32 v83, v86, v87
    v_exp_f32 v88, v88
    v_exp_f32 v89, v89
    s_waitcnt lgkmcnt(14)
    v_mfma_f32_32x32x16_bf16 v[96:111], v[48:51], v[80:83], 0
    v_add_f32 v12, v12, v88
    v_add_f32 v13, v13, v89
    v_cvt_pk_bf16_f32 v88, v88, v89
    v_exp_f32 v90, v90
    v_exp_f32 v91, v91
    s_waitcnt lgkmcnt(12)
    v_mfma_f32_32x32x16_bf16 v[112:127], v[52:55], v[80:83], 0
    v_add_f32 v12, v12, v90
    v_add_f32 v13, v13, v91
    v_cvt_pk_bf16_f32 v89, v90, v91
    v_exp_f32 v92, v92
    v_exp_f32 v93, v93
    s_waitcnt lgkmcnt(10)
    v_mfma_f32_32x32x16_bf16 v[128:143], v[56:59], v[80:83], 0
    v_add_f32 v12, v12, v92
    v_add_f32 v13, v13, v93
    v_cvt_pk_bf16_f32 v90, v92, v93
    s_add_u32 m0, s27, 139264
    s_mov_b32 s28, 40960
    buffer_load_dwordx4 v15, s[52:55], s28 offen nt lds
    v_exp_f32 v94, v94
    v_exp_f32 v95, v95
    s_waitcnt lgkmcnt(8)
    v_mfma_f32_32x32x16_bf16 v[144:159], v[60:63], v[80:83], 0
    v_add_f32 v12, v12, v94
    v_add_f32 v13, v13, v95
    v_cvt_pk_bf16_f32 v91, v94, v95
    s_waitcnt lgkmcnt(6)
    s_nop 0
    v_mfma_f32_32x32x16_bf16 v[96:111], v[64:67], v[88:91], v[96:111]
    s_waitcnt lgkmcnt(4)
    v_mfma_f32_32x32x16_bf16 v[112:127], v[68:71], v[88:91], v[112:127]
    s_waitcnt vmcnt(4) lgkmcnt(0)
    s_barrier
    ds_read_b128 v[48:51], v4 offset:40960
    ds_read_b128 v[52:55], v5 offset:40960
    ds_read_b128 v[56:59], v6 offset:40960
    ds_read_b128 v[60:63], v7 offset:40960
    ds_read_b128 v[64:67], v4 offset:49152
    ds_read_b128 v[68:71], v5 offset:49152
    v_mfma_f32_32x32x16_bf16 v[128:143], v[72:75], v[88:91], v[128:143]
    ds_read_b128 v[72:75], v6 offset:49152
    s_add_u32 m0, s27, 73728
    s_mov_b32 s28, 49152
    buffer_load_dwordx4 v14, s[48:51], s28 offen nt lds
    v_mfma_f32_32x32x16_bf16 v[144:159], v[76:79], v[88:91], v[144:159]
    ds_read_b128 v[76:79], v7 offset:49152
    s_setprio 1
    s_waitcnt lgkmcnt(7)
    v_mfma_f32_32x32x16_bf16 v[80:95], v[48:51], v[16:19], 0
    ds_read_b64_tr_b16 v[48:49], v8 offset:40960
    ds_read_b64_tr_b16 v[50:51], v8 offset:43008
    s_waitcnt lgkmcnt(8)
    v_mfma_f32_32x32x16_bf16 v[80:95], v[52:55], v[20:23], v[80:95]
    ds_read_b64_tr_b16 v[52:53], v9 offset:40960
    ds_read_b64_tr_b16 v[54:55], v9 offset:43008
    s_add_u32 m0, s27, 81920
    s_mov_b32 s28, 49280
    buffer_load_dwordx4 v14, s[48:51], s28 offen nt lds
    s_waitcnt lgkmcnt(9)
    v_mfma_f32_32x32x16_bf16 v[80:95], v[56:59], v[24:27], v[80:95]
    ds_read_b64_tr_b16 v[56:57], v10 offset:40960
    ds_read_b64_tr_b16 v[58:59], v10 offset:43008
    s_waitcnt lgkmcnt(10)
    v_mfma_f32_32x32x16_bf16 v[80:95], v[60:63], v[28:31], v[80:95]
    ds_read_b64_tr_b16 v[60:61], v11 offset:40960
    ds_read_b64_tr_b16 v[62:63], v11 offset:43008
    s_waitcnt lgkmcnt(11)
    v_mfma_f32_32x32x16_bf16 v[80:95], v[64:67], v[32:35], v[80:95]
    ds_read_b64_tr_b16 v[64:65], v8 offset:45056
    ds_read_b64_tr_b16 v[66:67], v8 offset:47104
    s_waitcnt lgkmcnt(12)
    v_mfma_f32_32x32x16_bf16 v[80:95], v[68:71], v[36:39], v[80:95]
    ds_read_b64_tr_b16 v[68:69], v9 offset:45056
    ds_read_b64_tr_b16 v[70:71], v9 offset:47104
    s_add_u32 m0, s27, 90112
    s_mov_b32 s28, 49152
    buffer_load_dwordx4 v15, s[52:55], s28 offen nt lds
    s_waitcnt lgkmcnt(13)
    v_mfma_f32_32x32x16_bf16 v[80:95], v[72:75], v[40:43], v[80:95]
    ds_read_b64_tr_b16 v[72:73], v10 offset:45056
    ds_read_b64_tr_b16 v[74:75], v10 offset:47104
    s_waitcnt lgkmcnt(14)
    v_mfma_f32_32x32x16_bf16 v[80:95], v[76:79], v[44:47], v[80:95]
    ds_read_b64_tr_b16 v[76:77], v11 offset:45056
    ds_read_b64_tr_b16 v[78:79], v11 offset:47104
    s_setprio 0
    v_add_u32 v4, 73728, v4
    v_add_u32 v5, 73728, v5
    v_add_u32 v6, 73728, v6
    v_add_u32 v7, 73728, v7
    v_add_u32 v8, 73728, v8
    v_add_u32 v9, 73728, v9
    v_add_u32 v10, 73728, v10
    v_add_u32 v11, 73728, v11
    s_nop 0
    v_exp_f32 v80, v80
    v_exp_f32 v81, v81
    v_exp_f32 v82, v82
    v_exp_f32 v83, v83
    v_exp_f32 v84, v84
    v_exp_f32 v85, v85
    v_exp_f32 v86, v86
    v_exp_f32 v87, v87
    v_add_f32 v12, v12, v80
    v_add_f32 v13, v13, v81
    v_add_f32 v12, v12, v82
    v_add_f32 v13, v13, v83
    v_add_f32 v12, v12, v84
    v_add_f32 v13, v13, v85
    v_add_f32 v12, v12, v86
    v_add_f32 v13, v13, v87
    v_cvt_pk_bf16_f32 v80, v80, v81
    v_cvt_pk_bf16_f32 v81, v82, v83
    v_cvt_pk_bf16_f32 v82, v84, v85
    v_cvt_pk_bf16_f32 v83, v86, v87
    v_exp_f32 v88, v88
    v_exp_f32 v89, v89
    s_waitcnt lgkmcnt(14)
    v_mfma_f32_32x32x16_bf16 v[96:111], v[48:51], v[80:83], v[96:111]
    v_add_f32 v12, v12, v88
    v_add_f32 v13, v13, v89
    v_cvt_pk_bf16_f32 v88, v88, v89
    v_exp_f32 v90, v90
    v_exp_f32 v91, v91
    s_waitcnt lgkmcnt(12)
    v_mfma_f32_32x32x16_bf16 v[112:127], v[52:55], v[80:83], v[112:127]
    v_add_f32 v12, v12, v90
    v_add_f32 v13, v13, v91
    v_cvt_pk_bf16_f32 v89, v90, v91
    v_exp_f32 v92, v92
    v_exp_f32 v93, v93
    s_waitcnt lgkmcnt(10)
    v_mfma_f32_32x32x16_bf16 v[128:143], v[56:59], v[80:83], v[128:143]
    v_add_f32 v12, v12, v92
    v_add_f32 v13, v13, v93
    v_cvt_pk_bf16_f32 v90, v92, v93
    s_add_u32 m0, s27, 98304
    s_mov_b32 s28, 57344
    buffer_load_dwordx4 v15, s[52:55], s28 offen nt lds
    v_exp_f32 v94, v94
    v_exp_f32 v95, v95
    s_waitcnt lgkmcnt(8)
    v_mfma_f32_32x32x16_bf16 v[144:159], v[60:63], v[80:83], v[144:159]
    v_add_f32 v12, v12, v94
    v_add_f32 v13, v13, v95
    v_cvt_pk_bf16_f32 v91, v94, v95
    s_waitcnt lgkmcnt(6)
    s_nop 0
    v_mfma_f32_32x32x16_bf16 v[96:111], v[64:67], v[88:91], v[96:111]
    s_waitcnt lgkmcnt(4)
    v_mfma_f32_32x32x16_bf16 v[112:127], v[68:71], v[88:91], v[112:127]
    s_waitcnt vmcnt(4) lgkmcnt(0)
    s_barrier
    ds_read_b128 v[48:51], v4 offset:40960
    ds_read_b128 v[52:55], v5 offset:40960
    ds_read_b128 v[56:59], v6 offset:40960
    ds_read_b128 v[60:63], v7 offset:40960
    ds_read_b128 v[64:67], v4 offset:49152
    ds_read_b128 v[68:71], v5 offset:49152
    v_mfma_f32_32x32x16_bf16 v[128:143], v[72:75], v[88:91], v[128:143]
    ds_read_b128 v[72:75], v6 offset:49152
    s_add_u32 m0, s27, 0
    s_mov_b32 s28, 65536
    buffer_load_dwordx4 v14, s[48:51], s28 offen nt lds
    v_mfma_f32_32x32x16_bf16 v[144:159], v[76:79], v[88:91], v[144:159]
    ds_read_b128 v[76:79], v7 offset:49152
    s_setprio 1
    s_waitcnt lgkmcnt(7)
    v_mfma_f32_32x32x16_bf16 v[80:95], v[48:51], v[16:19], 0
    ds_read_b64_tr_b16 v[48:49], v8 offset:40960
    ds_read_b64_tr_b16 v[50:51], v8 offset:43008
    s_waitcnt lgkmcnt(8)
    v_mfma_f32_32x32x16_bf16 v[80:95], v[52:55], v[20:23], v[80:95]
    ds_read_b64_tr_b16 v[52:53], v9 offset:40960
    ds_read_b64_tr_b16 v[54:55], v9 offset:43008
    s_add_u32 m0, s27, 8192
    s_mov_b32 s28, 65664
    buffer_load_dwordx4 v14, s[48:51], s28 offen nt lds
    s_waitcnt lgkmcnt(9)
    v_mfma_f32_32x32x16_bf16 v[80:95], v[56:59], v[24:27], v[80:95]
    ds_read_b64_tr_b16 v[56:57], v10 offset:40960
    ds_read_b64_tr_b16 v[58:59], v10 offset:43008
    s_waitcnt lgkmcnt(10)
    v_mfma_f32_32x32x16_bf16 v[80:95], v[60:63], v[28:31], v[80:95]
    ds_read_b64_tr_b16 v[60:61], v11 offset:40960
    ds_read_b64_tr_b16 v[62:63], v11 offset:43008
    s_waitcnt lgkmcnt(11)
    v_mfma_f32_32x32x16_bf16 v[80:95], v[64:67], v[32:35], v[80:95]
    ds_read_b64_tr_b16 v[64:65], v8 offset:45056
    ds_read_b64_tr_b16 v[66:67], v8 offset:47104
    s_waitcnt lgkmcnt(12)
    v_mfma_f32_32x32x16_bf16 v[80:95], v[68:71], v[36:39], v[80:95]
    ds_read_b64_tr_b16 v[68:69], v9 offset:45056
    ds_read_b64_tr_b16 v[70:71], v9 offset:47104
    s_add_u32 m0, s27, 16384
    s_mov_b32 s28, 65536
    buffer_load_dwordx4 v15, s[52:55], s28 offen nt lds
    s_waitcnt lgkmcnt(13)
    v_mfma_f32_32x32x16_bf16 v[80:95], v[72:75], v[40:43], v[80:95]
    ds_read_b64_tr_b16 v[72:73], v10 offset:45056
    ds_read_b64_tr_b16 v[74:75], v10 offset:47104
    s_waitcnt lgkmcnt(14)
    v_mfma_f32_32x32x16_bf16 v[80:95], v[76:79], v[44:47], v[80:95]
    ds_read_b64_tr_b16 v[76:77], v11 offset:45056
    ds_read_b64_tr_b16 v[78:79], v11 offset:47104
    s_setprio 0
    s_nop 8
    v_exp_f32 v80, v80
    v_exp_f32 v81, v81
    v_exp_f32 v82, v82
    v_exp_f32 v83, v83
    v_exp_f32 v84, v84
    v_exp_f32 v85, v85
    v_exp_f32 v86, v86
    v_exp_f32 v87, v87
    v_add_f32 v12, v12, v80
    v_add_f32 v13, v13, v81
    v_add_f32 v12, v12, v82
    v_add_f32 v13, v13, v83
    v_add_f32 v12, v12, v84
    v_add_f32 v13, v13, v85
    v_add_f32 v12, v12, v86
    v_add_f32 v13, v13, v87
    v_cvt_pk_bf16_f32 v80, v80, v81
    v_cvt_pk_bf16_f32 v81, v82, v83
    v_cvt_pk_bf16_f32 v82, v84, v85
    v_cvt_pk_bf16_f32 v83, v86, v87
    v_exp_f32 v88, v88
    v_exp_f32 v89, v89
    s_waitcnt lgkmcnt(14)
    v_mfma_f32_32x32x16_bf16 v[96:111], v[48:51], v[80:83], v[96:111]
    v_add_f32 v12, v12, v88
    v_add_f32 v13, v13, v89
    v_cvt_pk_bf16_f32 v88, v88, v89
    v_exp_f32 v90, v90
    v_exp_f32 v91, v91
    s_waitcnt lgkmcnt(12)
    v_mfma_f32_32x32x16_bf16 v[112:127], v[52:55], v[80:83], v[112:127]
    v_add_f32 v12, v12, v90
    v_add_f32 v13, v13, v91
    v_cvt_pk_bf16_f32 v89, v90, v91
    v_exp_f32 v92, v92
    v_exp_f32 v93, v93
    s_waitcnt lgkmcnt(10)
    v_mfma_f32_32x32x16_bf16 v[128:143], v[56:59], v[80:83], v[128:143]
    v_add_f32 v12, v12, v92
    v_add_f32 v13, v13, v93
    v_cvt_pk_bf16_f32 v90, v92, v93
    s_add_u32 m0, s27, 24576
    s_mov_b32 s28, 73728
    buffer_load_dwordx4 v15, s[52:55], s28 offen nt lds
    v_exp_f32 v94, v94
    v_exp_f32 v95, v95
    s_waitcnt lgkmcnt(8)
    v_mfma_f32_32x32x16_bf16 v[144:159], v[60:63], v[80:83], v[144:159]
    v_add_f32 v12, v12, v94
    v_add_f32 v13, v13, v95
    v_cvt_pk_bf16_f32 v91, v94, v95
    s_waitcnt lgkmcnt(6)
    s_nop 0
    v_mfma_f32_32x32x16_bf16 v[96:111], v[64:67], v[88:91], v[96:111]
    s_waitcnt lgkmcnt(4)
    v_mfma_f32_32x32x16_bf16 v[112:127], v[68:71], v[88:91], v[112:127]
    s_waitcnt vmcnt(4) lgkmcnt(0)
    s_barrier
    ds_read_b128 v[48:51], v4 offset:0
    ds_read_b128 v[52:55], v5 offset:0
    ds_read_b128 v[56:59], v6 offset:0
    ds_read_b128 v[60:63], v7 offset:0
    ds_read_b128 v[64:67], v4 offset:8192
    ds_read_b128 v[68:71], v5 offset:8192
    v_mfma_f32_32x32x16_bf16 v[128:143], v[72:75], v[88:91], v[128:143]
    ds_read_b128 v[72:75], v6 offset:8192
    s_add_u32 m0, s27, 40960
    s_mov_b32 s28, 81920
    buffer_load_dwordx4 v14, s[48:51], s28 offen nt lds
    v_mfma_f32_32x32x16_bf16 v[144:159], v[76:79], v[88:91], v[144:159]
    ds_read_b128 v[76:79], v7 offset:8192
    s_setprio 1
    s_waitcnt lgkmcnt(7)
    v_mfma_f32_32x32x16_bf16 v[80:95], v[48:51], v[16:19], 0
    ds_read_b64_tr_b16 v[48:49], v8 offset:0
    ds_read_b64_tr_b16 v[50:51], v8 offset:2048
    s_waitcnt lgkmcnt(8)
    v_mfma_f32_32x32x16_bf16 v[80:95], v[52:55], v[20:23], v[80:95]
    ds_read_b64_tr_b16 v[52:53], v9 offset:0
    ds_read_b64_tr_b16 v[54:55], v9 offset:2048
    s_add_u32 m0, s27, 49152
    s_mov_b32 s28, 82048
    buffer_load_dwordx4 v14, s[48:51], s28 offen nt lds
    s_waitcnt lgkmcnt(9)
    v_mfma_f32_32x32x16_bf16 v[80:95], v[56:59], v[24:27], v[80:95]
    ds_read_b64_tr_b16 v[56:57], v10 offset:0
    ds_read_b64_tr_b16 v[58:59], v10 offset:2048
    s_waitcnt lgkmcnt(10)
    v_mfma_f32_32x32x16_bf16 v[80:95], v[60:63], v[28:31], v[80:95]
    ds_read_b64_tr_b16 v[60:61], v11 offset:0
    ds_read_b64_tr_b16 v[62:63], v11 offset:2048
    s_waitcnt lgkmcnt(11)
    v_mfma_f32_32x32x16_bf16 v[80:95], v[64:67], v[32:35], v[80:95]
    ds_read_b64_tr_b16 v[64:65], v8 offset:4096
    ds_read_b64_tr_b16 v[66:67], v8 offset:6144
    s_waitcnt lgkmcnt(12)
    v_mfma_f32_32x32x16_bf16 v[80:95], v[68:71], v[36:39], v[80:95]
    ds_read_b64_tr_b16 v[68:69], v9 offset:4096
    ds_read_b64_tr_b16 v[70:71], v9 offset:6144
    s_add_u32 m0, s27, 57344
    s_mov_b32 s28, 81920
    buffer_load_dwordx4 v15, s[52:55], s28 offen nt lds
    s_waitcnt lgkmcnt(13)
    v_mfma_f32_32x32x16_bf16 v[80:95], v[72:75], v[40:43], v[80:95]
    ds_read_b64_tr_b16 v[72:73], v10 offset:4096
    ds_read_b64_tr_b16 v[74:75], v10 offset:6144
    s_waitcnt lgkmcnt(14)
    v_mfma_f32_32x32x16_bf16 v[80:95], v[76:79], v[44:47], v[80:95]
    ds_read_b64_tr_b16 v[76:77], v11 offset:4096
    ds_read_b64_tr_b16 v[78:79], v11 offset:6144
    s_setprio 0
    v_subrev_u32 v4, 73728, v4
    v_subrev_u32 v5, 73728, v5
    v_subrev_u32 v6, 73728, v6
    v_subrev_u32 v7, 73728, v7
    v_subrev_u32 v8, 73728, v8
    v_subrev_u32 v9, 73728, v9
    v_subrev_u32 v10, 73728, v10
    v_subrev_u32 v11, 73728, v11
    s_nop 0
    v_exp_f32 v80, v80
    v_exp_f32 v81, v81
    v_exp_f32 v82, v82
    v_exp_f32 v83, v83
    v_exp_f32 v84, v84
    v_exp_f32 v85, v85
    v_exp_f32 v86, v86
    v_exp_f32 v87, v87
    v_add_f32 v12, v12, v80
    v_add_f32 v13, v13, v81
    v_add_f32 v12, v12, v82
    v_add_f32 v13, v13, v83
    v_add_f32 v12, v12, v84
    v_add_f32 v13, v13, v85
    v_add_f32 v12, v12, v86
    v_add_f32 v13, v13, v87
    v_cvt_pk_bf16_f32 v80, v80, v81
    v_cvt_pk_bf16_f32 v81, v82, v83
    v_cvt_pk_bf16_f32 v82, v84, v85
    v_cvt_pk_bf16_f32 v83, v86, v87
    v_exp_f32 v88, v88
    v_exp_f32 v89, v89
    s_waitcnt lgkmcnt(14)
    v_mfma_f32_32x32x16_bf16 v[96:111], v[48:51], v[80:83], v[96:111]
    v_add_f32 v12, v12, v88
    v_add_f32 v13, v13, v89
    v_cvt_pk_bf16_f32 v88, v88, v89
    v_exp_f32 v90, v90
    v_exp_f32 v91, v91
    s_waitcnt lgkmcnt(12)
    v_mfma_f32_32x32x16_bf16 v[112:127], v[52:55], v[80:83], v[112:127]
    v_add_f32 v12, v12, v90
    v_add_f32 v13, v13, v91
    v_cvt_pk_bf16_f32 v89, v90, v91
    v_exp_f32 v92, v92
    v_exp_f32 v93, v93
    s_waitcnt lgkmcnt(10)
    v_mfma_f32_32x32x16_bf16 v[128:143], v[56:59], v[80:83], v[128:143]
    v_add_f32 v12, v12, v92
    v_add_f32 v13, v13, v93
    v_cvt_pk_bf16_f32 v90, v92, v93
    s_add_u32 m0, s27, 65536
    s_mov_b32 s28, 90112
    buffer_load_dwordx4 v15, s[52:55], s28 offen nt lds
    v_exp_f32 v94, v94
    v_exp_f32 v95, v95
    s_waitcnt lgkmcnt(8)
    v_mfma_f32_32x32x16_bf16 v[144:159], v[60:63], v[80:83], v[144:159]
    v_add_f32 v12, v12, v94
    v_add_f32 v13, v13, v95
    v_cvt_pk_bf16_f32 v91, v94, v95
    s_waitcnt lgkmcnt(6)
    s_nop 0
    v_mfma_f32_32x32x16_bf16 v[96:111], v[64:67], v[88:91], v[96:111]
    s_waitcnt lgkmcnt(4)
    v_mfma_f32_32x32x16_bf16 v[112:127], v[68:71], v[88:91], v[112:127]
    s_waitcnt vmcnt(4) lgkmcnt(0)
    s_barrier
    ds_read_b128 v[48:51], v4 offset:0
    ds_read_b128 v[52:55], v5 offset:0
    ds_read_b128 v[56:59], v6 offset:0
    ds_read_b128 v[60:63], v7 offset:0
    ds_read_b128 v[64:67], v4 offset:8192
    ds_read_b128 v[68:71], v5 offset:8192
    v_mfma_f32_32x32x16_bf16 v[128:143], v[72:75], v[88:91], v[128:143]
    ds_read_b128 v[72:75], v6 offset:8192
    s_add_u32 m0, s27, 114688
    s_mov_b32 s28, 98304
    buffer_load_dwordx4 v14, s[48:51], s28 offen nt lds
    v_mfma_f32_32x32x16_bf16 v[144:159], v[76:79], v[88:91], v[144:159]
    ds_read_b128 v[76:79], v7 offset:8192
    s_setprio 1
    s_waitcnt lgkmcnt(7)
    v_mfma_f32_32x32x16_bf16 v[80:95], v[48:51], v[16:19], 0
    ds_read_b64_tr_b16 v[48:49], v8 offset:0
    ds_read_b64_tr_b16 v[50:51], v8 offset:2048
    s_waitcnt lgkmcnt(8)
    v_mfma_f32_32x32x16_bf16 v[80:95], v[52:55], v[20:23], v[80:95]
    ds_read_b64_tr_b16 v[52:53], v9 offset:0
    ds_read_b64_tr_b16 v[54:55], v9 offset:2048
    s_add_u32 m0, s27, 122880
    s_mov_b32 s28, 98432
    buffer_load_dwordx4 v14, s[48:51], s28 offen nt lds
    s_waitcnt lgkmcnt(9)
    v_mfma_f32_32x32x16_bf16 v[80:95], v[56:59], v[24:27], v[80:95]
    ds_read_b64_tr_b16 v[56:57], v10 offset:0
    ds_read_b64_tr_b16 v[58:59], v10 offset:2048
    s_waitcnt lgkmcnt(10)
    v_mfma_f32_32x32x16_bf16 v[80:95], v[60:63], v[28:31], v[80:95]
    ds_read_b64_tr_b16 v[60:61], v11 offset:0
    ds_read_b64_tr_b16 v[62:63], v11 offset:2048
    s_waitcnt lgkmcnt(11)
    v_mfma_f32_32x32x16_bf16 v[80:95], v[64:67], v[32:35], v[80:95]
    ds_read_b64_tr_b16 v[64:65], v8 offset:4096
    ds_read_b64_tr_b16 v[66:67], v8 offset:6144
    s_waitcnt lgkmcnt(12)
    v_mfma_f32_32x32x16_bf16 v[80:95], v[68:71], v[36:39], v[80:95]
    ds_read_b64_tr_b16 v[68:69], v9 offset:4096
    ds_read_b64_tr_b16 v[70:71], v9 offset:6144
    s_add_u32 m0, s27, 131072
    s_mov_b32 s28, 98304
    buffer_load_dwordx4 v15, s[52:55], s28 offen nt lds
    s_waitcnt lgkmcnt(13)
    v_mfma_f32_32x32x16_bf16 v[80:95], v[72:75], v[40:43], v[80:95]
    ds_read_b64_tr_b16 v[72:73], v10 offset:4096
    ds_read_b64_tr_b16 v[74:75], v10 offset:6144
    s_waitcnt lgkmcnt(14)
    v_mfma_f32_32x32x16_bf16 v[80:95], v[76:79], v[44:47], v[80:95]
    ds_read_b64_tr_b16 v[76:77], v11 offset:4096
    ds_read_b64_tr_b16 v[78:79], v11 offset:6144
    s_setprio 0
    s_nop 8
    v_exp_f32 v80, v80
    v_exp_f32 v81, v81
    v_exp_f32 v82, v82
    v_exp_f32 v83, v83
    v_exp_f32 v84, v84
    v_exp_f32 v85, v85
    v_exp_f32 v86, v86
    v_exp_f32 v87, v87
    v_add_f32 v12, v12, v80
    v_add_f32 v13, v13, v81
    v_add_f32 v12, v12, v82
    v_add_f32 v13, v13, v83
    v_add_f32 v12, v12, v84
    v_add_f32 v13, v13, v85
    v_add_f32 v12, v12, v86
    v_add_f32 v13, v13, v87
    v_cvt_pk_bf16_f32 v80, v80, v81
    v_cvt_pk_bf16_f32 v81, v82, v83
    v_cvt_pk_bf16_f32 v82, v84, v85
    v_cvt_pk_bf16_f32 v83, v86, v87
    v_exp_f32 v88, v88
    v_exp_f32 v89, v89
    s_waitcnt lgkmcnt(14)
    v_mfma_f32_32x32x16_bf16 v[96:111], v[48:51], v[80:83], v[96:111]
    v_add_f32 v12, v12, v88
    v_add_f32 v13, v13, v89
    v_cvt_pk_bf16_f32 v88, v88, v89
    v_exp_f32 v90, v90
    v_exp_f32 v91, v91
    s_waitcnt lgkmcnt(12)
    v_mfma_f32_32x32x16_bf16 v[112:127], v[52:55], v[80:83], v[112:127]
    v_add_f32 v12, v12, v90
    v_add_f32 v13, v13, v91
    v_cvt_pk_bf16_f32 v89, v90, v91
    v_exp_f32 v92, v92
    v_exp_f32 v93, v93
    s_waitcnt lgkmcnt(10)
    v_mfma_f32_32x32x16_bf16 v[128:143], v[56:59], v[80:83], v[128:143]
    v_add_f32 v12, v12, v92
    v_add_f32 v13, v13, v93
    v_cvt_pk_bf16_f32 v90, v92, v93
    s_add_u32 m0, s27, 139264
    s_mov_b32 s28, 106496
    buffer_load_dwordx4 v15, s[52:55], s28 offen nt lds
    v_exp_f32 v94, v94
    v_exp_f32 v95, v95
    s_waitcnt lgkmcnt(8)
    v_mfma_f32_32x32x16_bf16 v[144:159], v[60:63], v[80:83], v[144:159]
    v_add_f32 v12, v12, v94
    v_add_f32 v13, v13, v95
    v_cvt_pk_bf16_f32 v91, v94, v95
    s_waitcnt lgkmcnt(6)
    s_nop 0
    v_mfma_f32_32x32x16_bf16 v[96:111], v[64:67], v[88:91], v[96:111]
    s_waitcnt lgkmcnt(4)
    v_mfma_f32_32x32x16_bf16 v[112:127], v[68:71], v[88:91], v[112:127]
    s_waitcnt vmcnt(4) lgkmcnt(0)
    s_barrier
    ds_read_b128 v[48:51], v4 offset:40960
    ds_read_b128 v[52:55], v5 offset:40960
    ds_read_b128 v[56:59], v6 offset:40960
    ds_read_b128 v[60:63], v7 offset:40960
    ds_read_b128 v[64:67], v4 offset:49152
    ds_read_b128 v[68:71], v5 offset:49152
    v_mfma_f32_32x32x16_bf16 v[128:143], v[72:75], v[88:91], v[128:143]
    ds_read_b128 v[72:75], v6 offset:49152
    s_add_u32 m0, s27, 73728
    s_mov_b32 s28, 114688
    buffer_load_dwordx4 v14, s[48:51], s28 offen nt lds
    v_mfma_f32_32x32x16_bf16 v[144:159], v[76:79], v[88:91], v[144:159]
    ds_read_b128 v[76:79], v7 offset:49152
    s_setprio 1
    s_waitcnt lgkmcnt(7)
    v_mfma_f32_32x32x16_bf16 v[80:95], v[48:51], v[16:19], 0
    ds_read_b64_tr_b16 v[48:49], v8 offset:40960
    ds_read_b64_tr_b16 v[50:51], v8 offset:43008
    s_waitcnt lgkmcnt(8)
    v_mfma_f32_32x32x16_bf16 v[80:95], v[52:55], v[20:23], v[80:95]
    ds_read_b64_tr_b16 v[52:53], v9 offset:40960
    ds_read_b64_tr_b16 v[54:55], v9 offset:43008
    s_add_u32 m0, s27, 81920
    s_mov_b32 s28, 114816
    buffer_load_dwordx4 v14, s[48:51], s28 offen nt lds
    s_waitcnt lgkmcnt(9)
    v_mfma_f32_32x32x16_bf16 v[80:95], v[56:59], v[24:27], v[80:95]
    ds_read_b64_tr_b16 v[56:57], v10 offset:40960
    ds_read_b64_tr_b16 v[58:59], v10 offset:43008
    s_waitcnt lgkmcnt(10)
    v_mfma_f32_32x32x16_bf16 v[80:95], v[60:63], v[28:31], v[80:95]
    ds_read_b64_tr_b16 v[60:61], v11 offset:40960
    ds_read_b64_tr_b16 v[62:63], v11 offset:43008
    s_waitcnt lgkmcnt(11)
    v_mfma_f32_32x32x16_bf16 v[80:95], v[64:67], v[32:35], v[80:95]
    ds_read_b64_tr_b16 v[64:65], v8 offset:45056
    ds_read_b64_tr_b16 v[66:67], v8 offset:47104
    s_waitcnt lgkmcnt(12)
    v_mfma_f32_32x32x16_bf16 v[80:95], v[68:71], v[36:39], v[80:95]
    ds_read_b64_tr_b16 v[68:69], v9 offset:45056
    ds_read_b64_tr_b16 v[70:71], v9 offset:47104
    s_waitcnt lgkmcnt(13)
    v_mfma_f32_32x32x16_bf16 v[80:95], v[72:75], v[40:43], v[80:95]
    ds_read_b64_tr_b16 v[72:73], v10 offset:45056
    ds_read_b64_tr_b16 v[74:75], v10 offset:47104
    s_add_u32 m0, s27, 90112
    s_mov_b32 s28, 114688
    buffer_load_dwordx4 v15, s[52:55], s28 offen nt lds
    s_waitcnt lgkmcnt(14)
    v_mfma_f32_32x32x16_bf16 v[80:95], v[76:79], v[44:47], v[80:95]
    ds_read_b64_tr_b16 v[76:77], v11 offset:45056
    ds_read_b64_tr_b16 v[78:79], v11 offset:47104
    s_setprio 0
    v_add_u32 v4, 73728, v4
    v_add_u32 v5, 73728, v5
    v_add_u32 v6, 73728, v6
    v_add_u32 v7, 73728, v7
    v_add_u32 v8, 73728, v8
    v_add_u32 v9, 73728, v9
    v_add_u32 v10, 73728, v10
    v_add_u32 v11, 73728, v11
    s_nop 0
    v_exp_f32 v80, v80
    v_exp_f32 v81, v81
    v_exp_f32 v82, v82
    v_exp_f32 v83, v83
    v_exp_f32 v84, v84
    v_exp_f32 v85, v85
    v_exp_f32 v86, v86
    v_exp_f32 v87, v87
    v_add_f32 v12, v12, v80
    v_add_f32 v13, v13, v81
    v_add_f32 v12, v12, v82
    v_add_f32 v13, v13, v83
    v_add_f32 v12, v12, v84
    v_add_f32 v13, v13, v85
    v_add_f32 v12, v12, v86
    v_add_f32 v13, v13, v87
    v_cvt_pk_bf16_f32 v80, v80, v81
    v_cvt_pk_bf16_f32 v81, v82, v83
    v_cvt_pk_bf16_f32 v82, v84, v85
    v_cvt_pk_bf16_f32 v83, v86, v87
    v_exp_f32 v88, v88
    v_exp_f32 v89, v89
    s_waitcnt lgkmcnt(14)
    v_mfma_f32_32x32x16_bf16 v[96:111], v[48:51], v[80:83], v[96:111]
    v_add_f32 v12, v12, v88
    v_add_f32 v13, v13, v89
    v_cvt_pk_bf16_f32 v88, v88, v89
    v_exp_f32 v90, v90
    v_exp_f32 v91, v91
    s_waitcnt lgkmcnt(12)
    v_mfma_f32_32x32x16_bf16 v[112:127], v[52:55], v[80:83], v[112:127]
    v_add_f32 v12, v12, v90
    v_add_f32 v13, v13, v91
    v_cvt_pk_bf16_f32 v89, v90, v91
    v_exp_f32 v92, v92
    v_exp_f32 v93, v93
    s_waitcnt lgkmcnt(10)
    v_mfma_f32_32x32x16_bf16 v[128:143], v[56:59], v[80:83], v[128:143]
    v_add_f32 v12, v12, v92
    v_add_f32 v13, v13, v93
    v_cvt_pk_bf16_f32 v90, v92, v93
    v_exp_f32 v94, v94
    v_exp_f32 v95, v95
    s_waitcnt lgkmcnt(8)
    v_mfma_f32_32x32x16_bf16 v[144:159], v[60:63], v[80:83], v[144:159]
    v_add_f32 v12, v12, v94
    v_add_f32 v13, v13, v95
    v_cvt_pk_bf16_f32 v91, v94, v95
    s_add_u32 m0, s27, 98304
    s_mov_b32 s28, 122880
    buffer_load_dwordx4 v15, s[52:55], s28 offen nt lds
    s_waitcnt lgkmcnt(6)
    v_mfma_f32_32x32x16_bf16 v[96:111], v[64:67], v[88:91], v[96:111]
    s_waitcnt lgkmcnt(4)
    v_mfma_f32_32x32x16_bf16 v[112:127], v[68:71], v[88:91], v[112:127]
    s_waitcnt vmcnt(4) lgkmcnt(0)
    s_barrier
    ds_read_b128 v[48:51], v4 offset:40960
    ds_read_b128 v[52:55], v5 offset:40960
    ds_read_b128 v[56:59], v6 offset:40960
    ds_read_b128 v[60:63], v7 offset:40960
    ds_read_b128 v[64:67], v4 offset:49152
    ds_read_b128 v[68:71], v5 offset:49152
    v_mfma_f32_32x32x16_bf16 v[128:143], v[72:75], v[88:91], v[128:143]
    ds_read_b128 v[72:75], v6 offset:49152
    s_mov_b64 exec, 0xffff
    buffer_load_dword v165, v164, s[56:59], s39 offen
    s_mov_b64 exec, -1
    v_mfma_f32_32x32x16_bf16 v[144:159], v[76:79], v[88:91], v[144:159]
    ds_read_b128 v[76:79], v7 offset:49152
    s_setprio 1
    s_waitcnt lgkmcnt(7)
    v_mfma_f32_32x32x16_bf16 v[80:95], v[48:51], v[16:19], 0
    ds_read_b64_tr_b16 v[48:49], v8 offset:40960
    ds_read_b64_tr_b16 v[50:51], v8 offset:43008
    s_waitcnt lgkmcnt(8)
    v_mfma_f32_32x32x16_bf16 v[80:95], v[52:55], v[20:23], v[80:95]
    ds_read_b64_tr_b16 v[52:53], v9 offset:40960
    ds_read_b64_tr_b16 v[54:55], v9 offset:43008
    s_add_u32 m0, s79, 0
    s_add_u32 s28, s72, 0
    buffer_load_dwordx4 v160, s[56:59], s28 offen lds
    s_waitcnt lgkmcnt(9)
    v_mfma_f32_32x32x16_bf16 v[80:95], v[56:59], v[24:27], v[80:95]
    ds_read_b64_tr_b16 v[56:57], v10 offset:40960
    ds_read_b64_tr_b16 v[58:59], v10 offset:43008
    s_waitcnt lgkmcnt(10)
    v_mfma_f32_32x32x16_bf16 v[80:95], v[60:63], v[28:31], v[80:95]
    ds_read_b64_tr_b16 v[60:61], v11 offset:40960
    ds_read_b64_tr_b16 v[62:63], v11 offset:43008
    s_waitcnt lgkmcnt(11)
    v_mfma_f32_32x32x16_bf16 v[80:95], v[64:67], v[32:35], v[80:95]
    ds_read_b64_tr_b16 v[64:65], v8 offset:45056
    ds_read_b64_tr_b16 v[66:67], v8 offset:47104
    s_waitcnt lgkmcnt(12)
    v_mfma_f32_32x32x16_bf16 v[80:95], v[68:71], v[36:39], v[80:95]
    ds_read_b64_tr_b16 v[68:69], v9 offset:45056
    ds_read_b64_tr_b16 v[70:71], v9 offset:47104
    s_waitcnt lgkmcnt(13)
    v_mfma_f32_32x32x16_bf16 v[80:95], v[72:75], v[40:43], v[80:95]
    ds_read_b64_tr_b16 v[72:73], v10 offset:45056
    ds_read_b64_tr_b16 v[74:75], v10 offset:47104
    s_add_u32 m0, s79, 1024
    s_add_u32 s28, s72, 0
    buffer_load_dwordx4 v161, s[56:59], s28 offen lds
    s_waitcnt lgkmcnt(14)
    v_mfma_f32_32x32x16_bf16 v[80:95], v[76:79], v[44:47], v[80:95]
    ds_read_b64_tr_b16 v[76:77], v11 offset:45056
    ds_read_b64_tr_b16 v[78:79], v11 offset:47104
    s_setprio 0
    s_nop 8
    v_exp_f32 v80, v80
    v_exp_f32 v81, v81
    v_exp_f32 v82, v82
    v_exp_f32 v83, v83
    v_exp_f32 v84, v84
    v_exp_f32 v85, v85
    v_exp_f32 v86, v86
    v_exp_f32 v87, v87
    v_add_f32 v12, v12, v80
    v_add_f32 v13, v13, v81
    v_add_f32 v12, v12, v82
    v_add_f32 v13, v13, v83
    v_add_f32 v12, v12, v84
    v_add_f32 v13, v13, v85
    v_add_f32 v12, v12, v86
    v_add_f32 v13, v13, v87
    v_cvt_pk_bf16_f32 v80, v80, v81
    v_cvt_pk_bf16_f32 v81, v82, v83
    v_cvt_pk_bf16_f32 v82, v84, v85
    v_cvt_pk_bf16_f32 v83, v86, v87
    v_exp_f32 v88, v88
    v_exp_f32 v89, v89
    s_waitcnt lgkmcnt(14)
    v_mfma_f32_32x32x16_bf16 v[96:111], v[48:51], v[80:83], v[96:111]
    v_add_f32 v12, v12, v88
    v_add_f32 v13, v13, v89
    v_cvt_pk_bf16_f32 v88, v88, v89
    v_exp_f32 v90, v90
    v_exp_f32 v91, v91
    s_waitcnt lgkmcnt(12)
    v_mfma_f32_32x32x16_bf16 v[112:127], v[52:55], v[80:83], v[112:127]
    v_add_f32 v12, v12, v90
    v_add_f32 v13, v13, v91
    v_cvt_pk_bf16_f32 v89, v90, v91
    v_exp_f32 v92, v92
    v_exp_f32 v93, v93
    s_waitcnt lgkmcnt(10)
    v_mfma_f32_32x32x16_bf16 v[128:143], v[56:59], v[80:83], v[128:143]
    v_add_f32 v12, v12, v92
    v_add_f32 v13, v13, v93
    v_cvt_pk_bf16_f32 v90, v92, v93
    v_exp_f32 v94, v94
    v_exp_f32 v95, v95
    s_waitcnt lgkmcnt(8)
    v_mfma_f32_32x32x16_bf16 v[144:159], v[60:63], v[80:83], v[144:159]
    v_add_f32 v12, v12, v94
    v_add_f32 v13, v13, v95
    v_cvt_pk_bf16_f32 v91, v94, v95
    s_waitcnt lgkmcnt(6)
    s_nop 0
    v_mfma_f32_32x32x16_bf16 v[96:111], v[64:67], v[88:91], v[96:111]
    s_waitcnt lgkmcnt(4)
    v_mfma_f32_32x32x16_bf16 v[112:127], v[68:71], v[88:91], v[112:127]
    s_waitcnt vmcnt(3) lgkmcnt(0)
    s_barrier
    ds_read_b128 v[48:51], v4 offset:0
    ds_read_b128 v[52:55], v5 offset:0
    ds_read_b128 v[56:59], v6 offset:0
    ds_read_b128 v[60:63], v7 offset:0
    ds_read_b128 v[64:67], v4 offset:8192
    ds_read_b128 v[68:71], v5 offset:8192
    v_mfma_f32_32x32x16_bf16 v[128:143], v[72:75], v[88:91], v[128:143]
    ds_read_b128 v[72:75], v6 offset:8192
    s_add_u32 m0, s79, 2048
    s_add_u32 s28, s72, 0
    buffer_load_dwordx4 v162, s[56:59], s28 offen lds
    v_mfma_f32_32x32x16_bf16 v[144:159], v[76:79], v[88:91], v[144:159]
    ds_read_b128 v[76:79], v7 offset:8192
    s_setprio 1
    s_waitcnt lgkmcnt(7)
    v_mfma_f32_32x32x16_bf16 v[80:95], v[48:51], v[16:19], 0
    ds_read_b64_tr_b16 v[48:49], v8 offset:0
    ds_read_b64_tr_b16 v[50:51], v8 offset:2048
    s_waitcnt lgkmcnt(8)
    v_mfma_f32_32x32x16_bf16 v[80:95], v[52:55], v[20:23], v[80:95]
    ds_read_b64_tr_b16 v[52:53], v9 offset:0
    ds_read_b64_tr_b16 v[54:55], v9 offset:2048
    s_add_u32 m0, s79, 36864
    s_add_u32 s28, s72, 73728
    buffer_load_dwordx4 v160, s[56:59], s28 offen lds
    s_waitcnt lgkmcnt(9)
    v_mfma_f32_32x32x16_bf16 v[80:95], v[56:59], v[24:27], v[80:95]
    ds_read_b64_tr_b16 v[56:57], v10 offset:0
    ds_read_b64_tr_b16 v[58:59], v10 offset:2048
    s_waitcnt lgkmcnt(10)
    v_mfma_f32_32x32x16_bf16 v[80:95], v[60:63], v[28:31], v[80:95]
    ds_read_b64_tr_b16 v[60:61], v11 offset:0
    ds_read_b64_tr_b16 v[62:63], v11 offset:2048
    s_waitcnt lgkmcnt(11)
    v_mfma_f32_32x32x16_bf16 v[80:95], v[64:67], v[32:35], v[80:95]
    ds_read_b64_tr_b16 v[64:65], v8 offset:4096
    ds_read_b64_tr_b16 v[66:67], v8 offset:6144
    s_add_u32 m0, s79, 37888
    s_add_u32 s28, s72, 73728
    buffer_load_dwordx4 v161, s[56:59], s28 offen lds
    s_waitcnt lgkmcnt(12)
    v_mfma_f32_32x32x16_bf16 v[80:95], v[68:71], v[36:39], v[80:95]
    ds_read_b64_tr_b16 v[68:69], v9 offset:4096
    ds_read_b64_tr_b16 v[70:71], v9 offset:6144
    s_waitcnt lgkmcnt(13)
    v_mfma_f32_32x32x16_bf16 v[80:95], v[72:75], v[40:43], v[80:95]
    ds_read_b64_tr_b16 v[72:73], v10 offset:4096
    ds_read_b64_tr_b16 v[74:75], v10 offset:6144
    s_waitcnt lgkmcnt(14)
    v_mfma_f32_32x32x16_bf16 v[80:95], v[76:79], v[44:47], v[80:95]
    ds_read_b64_tr_b16 v[76:77], v11 offset:4096
    ds_read_b64_tr_b16 v[78:79], v11 offset:6144
    s_add_u32 m0, s79, 38912
    s_add_u32 s28, s72, 73728
    buffer_load_dwordx4 v162, s[56:59], s28 offen lds
    s_setprio 0
    s_nop 5
    v_exp_f32 v80, v80
    v_exp_f32 v81, v81
    v_exp_f32 v82, v82
    v_exp_f32 v83, v83
    v_exp_f32 v84, v84
    v_exp_f32 v85, v85
    v_exp_f32 v86, v86
    v_exp_f32 v87, v87
    v_add_f32 v12, v12, v80
    v_add_f32 v13, v13, v81
    v_add_f32 v12, v12, v82
    v_add_f32 v13, v13, v83
    v_add_f32 v12, v12, v84
    v_add_f32 v13, v13, v85
    v_add_f32 v12, v12, v86
    v_add_f32 v13, v13, v87
    v_cvt_pk_bf16_f32 v80, v80, v81
    v_cvt_pk_bf16_f32 v81, v82, v83
    v_cvt_pk_bf16_f32 v82, v84, v85
    v_cvt_pk_bf16_f32 v83, v86, v87
    v_exp_f32 v88, v88
    v_exp_f32 v89, v89
    s_waitcnt lgkmcnt(14)
    v_mfma_f32_32x32x16_bf16 v[96:111], v[48:51], v[80:83], v[96:111]
    v_add_f32 v12, v12, v88
    v_add_f32 v13, v13, v89
    v_cvt_pk_bf16_f32 v88, v88, v89
    v_exp_f32 v90, v90
    v_exp_f32 v91, v91
    s_waitcnt lgkmcnt(12)
    v_mfma_f32_32x32x16_bf16 v[112:127], v[52:55], v[80:83], v[112:127]
    v_add_f32 v12, v12, v90
    v_add_f32 v13, v13, v91
    v_cvt_pk_bf16_f32 v89, v90, v91
    v_exp_f32 v92, v92
    v_exp_f32 v93, v93
    s_waitcnt lgkmcnt(10)
    v_mfma_f32_32x32x16_bf16 v[128:143], v[56:59], v[80:83], v[128:143]
    v_add_f32 v12, v12, v92
    v_add_f32 v13, v13, v93
    v_cvt_pk_bf16_f32 v90, v92, v93
    v_exp_f32 v94, v94
    v_exp_f32 v95, v95
    s_waitcnt lgkmcnt(8)
    v_mfma_f32_32x32x16_bf16 v[144:159], v[60:63], v[80:83], v[144:159]
    v_add_f32 v12, v12, v94
    v_add_f32 v13, v13, v95
    v_cvt_pk_bf16_f32 v91, v94, v95
    s_waitcnt lgkmcnt(6)
    s_nop 0
    v_mfma_f32_32x32x16_bf16 v[96:111], v[64:67], v[88:91], v[96:111]
    s_waitcnt lgkmcnt(4)
    v_mfma_f32_32x32x16_bf16 v[112:127], v[68:71], v[88:91], v[112:127]
    s_waitcnt lgkmcnt(2)
    v_mfma_f32_32x32x16_bf16 v[128:143], v[72:75], v[88:91], v[128:143]
    s_waitcnt lgkmcnt(0)
    v_mfma_f32_32x32x16_bf16 v[144:159], v[76:79], v[88:91], v[144:159]
    s_nop 11
    s_branch L_fin
L_qc:
    s_lshl_b32 s25, s22, 5
    s_add_u32 s68, s16, s25
    s_addc_u32 s69, s17, 0
    s_mov_b32 s70, 32
    s_mov_b32 s71, 0x20000
    s_or_b32 s36, s36, 1
    v_mov_b32 v166, s36
    v_mov_b32 v167, s37
    s_or_b32 s25, s23, s24
    s_or_b32 s25, s25, s3
    s_cmp_eq_u32 s25, 0
    s_cbranch_scc0 L_nolead
    s_mov_b64 exec, 1
    buffer_store_dwordx2 v[166:167], off, s[68:71], 0 sc0 sc1
    s_mov_b64 exec, -1
L_nolead:
    s_and_b32 s29, s24, 1
    s_lshr_b32 s30, s24, 1
    s_mul_i32 s25, s30, 12288
    s_add_u32 s25, s25, 49152
    v_and_b32 v1, 31, v0
    v_lshrrev_b32 v2, 1, v1
    v_and_b32 v2, 7, v2
    v_lshrrev_b32 v3, 5, v0
    v_xor_b32 v2, v2, v3
    v_lshlrev_b32 v2, 4, v2
    v_lshlrev_b32 v1, 7, v1
    v_add3_u32 v56, v1, v2, s25
    v_xor_b32 v57, 32, v56
    v_xor_b32 v58, 64, v56
    v_xor_b32 v59, 96, v56
    v_bfe_u32 v1, v0, 2, 2
    v_lshrrev_b32 v2, 5, v0
    v_lshl_add_u32 v2, v2, 3, v1
    v_lshlrev_b32 v2, 8, v2
    s_lshl_b32 s25, s29, 1
    v_xor_b32 v1, s25, v1
    v_lshl_add_u32 v2, v1, 6, v2
    v_bfe_u32 v1, v0, 4, 1
    v_lshl_add_u32 v2, v1, 5, v2
    v_and_b32 v1, 1, v0
    v_lshl_add_u32 v2, v1, 4, v2
    v_bfe_u32 v1, v0, 1, 1
    v_lshl_add_u32 v60, v1, 3, v2
    v_add_u32 v60, 32768, v60
    v_xor_b32 v61, 64, v60
    v_add_u32 v12, 81920, v56
    v_add_u32 v13, 81920, v57
    v_add_u32 v14, 81920, v58
    v_add_u32 v15, 81920, v59
    v_add_u32 v62, 81920, v60
    v_add_u32 v63, 81920, v61
    s_lshl_b32 s26, s29, 12
    v_lshl_add_u32 v1, v0, 4, s26
    s_cmp_eq_u32 s30, 0
    s_cselect_b32 s25, 11, 4
    v_lshl_add_u32 v163, s25, 13, v1
    s_cselect_b32 s25, 12, 18
    v_lshl_add_u32 v164, s25, 13, v1
    s_cselect_b32 s25, 13, 19
    v_lshl_add_u32 v165, s25, 13, v1
    s_lshl_b32 s25, s22, 5
    s_add_u32 s25, s25, s23
    s_lshl_b32 s26, s25, 17
    s_add_u32 s48, s6, s26
    s_addc_u32 s49, s7, 0
    s_mov_b32 s50, 131072
    s_mov_b32 s51, 0x20000
    s_add_u32 s52, s8, s26
    s_addc_u32 s53, s9, 0
    s_mov_b32 s54, 131072
    s_mov_b32 s55, 0x20000
    s_and_b32 s25, s21, 1
    s_mul_i32 s25, s25, 576
    s_add_u32 s56, s12, s25
    s_addc_u32 s57, s13, 0
    s_mov_b32 s58, 4718016
    s_mov_b32 s59, 0x20000
    s_mov_b32 s60, s18
    s_mov_b32 s61, s19
    s_mov_b32 s62, 268435456
    s_mov_b32 s63, 0x20000
    s_mul_i32 s72, s23, 147456
    s_and_b32 s25, s22, 3
    s_cmp_eq_u32 s25, 3
    s_cselect_b32 s25, 0, s25
    s_lshr_b32 s31, s21, 1
    s_mul_i32 s31, s31, 24576
    s_add_u32 s26, s25, 0
    s_cmp_ge_u32 s26, 3
    s_cselect_b32 s39, 3, 0
    s_sub_u32 s26, s26, s39
    s_add_u32 s26, s26, s21
    s_add_u32 s26, s26, 1
    s_and_b32 s26, s26, 3
    s_lshl_b32 s39, s20, 2
    s_add_u32 s26, s26, s39
    s_mul_i32 s73, s26, 147456
    s_lshl_b32 s39, s22, 5
    s_add_u32 s26, s26, s39
    s_mul_i32 s26, s26, 49152
    s_add_u32 s76, s26, s31
    s_add_u32 s26, s25, 1
    s_cmp_ge_u32 s26, 3
    s_cselect_b32 s39, 3, 0
    s_sub_u32 s26, s26, s39
    s_add_u32 s26, s26, s21
    s_add_u32 s26, s26, 1
    s_and_b32 s26, s26, 3
    s_lshl_b32 s39, s20, 2
    s_add_u32 s26, s26, s39
    s_mul_i32 s74, s26, 147456
    s_lshl_b32 s39, s22, 5
    s_add_u32 s26, s26, s39
    s_mul_i32 s26, s26, 49152
    s_add_u32 s77, s26, s31
    s_add_u32 s26, s25, 2
    s_cmp_ge_u32 s26, 3
    s_cselect_b32 s39, 3, 0
    s_sub_u32 s26, s26, s39
    s_add_u32 s26, s26, s21
    s_add_u32 s26, s26, 1
    s_and_b32 s26, s26, 3
    s_lshl_b32 s39, s20, 2
    s_add_u32 s26, s26, s39
    s_mul_i32 s75, s26, 147456
    s_lshl_b32 s39, s22, 5
    s_add_u32 s26, s26, s39
    s_mul_i32 s26, s26, 49152
    s_add_u32 s78, s26, s31
    s_mul_i32 s25, s24, 43
    s_lshr_b32 s25, s25, 7
    s_mul_i32 s26, s25, 3
    s_sub_u32 s26, s24, s26
    s_mul_i32 s79, s24, 3072
    s_mul_i32 s26, s26, 192
    s_mul_i32 s25, s25, 18432
    v_add_u32 v1, s26, v0
    v_mul_u32_u24 v2, 1821, v1
    v_lshrrev_b32 v2, 16, v2
    v_mul_u32_u24 v3, 36, v2
    v_sub_u32 v1, v1, v3
    v_bfe_u32 v3, v2, 2, 1
    v_lshlrev_b32 v3, 1, v3
    v_xor_b32 v1, v1, v3
    v_mul_u32_u24 v2, 1152, v2
    v_lshl_add_u32 v1, v1, 4, v2
    v_add_u32 v160, s25, v1
    v_add_u32 v1, s26, v0
    v_add_u32 v1, 64, v1
    v_mul_u32_u24 v2, 1821, v1
    v_lshrrev_b32 v2, 16, v2
    v_mul_u32_u24 v3, 36, v2
    v_sub_u32 v1, v1, v3
    v_bfe_u32 v3, v2, 2, 1
    v_lshlrev_b32 v3, 1, v3
    v_xor_b32 v1, v1, v3
    v_mul_u32_u24 v2, 1152, v2
    v_lshl_add_u32 v1, v1, 4, v2
    v_add_u32 v161, s25, v1
    v_add_u32 v1, s26, v0
    v_add_u32 v1, 128, v1
    v_mul_u32_u24 v2, 1821, v1
    v_lshrrev_b32 v2, 16, v2
    v_mul_u32_u24 v3, 36, v2
    v_sub_u32 v1, v1, v3
    v_bfe_u32 v3, v2, 2, 1
    v_lshlrev_b32 v3, 1, v3
    v_xor_b32 v1, v1, v3
    v_mul_u32_u24 v2, 1152, v2
    v_lshl_add_u32 v1, v1, 4, v2
    v_add_u32 v162, s25, v1
    s_and_b32 s29, s24, 1
    s_lshr_b32 s30, s24, 1
    s_lshl_b32 s25, s29, 12
    v_and_b32 v1, 31, v0
    v_lshrrev_b32 v2, 1, v1
    v_and_b32 v2, 7, v2
    v_lshrrev_b32 v3, 5, v0
    v_xor_b32 v2, v2, v3
    v_lshlrev_b32 v2, 4, v2
    v_lshlrev_b32 v1, 7, v1
    v_add3_u32 v4, v1, v2, s25
    v_xor_b32 v5, 32, v4
    v_xor_b32 v6, 64, v4
    v_xor_b32 v7, 96, v4
    v_bfe_u32 v1, v0, 2, 2
    v_lshrrev_b32 v2, 5, v0
    v_lshl_add_u32 v2, v2, 2, v1
    v_lshlrev_b32 v2, 8, v2
    v_lshl_add_u32 v2, v1, 6, v2
    v_bfe_u32 v1, v0, 4, 1
    v_lshl_add_u32 v2, v1, 5, v2
    v_and_b32 v1, 3, v0
    v_lshl_add_u32 v2, v1, 3, v2
    s_lshl_b32 s25, s29, 13
    s_add_u32 s25, s25, 16384
    v_add_u32 v8, s25, v2
    v_xor_b32 v9, 64, v8
    v_xor_b32 v10, 128, v8
    v_xor_b32 v11, 192, v8
    s_add_u32 s25, s30, 11
    s_add_u32 s26, s30, 14
    s_cmp_lt_u32 s30, 3
    s_cselect_b32 s25, s25, s26
    s_cmp_eq_u32 s30, 3
    s_cselect_b32 s25, 4, s25
    s_lshl_b32 s25, s25, 13
    v_lshl_add_u32 v3, v0, 4, s25
    s_barrier
    ds_read_b64_tr_b16 v[16:17], v60 offset:0
    ds_read_b64_tr_b16 v[18:19], v60 offset:1024
    ds_read_b128 v[24:27], v56 offset:0
    ds_read_b128 v[28:31], v56 offset:4096
    ds_read_b128 v[32:35], v56 offset:8192
    ds_read_b64_tr_b16 v[20:21], v61 offset:0
    ds_read_b64_tr_b16 v[22:23], v61 offset:1024
    s_waitcnt lgkmcnt(4)
    v_mfma_f32_32x32x16_bf16 v[64:79], v[16:19], v[24:27], 0
    ds_read_b64_tr_b16 v[36:37], v60 offset:4096
    ds_read_b64_tr_b16 v[38:39], v60 offset:5120
    ds_read_b128 v[44:47], v57 offset:0
    s_waitcnt lgkmcnt(6)
    v_mfma_f32_32x32x16_bf16 v[80:95], v[16:19], v[28:31], 0
    ds_read_b128 v[48:51], v57 offset:4096
    ds_read_b128 v[52:55], v57 offset:8192
    s_waitcnt lgkmcnt(7)
    v_mfma_f32_32x32x16_bf16 v[96:111], v[16:19], v[32:35], 0
    ds_read_b64_tr_b16 v[40:41], v61 offset:4096
    ds_read_b64_tr_b16 v[42:43], v61 offset:5120
    s_waitcnt lgkmcnt(7)
    v_mfma_f32_32x32x16_bf16 v[112:127], v[20:23], v[24:27], 0
    v_mfma_f32_32x32x16_bf16 v[128:143], v[20:23], v[28:31], 0
    v_mfma_f32_32x32x16_bf16 v[144:159], v[20:23], v[32:35], 0
    s_waitcnt lgkmcnt(4)
    v_mfma_f32_32x32x16_bf16 v[64:79], v[36:39], v[44:47], v[64:79]
    ds_read_b64_tr_b16 v[16:17], v60 offset:8192
    ds_read_b64_tr_b16 v[18:19], v60 offset:9216
    ds_read_b128 v[24:27], v58 offset:0
    s_waitcnt lgkmcnt(6)
    v_mfma_f32_32x32x16_bf16 v[80:95], v[36:39], v[48:51], v[80:95]
    ds_read_b128 v[28:31], v58 offset:4096
    ds_read_b128 v[32:35], v58 offset:8192
    s_waitcnt lgkmcnt(7)
    v_mfma_f32_32x32x16_bf16 v[96:111], v[36:39], v[52:55], v[96:111]
    ds_read_b64_tr_b16 v[20:21], v61 offset:8192
    ds_read_b64_tr_b16 v[22:23], v61 offset:9216
    s_waitcnt lgkmcnt(7)
    v_mfma_f32_32x32x16_bf16 v[112:127], v[40:43], v[44:47], v[112:127]
    v_mfma_f32_32x32x16_bf16 v[128:143], v[40:43], v[48:51], v[128:143]
    v_mfma_f32_32x32x16_bf16 v[144:159], v[40:43], v[52:55], v[144:159]
    s_waitcnt lgkmcnt(4)
    v_mfma_f32_32x32x16_bf16 v[64:79], v[16:19], v[24:27], v[64:79]
    ds_read_b64_tr_b16 v[36:37], v60 offset:12288
    ds_read_b64_tr_b16 v[38:39], v60 offset:13312
    ds_read_b128 v[44:47], v59 offset:0
    s_waitcnt lgkmcnt(6)
    v_mfma_f32_32x32x16_bf16 v[80:95], v[16:19], v[28:31], v[80:95]
    ds_read_b128 v[48:51], v59 offset:4096
    ds_read_b128 v[52:55], v59 offset:8192
    s_waitcnt lgkmcnt(7)
    v_mfma_f32_32x32x16_bf16 v[96:111], v[16:19], v[32:35], v[96:111]
    ds_read_b64_tr_b16 v[40:41], v61 offset:12288
    ds_read_b64_tr_b16 v[42:43], v61 offset:13312
    s_waitcnt lgkmcnt(7)
    v_mfma_f32_32x32x16_bf16 v[112:127], v[20:23], v[24:27], v[112:127]
    v_mfma_f32_32x32x16_bf16 v[128:143], v[20:23], v[28:31], v[128:143]
    v_mfma_f32_32x32x16_bf16 v[144:159], v[20:23], v[32:35], v[144:159]
    s_waitcnt lgkmcnt(0)
    v_mfma_f32_32x32x16_bf16 v[64:79], v[36:39], v[44:47], v[64:79]
    s_barrier
    ds_read_b64_tr_b16 v[16:17], v62 offset:0
    ds_read_b64_tr_b16 v[18:19], v62 offset:1024
    ds_read_b128 v[24:27], v12 offset:0
    v_mfma_f32_32x32x16_bf16 v[80:95], v[36:39], v[48:51], v[80:95]
    ds_read_b128 v[28:31], v12 offset:4096
    ds_read_b128 v[32:35], v12 offset:8192
    v_mfma_f32_32x32x16_bf16 v[96:111], v[36:39], v[52:55], v[96:111]
    ds_read_b64_tr_b16 v[20:21], v63 offset:0
    ds_read_b64_tr_b16 v[22:23], v63 offset:1024
    v_mfma_f32_32x32x16_bf16 v[112:127], v[40:43], v[44:47], v[112:127]
    v_mfma_f32_32x32x16_bf16 v[128:143], v[40:43], v[48:51], v[128:143]
    v_mfma_f32_32x32x16_bf16 v[144:159], v[40:43], v[52:55], v[144:159]
    s_waitcnt lgkmcnt(4)
    v_mfma_f32_32x32x16_bf16 v[64:79], v[16:19], v[24:27], v[64:79]
    ds_read_b64_tr_b16 v[36:37], v62 offset:4096
    ds_read_b64_tr_b16 v[38:39], v62 offset:5120
    ds_read_b128 v[44:47], v13 offset:0
    s_waitcnt lgkmcnt(6)
    v_mfma_f32_32x32x16_bf16 v[80:95], v[16:19], v[28:31], v[80:95]
    ds_read_b128 v[48:51], v13 offset:4096
    ds_read_b128 v[52:55], v13 offset:8192
    s_waitcnt lgkmcnt(7)
    v_mfma_f32_32x32x16_bf16 v[96:111], v[16:19], v[32:35], v[96:111]
    ds_read_b64_tr_b16 v[40:41], v63 offset:4096
    ds_read_b64_tr_b16 v[42:43], v63 offset:5120
    s_waitcnt lgkmcnt(7)
    v_mfma_f32_32x32x16_bf16 v[112:127], v[20:23], v[24:27], v[112:127]
    v_mfma_f32_32x32x16_bf16 v[128:143], v[20:23], v[28:31], v[128:143]
    v_mfma_f32_32x32x16_bf16 v[144:159], v[20:23], v[32:35], v[144:159]
    s_waitcnt lgkmcnt(4)
    v_mfma_f32_32x32x16_bf16 v[64:79], v[36:39], v[44:47], v[64:79]
    ds_read_b64_tr_b16 v[16:17], v62 offset:8192
    ds_read_b64_tr_b16 v[18:19], v62 offset:9216
    ds_read_b128 v[24:27], v14 offset:0
    s_waitcnt lgkmcnt(6)
    v_mfma_f32_32x32x16_bf16 v[80:95], v[36:39], v[48:51], v[80:95]
    ds_read_b128 v[28:31], v14 offset:4096
    ds_read_b128 v[32:35], v14 offset:8192
    s_waitcnt lgkmcnt(7)
    v_mfma_f32_32x32x16_bf16 v[96:111], v[36:39], v[52:55], v[96:111]
    ds_read_b64_tr_b16 v[20:21], v63 offset:8192
    ds_read_b64_tr_b16 v[22:23], v63 offset:9216
    s_waitcnt lgkmcnt(7)
    v_mfma_f32_32x32x16_bf16 v[112:127], v[40:43], v[44:47], v[112:127]
    v_mfma_f32_32x32x16_bf16 v[128:143], v[40:43], v[48:51], v[128:143]
    v_mfma_f32_32x32x16_bf16 v[144:159], v[40:43], v[52:55], v[144:159]
    s_waitcnt lgkmcnt(4)
    v_mfma_f32_32x32x16_bf16 v[64:79], v[16:19], v[24:27], v[64:79]
    ds_read_b64_tr_b16 v[36:37], v62 offset:12288
    ds_read_b64_tr_b16 v[38:39], v62 offset:13312
    ds_read_b128 v[44:47], v15 offset:0
    s_waitcnt lgkmcnt(6)
    v_mfma_f32_32x32x16_bf16 v[80:95], v[16:19], v[28:31], v[80:95]
    ds_read_b128 v[48:51], v15 offset:4096
    ds_read_b128 v[52:55], v15 offset:8192
    s_waitcnt lgkmcnt(7)
    v_mfma_f32_32x32x16_bf16 v[96:111], v[16:19], v[32:35], v[96:111]
    ds_read_b64_tr_b16 v[40:41], v63 offset:12288
    ds_read_b64_tr_b16 v[42:43], v63 offset:13312
    s_waitcnt lgkmcnt(7)
    v_mfma_f32_32x32x16_bf16 v[112:127], v[20:23], v[24:27], v[112:127]
    v_mfma_f32_32x32x16_bf16 v[128:143], v[20:23], v[28:31], v[128:143]
    v_mfma_f32_32x32x16_bf16 v[144:159], v[20:23], v[32:35], v[144:159]
    s_waitcnt lgkmcnt(0)
    v_mfma_f32_32x32x16_bf16 v[64:79], v[36:39], v[44:47], v[64:79]
    s_barrier
    ds_read_b64_tr_b16 v[16:17], v60 offset:40960
    ds_read_b64_tr_b16 v[18:19], v60 offset:41984
    ds_read_b128 v[24:27], v56 offset:40960
    v_mfma_f32_32x32x16_bf16 v[80:95], v[36:39], v[48:51], v[80:95]
    ds_read_b128 v[28:31], v56 offset:45056
    ds_read_b128 v[32:35], v56 offset:49152
    v_mfma_f32_32x32x16_bf16 v[96:111], v[36:39], v[52:55], v[96:111]
    ds_read_b64_tr_b16 v[20:21], v61 offset:40960
    ds_read_b64_tr_b16 v[22:23], v61 offset:41984
    v_mfma_f32_32x32x16_bf16 v[112:127], v[40:43], v[44:47], v[112:127]
    v_mfma_f32_32x32x16_bf16 v[128:143], v[40:43], v[48:51], v[128:143]
    v_mfma_f32_32x32x16_bf16 v[144:159], v[40:43], v[52:55], v[144:159]
    s_waitcnt lgkmcnt(4)
    v_mfma_f32_32x32x16_bf16 v[64:79], v[16:19], v[24:27], v[64:79]
    ds_read_b64_tr_b16 v[36:37], v60 offset:45056
    ds_read_b64_tr_b16 v[38:39], v60 offset:46080
    ds_read_b128 v[44:47], v57 offset:40960
    s_waitcnt lgkmcnt(6)
    v_mfma_f32_32x32x16_bf16 v[80:95], v[16:19], v[28:31], v[80:95]
    ds_read_b128 v[48:51], v57 offset:45056
    ds_read_b128 v[52:55], v57 offset:49152
    s_waitcnt lgkmcnt(7)
    v_mfma_f32_32x32x16_bf16 v[96:111], v[16:19], v[32:35], v[96:111]
    ds_read_b64_tr_b16 v[40:41], v61 offset:45056
    ds_read_b64_tr_b16 v[42:43], v61 offset:46080
    s_waitcnt lgkmcnt(7)
    v_mfma_f32_32x32x16_bf16 v[112:127], v[20:23], v[24:27], v[112:127]
    v_mfma_f32_32x32x16_bf16 v[128:143], v[20:23], v[28:31], v[128:143]
    v_mfma_f32_32x32x16_bf16 v[144:159], v[20:23], v[32:35], v[144:159]
    s_waitcnt lgkmcnt(4)
    v_mfma_f32_32x32x16_bf16 v[64:79], v[36:39], v[44:47], v[64:79]
    ds_read_b64_tr_b16 v[16:17], v60 offset:49152
    ds_read_b64_tr_b16 v[18:19], v60 offset:50176
    ds_read_b128 v[24:27], v58 offset:40960
    s_waitcnt lgkmcnt(6)
    v_mfma_f32_32x32x16_bf16 v[80:95], v[36:39], v[48:51], v[80:95]
    ds_read_b128 v[28:31], v58 offset:45056
    ds_read_b128 v[32:35], v58 offset:49152
    s_waitcnt lgkmcnt(7)
    v_mfma_f32_32x32x16_bf16 v[96:111], v[36:39], v[52:55], v[96:111]
    ds_read_b64_tr_b16 v[20:21], v61 offset:49152
    ds_read_b64_tr_b16 v[22:23], v61 offset:50176
    s_waitcnt lgkmcnt(7)
    v_mfma_f32_32x32x16_bf16 v[112:127], v[40:43], v[44:47], v[112:127]
    v_mfma_f32_32x32x16_bf16 v[128:143], v[40:43], v[48:51], v[128:143]
    v_mfma_f32_32x32x16_bf16 v[144:159], v[40:43], v[52:55], v[144:159]
    s_waitcnt lgkmcnt(4)
    v_mfma_f32_32x32x16_bf16 v[64:79], v[16:19], v[24:27], v[64:79]
    ds_read_b64_tr_b16 v[36:37], v60 offset:53248
    ds_read_b64_tr_b16 v[38:39], v60 offset:54272
    ds_read_b128 v[44:47], v59 offset:40960
    s_waitcnt lgkmcnt(6)
    v_mfma_f32_32x32x16_bf16 v[80:95], v[16:19], v[28:31], v[80:95]
    ds_read_b128 v[48:51], v59 offset:45056
    ds_read_b128 v[52:55], v59 offset:49152
    s_waitcnt lgkmcnt(7)
    v_mfma_f32_32x32x16_bf16 v[96:111], v[16:19], v[32:35], v[96:111]
    ds_read_b64_tr_b16 v[40:41], v61 offset:53248
    ds_read_b64_tr_b16 v[42:43], v61 offset:54272
    s_waitcnt lgkmcnt(7)
    v_mfma_f32_32x32x16_bf16 v[112:127], v[20:23], v[24:27], v[112:127]
    v_mfma_f32_32x32x16_bf16 v[128:143], v[20:23], v[28:31], v[128:143]
    v_mfma_f32_32x32x16_bf16 v[144:159], v[20:23], v[32:35], v[144:159]
    s_waitcnt lgkmcnt(0)
    v_mfma_f32_32x32x16_bf16 v[64:79], v[36:39], v[44:47], v[64:79]
    s_barrier
    ds_read_b64_tr_b16 v[16:17], v60 offset:0
    ds_read_b64_tr_b16 v[18:19], v60 offset:1024
    ds_read_b128 v[24:27], v56 offset:0
    v_mfma_f32_32x32x16_bf16 v[80:95], v[36:39], v[48:51], v[80:95]
    ds_read_b128 v[28:31], v56 offset:4096
    ds_read_b128 v[32:35], v56 offset:8192
    v_mfma_f32_32x32x16_bf16 v[96:111], v[36:39], v[52:55], v[96:111]
    ds_read_b64_tr_b16 v[20:21], v61 offset:0
    ds_read_b64_tr_b16 v[22:23], v61 offset:1024
    v_mfma_f32_32x32x16_bf16 v[112:127], v[40:43], v[44:47], v[112:127]
    v_mfma_f32_32x32x16_bf16 v[128:143], v[40:43], v[48:51], v[128:143]
    v_mfma_f32_32x32x16_bf16 v[144:159], v[40:43], v[52:55], v[144:159]
    s_waitcnt lgkmcnt(4)
    v_mfma_f32_32x32x16_bf16 v[64:79], v[16:19], v[24:27], v[64:79]
    ds_read_b64_tr_b16 v[36:37], v60 offset:4096
    ds_read_b64_tr_b16 v[38:39], v60 offset:5120
    ds_read_b128 v[44:47], v57 offset:0
    s_waitcnt lgkmcnt(6)
    v_mfma_f32_32x32x16_bf16 v[80:95], v[16:19], v[28:31], v[80:95]
    ds_read_b128 v[48:51], v57 offset:4096
    ds_read_b128 v[52:55], v57 offset:8192
    s_waitcnt lgkmcnt(7)
    v_mfma_f32_32x32x16_bf16 v[96:111], v[16:19], v[32:35], v[96:111]
    ds_read_b64_tr_b16 v[40:41], v61 offset:4096
    ds_read_b64_tr_b16 v[42:43], v61 offset:5120
    s_waitcnt lgkmcnt(7)
    v_mfma_f32_32x32x16_bf16 v[112:127], v[20:23], v[24:27], v[112:127]
    v_mfma_f32_32x32x16_bf16 v[128:143], v[20:23], v[28:31], v[128:143]
    v_mfma_f32_32x32x16_bf16 v[144:159], v[20:23], v[32:35], v[144:159]
    s_waitcnt lgkmcnt(4)
    v_mfma_f32_32x32x16_bf16 v[64:79], v[36:39], v[44:47], v[64:79]
    ds_read_b64_tr_b16 v[16:17], v60 offset:8192
    ds_read_b64_tr_b16 v[18:19], v60 offset:9216
    ds_read_b128 v[24:27], v58 offset:0
    s_waitcnt lgkmcnt(6)
    v_mfma_f32_32x32x16_bf16 v[80:95], v[36:39], v[48:51], v[80:95]
    ds_read_b128 v[28:31], v58 offset:4096
    ds_read_b128 v[32:35], v58 offset:8192
    s_waitcnt lgkmcnt(7)
    v_mfma_f32_32x32x16_bf16 v[96:111], v[36:39], v[52:55], v[96:111]
    ds_read_b64_tr_b16 v[20:21], v61 offset:8192
    ds_read_b64_tr_b16 v[22:23], v61 offset:9216
    s_waitcnt lgkmcnt(7)
    v_mfma_f32_32x32x16_bf16 v[112:127], v[40:43], v[44:47], v[112:127]
    v_mfma_f32_32x32x16_bf16 v[128:143], v[40:43], v[48:51], v[128:143]
    v_mfma_f32_32x32x16_bf16 v[144:159], v[40:43], v[52:55], v[144:159]
    s_cmp_eq_u32 s24, 0
    s_cselect_b64 exec, 1, 0
    buffer_load_dwordx2 v[166:167], off, s[68:71], 0 sc0 sc1
    s_mov_b64 exec, -1
    s_waitcnt lgkmcnt(4)
    v_mfma_f32_32x32x16_bf16 v[64:79], v[16:19], v[24:27], v[64:79]
    ds_read_b64_tr_b16 v[36:37], v60 offset:12288
    ds_read_b64_tr_b16 v[38:39], v60 offset:13312
    ds_read_b128 v[44:47], v59 offset:0
    s_waitcnt lgkmcnt(6)
    v_mfma_f32_32x32x16_bf16 v[80:95], v[16:19], v[28:31], v[80:95]
    ds_read_b128 v[48:51], v59 offset:4096
    ds_read_b128 v[52:55], v59 offset:8192
    s_waitcnt lgkmcnt(7)
    v_mfma_f32_32x32x16_bf16 v[96:111], v[16:19], v[32:35], v[96:111]
    ds_read_b64_tr_b16 v[40:41], v61 offset:12288
    ds_read_b64_tr_b16 v[42:43], v61 offset:13312
    s_waitcnt lgkmcnt(7)
    v_mfma_f32_32x32x16_bf16 v[112:127], v[20:23], v[24:27], v[112:127]
    v_mfma_f32_32x32x16_bf16 v[128:143], v[20:23], v[28:31], v[128:143]
    v_mfma_f32_32x32x16_bf16 v[144:159], v[20:23], v[32:35], v[144:159]
    s_waitcnt lgkmcnt(0)
    v_mfma_f32_32x32x16_bf16 v[64:79], v[36:39], v[44:47], v[64:79]
    s_barrier
    ds_read_b64_tr_b16 v[16:17], v62 offset:0
    ds_read_b64_tr_b16 v[18:19], v62 offset:1024
    ds_read_b128 v[24:27], v12 offset:0
    v_mfma_f32_32x32x16_bf16 v[80:95], v[36:39], v[48:51], v[80:95]
    ds_read_b128 v[28:31], v12 offset:4096
    ds_read_b128 v[32:35], v12 offset:8192
    v_mfma_f32_32x32x16_bf16 v[96:111], v[36:39], v[52:55], v[96:111]
    ds_read_b64_tr_b16 v[20:21], v63 offset:0
    ds_read_b64_tr_b16 v[22:23], v63 offset:1024
    v_mfma_f32_32x32x16_bf16 v[112:127], v[40:43], v[44:47], v[112:127]
    v_mfma_f32_32x32x16_bf16 v[128:143], v[40:43], v[48:51], v[128:143]
    v_mfma_f32_32x32x16_bf16 v[144:159], v[40:43], v[52:55], v[144:159]
    s_waitcnt lgkmcnt(4)
    v_mfma_f32_32x32x16_bf16 v[64:79], v[16:19], v[24:27], v[64:79]
    ds_read_b64_tr_b16 v[36:37], v62 offset:4096
    ds_read_b64_tr_b16 v[38:39], v62 offset:5120
    ds_read_b128 v[44:47], v13 offset:0
    s_waitcnt lgkmcnt(6)
    v_mfma_f32_32x32x16_bf16 v[80:95], v[16:19], v[28:31], v[80:95]
    ds_read_b128 v[48:51], v13 offset:4096
    ds_read_b128 v[52:55], v13 offset:8192
    s_waitcnt lgkmcnt(7)
    v_mfma_f32_32x32x16_bf16 v[96:111], v[16:19], v[32:35], v[96:111]
    ds_read_b64_tr_b16 v[40:41], v63 offset:4096
    ds_read_b64_tr_b16 v[42:43], v63 offset:5120
    s_waitcnt lgkmcnt(7)
    v_mfma_f32_32x32x16_bf16 v[112:127], v[20:23], v[24:27], v[112:127]
    v_mfma_f32_32x32x16_bf16 v[128:143], v[20:23], v[28:31], v[128:143]
    v_mfma_f32_32x32x16_bf16 v[144:159], v[20:23], v[32:35], v[144:159]
    s_waitcnt lgkmcnt(4)
    v_mfma_f32_32x32x16_bf16 v[64:79], v[36:39], v[44:47], v[64:79]
    ds_read_b64_tr_b16 v[16:17], v62 offset:8192
    ds_read_b64_tr_b16 v[18:19], v62 offset:9216
    ds_read_b128 v[24:27], v14 offset:0
    s_waitcnt lgkmcnt(6)
    v_mfma_f32_32x32x16_bf16 v[80:95], v[36:39], v[48:51], v[80:95]
    ds_read_b128 v[28:31], v14 offset:4096
    ds_read_b128 v[32:35], v14 offset:8192
    s_waitcnt lgkmcnt(7)
    v_mfma_f32_32x32x16_bf16 v[96:111], v[36:39], v[52:55], v[96:111]
    ds_read_b64_tr_b16 v[20:21], v63 offset:8192
    ds_read_b64_tr_b16 v[22:23], v63 offset:9216
    s_waitcnt lgkmcnt(7)
    v_mfma_f32_32x32x16_bf16 v[112:127], v[40:43], v[44:47], v[112:127]
    v_mfma_f32_32x32x16_bf16 v[128:143], v[40:43], v[48:51], v[128:143]
    v_mfma_f32_32x32x16_bf16 v[144:159], v[40:43], v[52:55], v[144:159]
    s_waitcnt lgkmcnt(4)
    v_mfma_f32_32x32x16_bf16 v[64:79], v[16:19], v[24:27], v[64:79]
    ds_read_b64_tr_b16 v[36:37], v62 offset:12288
    ds_read_b64_tr_b16 v[38:39], v62 offset:13312
    ds_read_b128 v[44:47], v15 offset:0
    s_waitcnt lgkmcnt(6)
    v_mfma_f32_32x32x16_bf16 v[80:95], v[16:19], v[28:31], v[80:95]
    ds_read_b128 v[48:51], v15 offset:4096
    ds_read_b128 v[52:55], v15 offset:8192
    s_waitcnt lgkmcnt(7)
    v_mfma_f32_32x32x16_bf16 v[96:111], v[16:19], v[32:35], v[96:111]
    ds_read_b64_tr_b16 v[40:41], v63 offset:12288
    ds_read_b64_tr_b16 v[42:43], v63 offset:13312
    s_waitcnt lgkmcnt(7)
    v_mfma_f32_32x32x16_bf16 v[112:127], v[20:23], v[24:27], v[112:127]
    v_mfma_f32_32x32x16_bf16 v[128:143], v[20:23], v[28:31], v[128:143]
    v_mfma_f32_32x32x16_bf16 v[144:159], v[20:23], v[32:35], v[144:159]
    s_waitcnt lgkmcnt(0)
    v_mfma_f32_32x32x16_bf16 v[64:79], v[36:39], v[44:47], v[64:79]
    s_barrier
    ds_read_b64_tr_b16 v[16:17], v60 offset:40960
    ds_read_b64_tr_b16 v[18:19], v60 offset:41984
    ds_read_b128 v[24:27], v56 offset:40960
    v_mfma_f32_32x32x16_bf16 v[80:95], v[36:39], v[48:51], v[80:95]
    ds_read_b128 v[28:31], v56 offset:45056
    ds_read_b128 v[32:35], v56 offset:49152
    v_mfma_f32_32x32x16_bf16 v[96:111], v[36:39], v[52:55], v[96:111]
    ds_read_b64_tr_b16 v[20:21], v61 offset:40960
    ds_read_b64_tr_b16 v[22:23], v61 offset:41984
    v_mfma_f32_32x32x16_bf16 v[112:127], v[40:43], v[44:47], v[112:127]
    v_mfma_f32_32x32x16_bf16 v[128:143], v[40:43], v[48:51], v[128:143]
    v_mfma_f32_32x32x16_bf16 v[144:159], v[40:43], v[52:55], v[144:159]
    s_waitcnt lgkmcnt(4)
    v_mfma_f32_32x32x16_bf16 v[64:79], v[16:19], v[24:27], v[64:79]
    ds_read_b64_tr_b16 v[36:37], v60 offset:45056
    ds_read_b64_tr_b16 v[38:39], v60 offset:46080
    ds_read_b128 v[44:47], v57 offset:40960
    s_waitcnt lgkmcnt(6)
    v_mfma_f32_32x32x16_bf16 v[80:95], v[16:19], v[28:31], v[80:95]
    ds_read_b128 v[48:51], v57 offset:45056
    ds_read_b128 v[52:55], v57 offset:49152
    s_waitcnt lgkmcnt(7)
    v_mfma_f32_32x32x16_bf16 v[96:111], v[16:19], v[32:35], v[96:111]
    ds_read_b64_tr_b16 v[40:41], v61 offset:45056
    ds_read_b64_tr_b16 v[42:43], v61 offset:46080
    s_waitcnt lgkmcnt(7)
    v_mfma_f32_32x32x16_bf16 v[112:127], v[20:23], v[24:27], v[112:127]
    v_mfma_f32_32x32x16_bf16 v[128:143], v[20:23], v[28:31], v[128:143]
    v_mfma_f32_32x32x16_bf16 v[144:159], v[20:23], v[32:35], v[144:159]
    s_waitcnt lgkmcnt(4)
    v_mfma_f32_32x32x16_bf16 v[64:79], v[36:39], v[44:47], v[64:79]
    ds_read_b64_tr_b16 v[16:17], v60 offset:49152
    ds_read_b64_tr_b16 v[18:19], v60 offset:50176
    ds_read_b128 v[24:27], v58 offset:40960
    s_waitcnt lgkmcnt(6)
    v_mfma_f32_32x32x16_bf16 v[80:95], v[36:39], v[48:51], v[80:95]
    ds_read_b128 v[28:31], v58 offset:45056
    ds_read_b128 v[32:35], v58 offset:49152
    s_waitcnt lgkmcnt(7)
    v_mfma_f32_32x32x16_bf16 v[96:111], v[36:39], v[52:55], v[96:111]
    ds_read_b64_tr_b16 v[20:21], v61 offset:49152
    ds_read_b64_tr_b16 v[22:23], v61 offset:50176
    s_waitcnt lgkmcnt(7)
    v_mfma_f32_32x32x16_bf16 v[112:127], v[40:43], v[44:47], v[112:127]
    v_mfma_f32_32x32x16_bf16 v[128:143], v[40:43], v[48:51], v[128:143]
    v_mfma_f32_32x32x16_bf16 v[144:159], v[40:43], v[52:55], v[144:159]
    s_waitcnt lgkmcnt(4)
    v_mfma_f32_32x32x16_bf16 v[64:79], v[16:19], v[24:27], v[64:79]
    ds_read_b64_tr_b16 v[36:37], v60 offset:53248
    ds_read_b64_tr_b16 v[38:39], v60 offset:54272
    ds_read_b128 v[44:47], v59 offset:40960
    s_waitcnt lgkmcnt(6)
    v_mfma_f32_32x32x16_bf16 v[80:95], v[16:19], v[28:31], v[80:95]
    ds_read_b128 v[48:51], v59 offset:45056
    ds_read_b128 v[52:55], v59 offset:49152
    s_waitcnt lgkmcnt(7)
    v_mfma_f32_32x32x16_bf16 v[96:111], v[16:19], v[32:35], v[96:111]
    ds_read_b64_tr_b16 v[40:41], v61 offset:53248
    ds_read_b64_tr_b16 v[42:43], v61 offset:54272
    s_waitcnt lgkmcnt(7)
    v_mfma_f32_32x32x16_bf16 v[112:127], v[20:23], v[24:27], v[112:127]
    v_mfma_f32_32x32x16_bf16 v[128:143], v[20:23], v[28:31], v[128:143]
    v_mfma_f32_32x32x16_bf16 v[144:159], v[20:23], v[32:35], v[144:159]
    s_waitcnt lgkmcnt(0)
    v_mfma_f32_32x32x16_bf16 v[64:79], v[36:39], v[44:47], v[64:79]
    s_barrier
    ds_read_b64_tr_b16 v[16:17], v60 offset:0
    ds_read_b64_tr_b16 v[18:19], v60 offset:1024
    ds_read_b128 v[24:27], v56 offset:0
    v_mfma_f32_32x32x16_bf16 v[80:95], v[36:39], v[48:51], v[80:95]
    ds_read_b128 v[28:31], v56 offset:4096
    ds_read_b128 v[32:35], v56 offset:8192
    v_mfma_f32_32x32x16_bf16 v[96:111], v[36:39], v[52:55], v[96:111]
    ds_read_b64_tr_b16 v[20:21], v61 offset:0
    ds_read_b64_tr_b16 v[22:23], v61 offset:1024
    v_mfma_f32_32x32x16_bf16 v[112:127], v[40:43], v[44:47], v[112:127]
    v_mfma_f32_32x32x16_bf16 v[128:143], v[40:43], v[48:51], v[128:143]
    v_mfma_f32_32x32x16_bf16 v[144:159], v[40:43], v[52:55], v[144:159]
    s_waitcnt lgkmcnt(4)
    v_mfma_f32_32x32x16_bf16 v[64:79], v[16:19], v[24:27], v[64:79]
    ds_read_b64_tr_b16 v[36:37], v60 offset:4096
    ds_read_b64_tr_b16 v[38:39], v60 offset:5120
    ds_read_b128 v[44:47], v57 offset:0
    s_waitcnt lgkmcnt(6)
    v_mfma_f32_32x32x16_bf16 v[80:95], v[16:19], v[28:31], v[80:95]
    ds_read_b128 v[48:51], v57 offset:4096
    ds_read_b128 v[52:55], v57 offset:8192
    s_waitcnt lgkmcnt(7)
    v_mfma_f32_32x32x16_bf16 v[96:111], v[16:19], v[32:35], v[96:111]
    ds_read_b64_tr_b16 v[40:41], v61 offset:4096
    ds_read_b64_tr_b16 v[42:43], v61 offset:5120
    s_waitcnt lgkmcnt(7)
    v_mfma_f32_32x32x16_bf16 v[112:127], v[20:23], v[24:27], v[112:127]
    v_mfma_f32_32x32x16_bf16 v[128:143], v[20:23], v[28:31], v[128:143]
    v_mfma_f32_32x32x16_bf16 v[144:159], v[20:23], v[32:35], v[144:159]
    s_waitcnt lgkmcnt(4)
    v_mfma_f32_32x32x16_bf16 v[64:79], v[36:39], v[44:47], v[64:79]
    ds_read_b64_tr_b16 v[16:17], v60 offset:8192
    ds_read_b64_tr_b16 v[18:19], v60 offset:9216
    ds_read_b128 v[24:27], v58 offset:0
    s_waitcnt lgkmcnt(6)
    v_mfma_f32_32x32x16_bf16 v[80:95], v[36:39], v[48:51], v[80:95]
    ds_read_b128 v[28:31], v58 offset:4096
    ds_read_b128 v[32:35], v58 offset:8192
    s_waitcnt lgkmcnt(7)
    v_mfma_f32_32x32x16_bf16 v[96:111], v[36:39], v[52:55], v[96:111]
    ds_read_b64_tr_b16 v[20:21], v61 offset:8192
    ds_read_b64_tr_b16 v[22:23], v61 offset:9216
    s_waitcnt lgkmcnt(7)
    v_mfma_f32_32x32x16_bf16 v[112:127], v[40:43], v[44:47], v[112:127]
    v_mfma_f32_32x32x16_bf16 v[128:143], v[40:43], v[48:51], v[128:143]
    v_mfma_f32_32x32x16_bf16 v[144:159], v[40:43], v[52:55], v[144:159]
    s_waitcnt lgkmcnt(4)
    v_mfma_f32_32x32x16_bf16 v[64:79], v[16:19], v[24:27], v[64:79]
    ds_read_b64_tr_b16 v[36:37], v60 offset:12288
    ds_read_b64_tr_b16 v[38:39], v60 offset:13312
    ds_read_b128 v[44:47], v59 offset:0
    s_waitcnt lgkmcnt(6)
    v_mfma_f32_32x32x16_bf16 v[80:95], v[16:19], v[28:31], v[80:95]
    ds_read_b128 v[48:51], v59 offset:4096
    ds_read_b128 v[52:55], v59 offset:8192
    s_waitcnt lgkmcnt(7)
    v_mfma_f32_32x32x16_bf16 v[96:111], v[16:19], v[32:35], v[96:111]
    ds_read_b64_tr_b16 v[40:41], v61 offset:12288
    ds_read_b64_tr_b16 v[42:43], v61 offset:13312
    s_waitcnt lgkmcnt(7)
    v_mfma_f32_32x32x16_bf16 v[112:127], v[20:23], v[24:27], v[112:127]
    v_mfma_f32_32x32x16_bf16 v[128:143], v[20:23], v[28:31], v[128:143]
    v_mfma_f32_32x32x16_bf16 v[144:159], v[20:23], v[32:35], v[144:159]
    s_waitcnt lgkmcnt(0)
    v_mfma_f32_32x32x16_bf16 v[64:79], v[36:39], v[44:47], v[64:79]
    s_barrier
    ds_read_b64_tr_b16 v[16:17], v62 offset:0
    ds_read_b64_tr_b16 v[18:19], v62 offset:1024
    ds_read_b128 v[24:27], v12 offset:0
    v_mfma_f32_32x32x16_bf16 v[80:95], v[36:39], v[48:51], v[80:95]
    ds_read_b128 v[28:31], v12 offset:4096
    ds_read_b128 v[32:35], v12 offset:8192
    v_mfma_f32_32x32x16_bf16 v[96:111], v[36:39], v[52:55], v[96:111]
    ds_read_b64_tr_b16 v[20:21], v63 offset:0
    ds_read_b64_tr_b16 v[22:23], v63 offset:1024
    v_mfma_f32_32x32x16_bf16 v[112:127], v[40:43], v[44:47], v[112:127]
    v_mfma_f32_32x32x16_bf16 v[128:143], v[40:43], v[48:51], v[128:143]
    v_mfma_f32_32x32x16_bf16 v[144:159], v[40:43], v[52:55], v[144:159]
    s_waitcnt lgkmcnt(4)
    v_mfma_f32_32x32x16_bf16 v[64:79], v[16:19], v[24:27], v[64:79]
    ds_read_b64_tr_b16 v[36:37], v62 offset:4096
    ds_read_b64_tr_b16 v[38:39], v62 offset:5120
    ds_read_b128 v[44:47], v13 offset:0
    s_waitcnt lgkmcnt(6)
    v_mfma_f32_32x32x16_bf16 v[80:95], v[16:19], v[28:31], v[80:95]
    ds_read_b128 v[48:51], v13 offset:4096
    ds_read_b128 v[52:55], v13 offset:8192
    s_waitcnt lgkmcnt(7)
    v_mfma_f32_32x32x16_bf16 v[96:111], v[16:19], v[32:35], v[96:111]
    ds_read_b64_tr_b16 v[40:41], v63 offset:4096
    ds_read_b64_tr_b16 v[42:43], v63 offset:5120
    s_waitcnt lgkmcnt(7)
    v_mfma_f32_32x32x16_bf16 v[112:127], v[20:23], v[24:27], v[112:127]
    v_mfma_f32_32x32x16_bf16 v[128:143], v[20:23], v[28:31], v[128:143]
    v_mfma_f32_32x32x16_bf16 v[144:159], v[20:23], v[32:35], v[144:159]
    s_waitcnt lgkmcnt(4)
    v_mfma_f32_32x32x16_bf16 v[64:79], v[36:39], v[44:47], v[64:79]
    ds_read_b64_tr_b16 v[16:17], v62 offset:8192
    ds_read_b64_tr_b16 v[18:19], v62 offset:9216
    ds_read_b128 v[24:27], v14 offset:0
    s_waitcnt lgkmcnt(6)
    v_mfma_f32_32x32x16_bf16 v[80:95], v[36:39], v[48:51], v[80:95]
    ds_read_b128 v[28:31], v14 offset:4096
    ds_read_b128 v[32:35], v14 offset:8192
    s_waitcnt lgkmcnt(7)
    v_mfma_f32_32x32x16_bf16 v[96:111], v[36:39], v[52:55], v[96:111]
    ds_read_b64_tr_b16 v[20:21], v63 offset:8192
    ds_read_b64_tr_b16 v[22:23], v63 offset:9216
    s_waitcnt lgkmcnt(7)
    v_mfma_f32_32x32x16_bf16 v[112:127], v[40:43], v[44:47], v[112:127]
    v_mfma_f32_32x32x16_bf16 v[128:143], v[40:43], v[48:51], v[128:143]
    v_mfma_f32_32x32x16_bf16 v[144:159], v[40:43], v[52:55], v[144:159]
    s_waitcnt lgkmcnt(4)
    v_mfma_f32_32x32x16_bf16 v[64:79], v[16:19], v[24:27], v[64:79]
    ds_read_b64_tr_b16 v[36:37], v62 offset:12288
    ds_read_b64_tr_b16 v[38:39], v62 offset:13312
    ds_read_b128 v[44:47], v15 offset:0
    s_waitcnt lgkmcnt(6)
    v_mfma_f32_32x32x16_bf16 v[80:95], v[16:19], v[28:31], v[80:95]
    ds_read_b128 v[48:51], v15 offset:4096
    ds_read_b128 v[52:55], v15 offset:8192
    s_waitcnt lgkmcnt(7)
    v_mfma_f32_32x32x16_bf16 v[96:111], v[16:19], v[32:35], v[96:111]
    ds_read_b64_tr_b16 v[40:41], v63 offset:12288
    ds_read_b64_tr_b16 v[42:43], v63 offset:13312
    s_waitcnt lgkmcnt(7)
    v_mfma_f32_32x32x16_bf16 v[112:127], v[20:23], v[24:27], v[112:127]
    v_mfma_f32_32x32x16_bf16 v[128:143], v[20:23], v[28:31], v[128:143]
    v_mfma_f32_32x32x16_bf16 v[144:159], v[20:23], v[32:35], v[144:159]
    s_waitcnt lgkmcnt(0)
    v_mfma_f32_32x32x16_bf16 v[64:79], v[36:39], v[44:47], v[64:79]
    s_barrier
    ds_read_b64_tr_b16 v[16:17], v60 offset:40960
    ds_read_b64_tr_b16 v[18:19], v60 offset:41984
    ds_read_b128 v[24:27], v56 offset:40960
    v_mfma_f32_32x32x16_bf16 v[80:95], v[36:39], v[48:51], v[80:95]
    ds_read_b128 v[28:31], v56 offset:45056
    ds_read_b128 v[32:35], v56 offset:49152
    v_mfma_f32_32x32x16_bf16 v[96:111], v[36:39], v[52:55], v[96:111]
    ds_read_b64_tr_b16 v[20:21], v61 offset:40960
    ds_read_b64_tr_b16 v[22:23], v61 offset:41984
    v_mfma_f32_32x32x16_bf16 v[112:127], v[40:43], v[44:47], v[112:127]
    v_mfma_f32_32x32x16_bf16 v[128:143], v[40:43], v[48:51], v[128:143]
    v_mfma_f32_32x32x16_bf16 v[144:159], v[40:43], v[52:55], v[144:159]
    s_waitcnt lgkmcnt(4)
    v_mfma_f32_32x32x16_bf16 v[64:79], v[16:19], v[24:27], v[64:79]
    ds_read_b64_tr_b16 v[36:37], v60 offset:45056
    ds_read_b64_tr_b16 v[38:39], v60 offset:46080
    ds_read_b128 v[44:47], v57 offset:40960
    s_waitcnt lgkmcnt(6)
    v_mfma_f32_32x32x16_bf16 v[80:95], v[16:19], v[28:31], v[80:95]
    ds_read_b128 v[48:51], v57 offset:45056
    ds_read_b128 v[52:55], v57 offset:49152
    s_waitcnt lgkmcnt(7)
    v_mfma_f32_32x32x16_bf16 v[96:111], v[16:19], v[32:35], v[96:111]
    ds_read_b64_tr_b16 v[40:41], v61 offset:45056
    ds_read_b64_tr_b16 v[42:43], v61 offset:46080
    s_waitcnt lgkmcnt(7)
    v_mfma_f32_32x32x16_bf16 v[112:127], v[20:23], v[24:27], v[112:127]
    v_mfma_f32_32x32x16_bf16 v[128:143], v[20:23], v[28:31], v[128:143]
    v_mfma_f32_32x32x16_bf16 v[144:159], v[20:23], v[32:35], v[144:159]
    s_waitcnt lgkmcnt(4)
    v_mfma_f32_32x32x16_bf16 v[64:79], v[36:39], v[44:47], v[64:79]
    ds_read_b64_tr_b16 v[16:17], v60 offset:49152
    ds_read_b64_tr_b16 v[18:19], v60 offset:50176
    ds_read_b128 v[24:27], v58 offset:40960
    s_waitcnt lgkmcnt(6)
    v_mfma_f32_32x32x16_bf16 v[80:95], v[36:39], v[48:51], v[80:95]
    ds_read_b128 v[28:31], v58 offset:45056
    ds_read_b128 v[32:35], v58 offset:49152
    s_waitcnt lgkmcnt(7)
    v_mfma_f32_32x32x16_bf16 v[96:111], v[36:39], v[52:55], v[96:111]
    ds_read_b64_tr_b16 v[20:21], v61 offset:49152
    ds_read_b64_tr_b16 v[22:23], v61 offset:50176
    s_waitcnt lgkmcnt(7)
    v_mfma_f32_32x32x16_bf16 v[112:127], v[40:43], v[44:47], v[112:127]
    v_mfma_f32_32x32x16_bf16 v[128:143], v[40:43], v[48:51], v[128:143]
    v_mfma_f32_32x32x16_bf16 v[144:159], v[40:43], v[52:55], v[144:159]
    s_waitcnt lgkmcnt(4)
    v_mfma_f32_32x32x16_bf16 v[64:79], v[16:19], v[24:27], v[64:79]
    ds_read_b64_tr_b16 v[36:37], v60 offset:53248
    ds_read_b64_tr_b16 v[38:39], v60 offset:54272
    ds_read_b128 v[44:47], v59 offset:40960
    s_waitcnt lgkmcnt(6)
    v_mfma_f32_32x32x16_bf16 v[80:95], v[16:19], v[28:31], v[80:95]
    ds_read_b128 v[48:51], v59 offset:45056
    ds_read_b128 v[52:55], v59 offset:49152
    s_waitcnt lgkmcnt(7)
    v_mfma_f32_32x32x16_bf16 v[96:111], v[16:19], v[32:35], v[96:111]
    ds_read_b64_tr_b16 v[40:41], v61 offset:53248
    ds_read_b64_tr_b16 v[42:43], v61 offset:54272
    s_waitcnt lgkmcnt(7)
    v_mfma_f32_32x32x16_bf16 v[112:127], v[20:23], v[24:27], v[112:127]
    v_mfma_f32_32x32x16_bf16 v[128:143], v[20:23], v[28:31], v[128:143]
    v_mfma_f32_32x32x16_bf16 v[144:159], v[20:23], v[32:35], v[144:159]
    s_waitcnt lgkmcnt(0)
    v_mfma_f32_32x32x16_bf16 v[64:79], v[36:39], v[44:47], v[64:79]
    s_barrier
    v_mfma_f32_32x32x16_bf16 v[80:95], v[36:39], v[48:51], v[80:95]
    v_mfma_f32_32x32x16_bf16 v[96:111], v[36:39], v[52:55], v[96:111]
    v_mfma_f32_32x32x16_bf16 v[112:127], v[40:43], v[44:47], v[112:127]
    v_mfma_f32_32x32x16_bf16 v[128:143], v[40:43], v[48:51], v[128:143]
    v_mfma_f32_32x32x16_bf16 v[144:159], v[40:43], v[52:55], v[144:159]
    s_mov_b32 s32, 0x3e0293ee
    s_mov_b32 s33, s32
    s_nop 3
    v_pk_mul_f32 v[64:65], v[64:65], s[32:33]
    v_pk_mul_f32 v[66:67], v[66:67], s[32:33]
    v_pk_mul_f32 v[68:69], v[68:69], s[32:33]
    v_pk_mul_f32 v[70:71], v[70:71], s[32:33]
    v_cvt_pk_bf16_f32 v16, v64, v65
    v_cvt_pk_bf16_f32 v17, v66, v67
    v_cvt_pk_bf16_f32 v18, v68, v69
    v_cvt_pk_bf16_f32 v19, v70, v71
    ds_write_b128 v163, v[16:19] offset:0
    v_pk_mul_f32 v[72:73], v[72:73], s[32:33]
    v_pk_mul_f32 v[74:75], v[74:75], s[32:33]
    v_pk_mul_f32 v[76:77], v[76:77], s[32:33]
    v_pk_mul_f32 v[78:79], v[78:79], s[32:33]
    v_cvt_pk_bf16_f32 v20, v72, v73
    v_cvt_pk_bf16_f32 v21, v74, v75
    v_cvt_pk_bf16_f32 v22, v76, v77
    v_cvt_pk_bf16_f32 v23, v78, v79
    ds_write_b128 v163, v[20:23] offset:1024
    v_pk_mul_f32 v[80:81], v[80:81], s[32:33]
    v_pk_mul_f32 v[82:83], v[82:83], s[32:33]
    v_pk_mul_f32 v[84:85], v[84:85], s[32:33]
    v_pk_mul_f32 v[86:87], v[86:87], s[32:33]
    v_cvt_pk_bf16_f32 v24, v80, v81
    v_cvt_pk_bf16_f32 v25, v82, v83
    v_cvt_pk_bf16_f32 v26, v84, v85
    v_cvt_pk_bf16_f32 v27, v86, v87
    ds_write_b128 v164, v[24:27] offset:0
    v_pk_mul_f32 v[88:89], v[88:89], s[32:33]
    v_pk_mul_f32 v[90:91], v[90:91], s[32:33]
    v_pk_mul_f32 v[92:93], v[92:93], s[32:33]
    v_pk_mul_f32 v[94:95], v[94:95], s[32:33]
    v_cvt_pk_bf16_f32 v28, v88, v89
    v_cvt_pk_bf16_f32 v29, v90, v91
    v_cvt_pk_bf16_f32 v30, v92, v93
    v_cvt_pk_bf16_f32 v31, v94, v95
    ds_write_b128 v164, v[28:31] offset:1024
    v_pk_mul_f32 v[96:97], v[96:97], s[32:33]
    v_pk_mul_f32 v[98:99], v[98:99], s[32:33]
    v_pk_mul_f32 v[100:101], v[100:101], s[32:33]
    v_pk_mul_f32 v[102:103], v[102:103], s[32:33]
    v_cvt_pk_bf16_f32 v32, v96, v97
    v_cvt_pk_bf16_f32 v33, v98, v99
    v_cvt_pk_bf16_f32 v34, v100, v101
    v_cvt_pk_bf16_f32 v35, v102, v103
    ds_write_b128 v165, v[32:35] offset:0
    v_pk_mul_f32 v[104:105], v[104:105], s[32:33]
    v_pk_mul_f32 v[106:107], v[106:107], s[32:33]
    v_pk_mul_f32 v[108:109], v[108:109], s[32:33]
    v_pk_mul_f32 v[110:111], v[110:111], s[32:33]
    v_cvt_pk_bf16_f32 v36, v104, v105
    v_cvt_pk_bf16_f32 v37, v106, v107
    v_cvt_pk_bf16_f32 v38, v108, v109
    v_cvt_pk_bf16_f32 v39, v110, v111
    ds_write_b128 v165, v[36:39] offset:1024
    v_pk_mul_f32 v[112:113], v[112:113], s[32:33]
    v_pk_mul_f32 v[114:115], v[114:115], s[32:33]
    v_pk_mul_f32 v[116:117], v[116:117], s[32:33]
    v_pk_mul_f32 v[118:119], v[118:119], s[32:33]
    v_cvt_pk_bf16_f32 v40, v112, v113
    v_cvt_pk_bf16_f32 v41, v114, v115
    v_cvt_pk_bf16_f32 v42, v116, v117
    v_cvt_pk_bf16_f32 v43, v118, v119
    ds_write_b128 v163, v[40:43] offset:2048
    v_pk_mul_f32 v[120:121], v[120:121], s[32:33]
    v_pk_mul_f32 v[122:123], v[122:123], s[32:33]
    v_pk_mul_f32 v[124:125], v[124:125], s[32:33]
    v_pk_mul_f32 v[126:127], v[126:127], s[32:33]
    v_cvt_pk_bf16_f32 v44, v120, v121
    v_cvt_pk_bf16_f32 v45, v122, v123
    v_cvt_pk_bf16_f32 v46, v124, v125
    v_cvt_pk_bf16_f32 v47, v126, v127
    ds_write_b128 v163, v[44:47] offset:3072
    v_pk_mul_f32 v[128:129], v[128:129], s[32:33]
    v_pk_mul_f32 v[130:131], v[130:131], s[32:33]
    v_pk_mul_f32 v[132:133], v[132:133], s[32:33]
    v_pk_mul_f32 v[134:135], v[134:135], s[32:33]
    v_cvt_pk_bf16_f32 v16, v128, v129
    v_cvt_pk_bf16_f32 v17, v130, v131
    v_cvt_pk_bf16_f32 v18, v132, v133
    v_cvt_pk_bf16_f32 v19, v134, v135
    ds_write_b128 v164, v[16:19] offset:2048
    v_pk_mul_f32 v[136:137], v[136:137], s[32:33]
    v_pk_mul_f32 v[138:139], v[138:139], s[32:33]
    v_pk_mul_f32 v[140:141], v[140:141], s[32:33]
    v_pk_mul_f32 v[142:143], v[142:143], s[32:33]
    v_cvt_pk_bf16_f32 v20, v136, v137
    v_cvt_pk_bf16_f32 v21, v138, v139
    v_cvt_pk_bf16_f32 v22, v140, v141
    v_cvt_pk_bf16_f32 v23, v142, v143
    ds_write_b128 v164, v[20:23] offset:3072
    v_pk_mul_f32 v[144:145], v[144:145], s[32:33]
    v_pk_mul_f32 v[146:147], v[146:147], s[32:33]
    v_pk_mul_f32 v[148:149], v[148:149], s[32:33]
    v_pk_mul_f32 v[150:151], v[150:151], s[32:33]
    v_cvt_pk_bf16_f32 v24, v144, v145
    v_cvt_pk_bf16_f32 v25, v146, v147
    v_cvt_pk_bf16_f32 v26, v148, v149
    v_cvt_pk_bf16_f32 v27, v150, v151
    ds_write_b128 v165, v[24:27] offset:2048
    v_pk_mul_f32 v[152:153], v[152:153], s[32:33]
    v_pk_mul_f32 v[154:155], v[154:155], s[32:33]
    v_pk_mul_f32 v[156:157], v[156:157], s[32:33]
    v_pk_mul_f32 v[158:159], v[158:159], s[32:33]
    v_cvt_pk_bf16_f32 v28, v152, v153
    v_cvt_pk_bf16_f32 v29, v154, v155
    v_cvt_pk_bf16_f32 v30, v156, v157
    v_cvt_pk_bf16_f32 v31, v158, v159
    ds_write_b128 v165, v[28:31] offset:3072
    s_waitcnt vmcnt(0)
    v_readfirstlane_b32 s36, v166
    v_readfirstlane_b32 s37, v167
    s_mov_b32 s38, 65536
    s_waitcnt lgkmcnt(0)
    s_nop 2
L_nonce:
    s_cmp_lg_u32 s36, 0
    s_cbranch_scc1 L_nonced
    buffer_load_dwordx2 v[166:167], off, s[68:71], 0 sc0 sc1
    s_waitcnt vmcnt(0)
    v_readfirstlane_b32 s36, v166
    v_readfirstlane_b32 s37, v167
    s_sub_u32 s38, s38, 1
    s_nop 3
    s_cbranch_scc0 L_nonce
L_nonced:
    s_barrier
    s_cmp_lg_u32 s3, 0
    s_cbranch_scc1 L_slow_n
    ds_read_b128 v[16:19], v3 offset:0
    ds_read_b128 v[48:51], v4 offset:0
    ds_read_b128 v[20:23], v3 offset:1024
    ds_read_b128 v[52:55], v5 offset:0
    ds_read_b128 v[24:27], v3 offset:2048
    ds_read_b128 v[56:59], v6 offset:0
    ds_read_b128 v[28:31], v3 offset:3072
    ds_read_b128 v[60:63], v7 offset:0
    ds_read_b128 v[32:35], v3 offset:4096
    ds_read_b128 v[64:67], v4 offset:8192
    ds_read_b128 v[36:39], v3 offset:5120
    ds_read_b128 v[68:71], v5 offset:8192
    ds_read_b128 v[40:43], v3 offset:6144
    ds_read_b128 v[72:75], v6 offset:8192
    ds_read_b128 v[44:47], v3 offset:7168
    ds_read_b128 v[76:79], v7 offset:8192
    v_mov_b32 v12, 0
    v_mov_b32 v13, 0
    s_setprio 1
    s_waitcnt lgkmcnt(14)
    v_mfma_f32_32x32x16_bf16 v[80:95], v[48:51], v[16:19], 0
    ds_read_b64_tr_b16 v[48:49], v8 offset:0
    ds_read_b64_tr_b16 v[50:51], v8 offset:2048
    s_waitcnt lgkmcnt(14)
    v_mfma_f32_32x32x16_bf16 v[80:95], v[52:55], v[20:23], v[80:95]
    ds_read_b64_tr_b16 v[52:53], v9 offset:0
    ds_read_b64_tr_b16 v[54:55], v9 offset:2048
    s_waitcnt lgkmcnt(14)
    v_mfma_f32_32x32x16_bf16 v[80:95], v[56:59], v[24:27], v[80:95]
    ds_read_b64_tr_b16 v[56:57], v10 offset:0
    ds_read_b64_tr_b16 v[58:59], v10 offset:2048
    s_waitcnt lgkmcnt(14)
    v_mfma_f32_32x32x16_bf16 v[80:95], v[60:63], v[28:31], v[80:95]
    ds_read_b64_tr_b16 v[60:61], v11 offset:0
    ds_read_b64_tr_b16 v[62:63], v11 offset:2048
    s_waitcnt lgkmcnt(14)
    v_mfma_f32_32x32x16_bf16 v[80:95], v[64:67], v[32:35], v[80:95]
    ds_read_b64_tr_b16 v[64:65], v8 offset:4096
    ds_read_b64_tr_b16 v[66:67], v8 offset:6144
    s_waitcnt lgkmcnt(14)
    v_mfma_f32_32x32x16_bf16 v[80:95], v[68:71], v[36:39], v[80:95]
    ds_read_b64_tr_b16 v[68:69], v9 offset:4096
    ds_read_b64_tr_b16 v[70:71], v9 offset:6144
    s_waitcnt lgkmcnt(14)
    v_mfma_f32_32x32x16_bf16 v[80:95], v[72:75], v[40:43], v[80:95]
    ds_read_b64_tr_b16 v[72:73], v10 offset:4096
    ds_read_b64_tr_b16 v[74:75], v10 offset:6144
    s_waitcnt lgkmcnt(14)
    v_mfma_f32_32x32x16_bf16 v[80:95], v[76:79], v[44:47], v[80:95]
    ds_read_b64_tr_b16 v[76:77], v11 offset:4096
    ds_read_b64_tr_b16 v[78:79], v11 offset:6144
    s_setprio 0
    s_nop 8
    v_exp_f32 v80, v80
    v_exp_f32 v81, v81
    v_exp_f32 v82, v82
    v_exp_f32 v83, v83
    v_exp_f32 v84, v84
    v_exp_f32 v85, v85
    v_exp_f32 v86, v86
    v_exp_f32 v87, v87
    v_add_f32 v12, v12, v80
    v_add_f32 v13, v13, v81
    v_add_f32 v12, v12, v82
    v_add_f32 v13, v13, v83
    v_add_f32 v12, v12, v84
    v_add_f32 v13, v13, v85
    v_add_f32 v12, v12, v86
    v_add_f32 v13, v13, v87
    v_cvt_pk_bf16_f32 v80, v80, v81
    v_cvt_pk_bf16_f32 v81, v82, v83
    v_cvt_pk_bf16_f32 v82, v84, v85
    v_cvt_pk_bf16_f32 v83, v86, v87
    v_exp_f32 v88, v88
    v_exp_f32 v89, v89
    s_waitcnt lgkmcnt(14)
    v_mfma_f32_32x32x16_bf16 v[96:111], v[48:51], v[80:83], 0
    v_add_f32 v12, v12, v88
    v_add_f32 v13, v13, v89
    v_cvt_pk_bf16_f32 v88, v88, v89
    v_exp_f32 v90, v90
    v_exp_f32 v91, v91
    s_waitcnt lgkmcnt(12)
    v_mfma_f32_32x32x16_bf16 v[112:127], v[52:55], v[80:83], 0
    v_add_f32 v12, v12, v90
    v_add_f32 v13, v13, v91
    v_cvt_pk_bf16_f32 v89, v90, v91
    v_exp_f32 v92, v92
    v_exp_f32 v93, v93
    s_waitcnt lgkmcnt(10)
    v_mfma_f32_32x32x16_bf16 v[128:143], v[56:59], v[80:83], 0
    v_add_f32 v12, v12, v92
    v_add_f32 v13, v13, v93
    v_cvt_pk_bf16_f32 v90, v92, v93
    v_exp_f32 v94, v94
    v_exp_f32 v95, v95
    s_waitcnt lgkmcnt(8)
    v_mfma_f32_32x32x16_bf16 v[144:159], v[60:63], v[80:83], 0
    v_add_f32 v12, v12, v94
    v_add_f32 v13, v13, v95
    v_cvt_pk_bf16_f32 v91, v94, v95
    s_waitcnt lgkmcnt(6)
    s_nop 0
    v_mfma_f32_32x32x16_bf16 v[96:111], v[64:67], v[88:91], v[96:111]
    s_waitcnt lgkmcnt(4)
    v_mfma_f32_32x32x16_bf16 v[112:127], v[68:71], v[88:91], v[112:127]
    s_waitcnt lgkmcnt(0)
    s_barrier
    ds_read_b128 v[48:51], v4 offset:40960
    ds_read_b128 v[52:55], v5 offset:40960
    ds_read_b128 v[56:59], v6 offset:40960
    ds_read_b128 v[60:63], v7 offset:40960
    ds_read_b128 v[64:67], v4 offset:49152
    ds_read_b128 v[68:71], v5 offset:49152
    v_mfma_f32_32x32x16_bf16 v[128:143], v[72:75], v[88:91], v[128:143]
    ds_read_b128 v[72:75], v6 offset:49152
    v_mfma_f32_32x32x16_bf16 v[144:159], v[76:79], v[88:91], v[144:159]
    ds_read_b128 v[76:79], v7 offset:49152
    s_setprio 1
    s_waitcnt lgkmcnt(7)
    v_mfma_f32_32x32x16_bf16 v[80:95], v[48:51], v[16:19], 0
    ds_read_b64_tr_b16 v[48:49], v8 offset:40960
    ds_read_b64_tr_b16 v[50:51], v8 offset:43008
    s_waitcnt lgkmcnt(8)
    v_mfma_f32_32x32x16_bf16 v[80:95], v[52:55], v[20:23], v[80:95]
    ds_read_b64_tr_b16 v[52:53], v9 offset:40960
    ds_read_b64_tr_b16 v[54:55], v9 offset:43008
    s_waitcnt lgkmcnt(9)
    v_mfma_f32_32x32x16_bf16 v[80:95], v[56:59], v[24:27], v[80:95]
    ds_read_b64_tr_b16 v[56:57], v10 offset:40960
    ds_read_b64_tr_b16 v[58:59], v10 offset:43008
    s_waitcnt lgkmcnt(10)
    v_mfma_f32_32x32x16_bf16 v[80:95], v[60:63], v[28:31], v[80:95]
    ds_read_b64_tr_b16 v[60:61], v11 offset:40960
    ds_read_b64_tr_b16 v[62:63], v11 offset:43008
    s_waitcnt lgkmcnt(11)
    v_mfma_f32_32x32x16_bf16 v[80:95], v[64:67], v[32:35], v[80:95]
    ds_read_b64_tr_b16 v[64:65], v8 offset:45056
    ds_read_b64_tr_b16 v[66:67], v8 offset:47104
    s_waitcnt lgkmcnt(12)
    v_mfma_f32_32x32x16_bf16 v[80:95], v[68:71], v[36:39], v[80:95]
    ds_read_b64_tr_b16 v[68:69], v9 offset:45056
    ds_read_b64_tr_b16 v[70:71], v9 offset:47104
    s_waitcnt lgkmcnt(13)
    v_mfma_f32_32x32x16_bf16 v[80:95], v[72:75], v[40:43], v[80:95]
    ds_read_b64_tr_b16 v[72:73], v10 offset:45056
    ds_read_b64_tr_b16 v[74:75], v10 offset:47104
    s_waitcnt lgkmcnt(14)
    v_mfma_f32_32x32x16_bf16 v[80:95], v[76:79], v[44:47], v[80:95]
    ds_read_b64_tr_b16 v[76:77], v11 offset:45056
    ds_read_b64_tr_b16 v[78:79], v11 offset:47104
    s_setprio 0
    v_add_u32 v4, 73728, v4
    v_add_u32 v5, 73728, v5
    v_add_u32 v6, 73728, v6
    v_add_u32 v7, 73728, v7
    v_add_u32 v8, 73728, v8
    v_add_u32 v9, 73728, v9
    v_add_u32 v10, 73728, v10
    v_add_u32 v11, 73728, v11
    s_nop 0
    v_exp_f32 v80, v80
    v_exp_f32 v81, v81
    v_exp_f32 v82, v82
    v_exp_f32 v83, v83
    v_exp_f32 v84, v84
    v_exp_f32 v85, v85
    v_exp_f32 v86, v86
    v_exp_f32 v87, v87
    v_add_f32 v12, v12, v80
    v_add_f32 v13, v13, v81
    v_add_f32 v12, v12, v82
    v_add_f32 v13, v13, v83
    v_add_f32 v12, v12, v84
    v_add_f32 v13, v13, v85
    v_add_f32 v12, v12, v86
    v_add_f32 v13, v13, v87
    v_cvt_pk_bf16_f32 v80, v80, v81
    v_cvt_pk_bf16_f32 v81, v82, v83
    v_cvt_pk_bf16_f32 v82, v84, v85
    v_cvt_pk_bf16_f32 v83, v86, v87
    v_exp_f32 v88, v88
    v_exp_f32 v89, v89
    s_waitcnt lgkmcnt(14)
    v_mfma_f32_32x32x16_bf16 v[96:111], v[48:51], v[80:83], v[96:111]
    v_add_f32 v12, v12, v88
    v_add_f32 v13, v13, v89
    v_cvt_pk_bf16_f32 v88, v88, v89
    v_exp_f32 v90, v90
    v_exp_f32 v91, v91
    s_waitcnt lgkmcnt(12)
    v_mfma_f32_32x32x16_bf16 v[112:127], v[52:55], v[80:83], v[112:127]
    v_add_f32 v12, v12, v90
    v_add_f32 v13, v13, v91
    v_cvt_pk_bf16_f32 v89, v90, v91
    v_exp_f32 v92, v92
    v_exp_f32 v93, v93
    s_waitcnt lgkmcnt(10)
    v_mfma_f32_32x32x16_bf16 v[128:143], v[56:59], v[80:83], v[128:143]
    v_add_f32 v12, v12, v92
    v_add_f32 v13, v13, v93
    v_cvt_pk_bf16_f32 v90, v92, v93
    v_exp_f32 v94, v94
    v_exp_f32 v95, v95
    s_waitcnt lgkmcnt(8)
    v_mfma_f32_32x32x16_bf16 v[144:159], v[60:63], v[80:83], v[144:159]
    v_add_f32 v12, v12, v94
    v_add_f32 v13, v13, v95
    v_cvt_pk_bf16_f32 v91, v94, v95
    s_waitcnt lgkmcnt(6)
    s_nop 0
    v_mfma_f32_32x32x16_bf16 v[96:111], v[64:67], v[88:91], v[96:111]
    s_waitcnt lgkmcnt(4)
    v_mfma_f32_32x32x16_bf16 v[112:127], v[68:71], v[88:91], v[112:127]
    s_waitcnt lgkmcnt(0)
    s_barrier
    ds_read_b128 v[48:51], v4 offset:40960
    ds_read_b128 v[52:55], v5 offset:40960
    ds_read_b128 v[56:59], v6 offset:40960
    ds_read_b128 v[60:63], v7 offset:40960
    ds_read_b128 v[64:67], v4 offset:49152
    ds_read_b128 v[68:71], v5 offset:49152
    v_mfma_f32_32x32x16_bf16 v[128:143], v[72:75], v[88:91], v[128:143]
    ds_read_b128 v[72:75], v6 offset:49152
    v_mfma_f32_32x32x16_bf16 v[144:159], v[76:79], v[88:91], v[144:159]
    ds_read_b128 v[76:79], v7 offset:49152
    s_setprio 1
    s_waitcnt lgkmcnt(7)
    v_mfma_f32_32x32x16_bf16 v[80:95], v[48:51], v[16:19], 0
    ds_read_b64_tr_b16 v[48:49], v8 offset:40960
    ds_read_b64_tr_b16 v[50:51], v8 offset:43008
    s_waitcnt lgkmcnt(8)
    v_mfma_f32_32x32x16_bf16 v[80:95], v[52:55], v[20:23], v[80:95]
    ds_read_b64_tr_b16 v[52:53], v9 offset:40960
    ds_read_b64_tr_b16 v[54:55], v9 offset:43008
    s_waitcnt lgkmcnt(9)
    v_mfma_f32_32x32x16_bf16 v[80:95], v[56:59], v[24:27], v[80:95]
    ds_read_b64_tr_b16 v[56:57], v10 offset:40960
    ds_read_b64_tr_b16 v[58:59], v10 offset:43008
    s_waitcnt lgkmcnt(10)
    v_mfma_f32_32x32x16_bf16 v[80:95], v[60:63], v[28:31], v[80:95]
    ds_read_b64_tr_b16 v[60:61], v11 offset:40960
    ds_read_b64_tr_b16 v[62:63], v11 offset:43008
    s_waitcnt lgkmcnt(11)
    v_mfma_f32_32x32x16_bf16 v[80:95], v[64:67], v[32:35], v[80:95]
    ds_read_b64_tr_b16 v[64:65], v8 offset:45056
    ds_read_b64_tr_b16 v[66:67], v8 offset:47104
    s_waitcnt lgkmcnt(12)
    v_mfma_f32_32x32x16_bf16 v[80:95], v[68:71], v[36:39], v[80:95]
    ds_read_b64_tr_b16 v[68:69], v9 offset:45056
    ds_read_b64_tr_b16 v[70:71], v9 offset:47104
    s_waitcnt lgkmcnt(13)
    v_mfma_f32_32x32x16_bf16 v[80:95], v[72:75], v[40:43], v[80:95]
    ds_read_b64_tr_b16 v[72:73], v10 offset:45056
    ds_read_b64_tr_b16 v[74:75], v10 offset:47104
    s_waitcnt lgkmcnt(14)
    v_mfma_f32_32x32x16_bf16 v[80:95], v[76:79], v[44:47], v[80:95]
    ds_read_b64_tr_b16 v[76:77], v11 offset:45056
    ds_read_b64_tr_b16 v[78:79], v11 offset:47104
    s_setprio 0
    s_nop 8
    v_exp_f32 v80, v80
    v_exp_f32 v81, v81
    v_exp_f32 v82, v82
    v_exp_f32 v83, v83
    v_exp_f32 v84, v84
    v_exp_f32 v85, v85
    v_exp_f32 v86, v86
    v_exp_f32 v87, v87
    v_add_f32 v12, v12, v80
    v_add_f32 v13, v13, v81
    v_add_f32 v12, v12, v82
    v_add_f32 v13, v13, v83
    v_add_f32 v12, v12, v84
    v_add_f32 v13, v13, v85
    v_add_f32 v12, v12, v86
    v_add_f32 v13, v13, v87
    v_cvt_pk_bf16_f32 v80, v80, v81
    v_cvt_pk_bf16_f32 v81, v82, v83
    v_cvt_pk_bf16_f32 v82, v84, v85
    v_cvt_pk_bf16_f32 v83, v86, v87
    v_exp_f32 v88, v88
    v_exp_f32 v89, v89
    s_waitcnt lgkmcnt(14)
    v_mfma_f32_32x32x16_bf16 v[96:111], v[48:51], v[80:83], v[96:111]
    v_add_f32 v12, v12, v88
    v_add_f32 v13, v13, v89
    v_cvt_pk_bf16_f32 v88, v88, v89
    v_exp_f32 v90, v90
    v_exp_f32 v91, v91
    s_waitcnt lgkmcnt(12)
    v_mfma_f32_32x32x16_bf16 v[112:127], v[52:55], v[80:83], v[112:127]
    v_add_f32 v12, v12, v90
    v_add_f32 v13, v13, v91
    v_cvt_pk_bf16_f32 v89, v90, v91
    v_exp_f32 v92, v92
    v_exp_f32 v93, v93
    s_waitcnt lgkmcnt(10)
    v_mfma_f32_32x32x16_bf16 v[128:143], v[56:59], v[80:83], v[128:143]
    v_add_f32 v12, v12, v92
    v_add_f32 v13, v13, v93
    v_cvt_pk_bf16_f32 v90, v92, v93
    v_exp_f32 v94, v94
    v_exp_f32 v95, v95
    s_waitcnt lgkmcnt(8)
    v_mfma_f32_32x32x16_bf16 v[144:159], v[60:63], v[80:83], v[144:159]
    v_add_f32 v12, v12, v94
    v_add_f32 v13, v13, v95
    v_cvt_pk_bf16_f32 v91, v94, v95
    s_waitcnt lgkmcnt(6)
    s_nop 0
    v_mfma_f32_32x32x16_bf16 v[96:111], v[64:67], v[88:91], v[96:111]
    s_waitcnt lgkmcnt(4)
    v_mfma_f32_32x32x16_bf16 v[112:127], v[68:71], v[88:91], v[112:127]
    s_waitcnt lgkmcnt(0)
    s_barrier
    ds_read_b128 v[48:51], v4 offset:0
    ds_read_b128 v[52:55], v5 offset:0
    ds_read_b128 v[56:59], v6 offset:0
    ds_read_b128 v[60:63], v7 offset:0
    ds_read_b128 v[64:67], v4 offset:8192
    ds_read_b128 v[68:71], v5 offset:8192
    v_mfma_f32_32x32x16_bf16 v[128:143], v[72:75], v[88:91], v[128:143]
    ds_read_b128 v[72:75], v6 offset:8192
    v_mfma_f32_32x32x16_bf16 v[144:159], v[76:79], v[88:91], v[144:159]
    ds_read_b128 v[76:79], v7 offset:8192
    s_setprio 1
    s_waitcnt lgkmcnt(7)
    v_mfma_f32_32x32x16_bf16 v[80:95], v[48:51], v[16:19], 0
    ds_read_b64_tr_b16 v[48:49], v8 offset:0
    ds_read_b64_tr_b16 v[50:51], v8 offset:2048
    s_waitcnt lgkmcnt(8)
    v_mfma_f32_32x32x16_bf16 v[80:95], v[52:55], v[20:23], v[80:95]
    ds_read_b64_tr_b16 v[52:53], v9 offset:0
    ds_read_b64_tr_b16 v[54:55], v9 offset:2048
    s_waitcnt lgkmcnt(9)
    v_mfma_f32_32x32x16_bf16 v[80:95], v[56:59], v[24:27], v[80:95]
    ds_read_b64_tr_b16 v[56:57], v10 offset:0
    ds_read_b64_tr_b16 v[58:59], v10 offset:2048
    s_waitcnt lgkmcnt(10)
    v_mfma_f32_32x32x16_bf16 v[80:95], v[60:63], v[28:31], v[80:95]
    ds_read_b64_tr_b16 v[60:61], v11 offset:0
    ds_read_b64_tr_b16 v[62:63], v11 offset:2048
    s_waitcnt lgkmcnt(11)
    v_mfma_f32_32x32x16_bf16 v[80:95], v[64:67], v[32:35], v[80:95]
    ds_read_b64_tr_b16 v[64:65], v8 offset:4096
    ds_read_b64_tr_b16 v[66:67], v8 offset:6144
    s_waitcnt lgkmcnt(12)
    v_mfma_f32_32x32x16_bf16 v[80:95], v[68:71], v[36:39], v[80:95]
    ds_read_b64_tr_b16 v[68:69], v9 offset:4096
    ds_read_b64_tr_b16 v[70:71], v9 offset:6144
    s_waitcnt lgkmcnt(13)
    v_mfma_f32_32x32x16_bf16 v[80:95], v[72:75], v[40:43], v[80:95]
    ds_read_b64_tr_b16 v[72:73], v10 offset:4096
    ds_read_b64_tr_b16 v[74:75], v10 offset:6144
    s_waitcnt lgkmcnt(14)
    v_mfma_f32_32x32x16_bf16 v[80:95], v[76:79], v[44:47], v[80:95]
    ds_read_b64_tr_b16 v[76:77], v11 offset:4096
    ds_read_b64_tr_b16 v[78:79], v11 offset:6144
    s_setprio 0
    v_subrev_u32 v4, 73728, v4
    v_subrev_u32 v5, 73728, v5
    v_subrev_u32 v6, 73728, v6
    v_subrev_u32 v7, 73728, v7
    v_subrev_u32 v8, 73728, v8
    v_subrev_u32 v9, 73728, v9
    v_subrev_u32 v10, 73728, v10
    v_subrev_u32 v11, 73728, v11
    s_nop 0
    v_exp_f32 v80, v80
    v_exp_f32 v81, v81
    v_exp_f32 v82, v82
    v_exp_f32 v83, v83
    v_exp_f32 v84, v84
    v_exp_f32 v85, v85
    v_exp_f32 v86, v86
    v_exp_f32 v87, v87
    v_add_f32 v12, v12, v80
    v_add_f32 v13, v13, v81
    v_add_f32 v12, v12, v82
    v_add_f32 v13, v13, v83
    v_add_f32 v12, v12, v84
    v_add_f32 v13, v13, v85
    v_add_f32 v12, v12, v86
    v_add_f32 v13, v13, v87
    v_cvt_pk_bf16_f32 v80, v80, v81
    v_cvt_pk_bf16_f32 v81, v82, v83
    v_cvt_pk_bf16_f32 v82, v84, v85
    v_cvt_pk_bf16_f32 v83, v86, v87
    v_exp_f32 v88, v88
    v_exp_f32 v89, v89
    s_waitcnt lgkmcnt(14)
    v_mfma_f32_32x32x16_bf16 v[96:111], v[48:51], v[80:83], v[96:111]
    v_add_f32 v12, v12, v88
    v_add_f32 v13, v13, v89
    v_cvt_pk_bf16_f32 v88, v88, v89
    v_exp_f32 v90, v90
    v_exp_f32 v91, v91
    s_waitcnt lgkmcnt(12)
    v_mfma_f32_32x32x16_bf16 v[112:127], v[52:55], v[80:83], v[112:127]
    v_add_f32 v12, v12, v90
    v_add_f32 v13, v13, v91
    v_cvt_pk_bf16_f32 v89, v90, v91
    v_exp_f32 v92, v92
    v_exp_f32 v93, v93
    s_waitcnt lgkmcnt(10)
    v_mfma_f32_32x32x16_bf16 v[128:143], v[56:59], v[80:83], v[128:143]
    v_add_f32 v12, v12, v92
    v_add_f32 v13, v13, v93
    v_cvt_pk_bf16_f32 v90, v92, v93
    v_exp_f32 v94, v94
    v_exp_f32 v95, v95
    s_waitcnt lgkmcnt(8)
    v_mfma_f32_32x32x16_bf16 v[144:159], v[60:63], v[80:83], v[144:159]
    v_add_f32 v12, v12, v94
    v_add_f32 v13, v13, v95
    v_cvt_pk_bf16_f32 v91, v94, v95
    s_waitcnt lgkmcnt(6)
    s_nop 0
    v_mfma_f32_32x32x16_bf16 v[96:111], v[64:67], v[88:91], v[96:111]
    s_waitcnt lgkmcnt(4)
    v_mfma_f32_32x32x16_bf16 v[112:127], v[68:71], v[88:91], v[112:127]
    s_waitcnt lgkmcnt(0)
    s_barrier
    ds_read_b128 v[48:51], v4 offset:0
    ds_read_b128 v[52:55], v5 offset:0
    ds_read_b128 v[56:59], v6 offset:0
    ds_read_b128 v[60:63], v7 offset:0
    ds_read_b128 v[64:67], v4 offset:8192
    ds_read_b128 v[68:71], v5 offset:8192
    v_mfma_f32_32x32x16_bf16 v[128:143], v[72:75], v[88:91], v[128:143]
    ds_read_b128 v[72:75], v6 offset:8192
    v_mfma_f32_32x32x16_bf16 v[144:159], v[76:79], v[88:91], v[144:159]
    ds_read_b128 v[76:79], v7 offset:8192
    s_setprio 1
    s_waitcnt lgkmcnt(7)
    v_mfma_f32_32x32x16_bf16 v[80:95], v[48:51], v[16:19], 0
    ds_read_b64_tr_b16 v[48:49], v8 offset:0
    ds_read_b64_tr_b16 v[50:51], v8 offset:2048
    s_waitcnt lgkmcnt(8)
    v_mfma_f32_32x32x16_bf16 v[80:95], v[52:55], v[20:23], v[80:95]
    ds_read_b64_tr_b16 v[52:53], v9 offset:0
    ds_read_b64_tr_b16 v[54:55], v9 offset:2048
    s_waitcnt lgkmcnt(9)
    v_mfma_f32_32x32x16_bf16 v[80:95], v[56:59], v[24:27], v[80:95]
    ds_read_b64_tr_b16 v[56:57], v10 offset:0
    ds_read_b64_tr_b16 v[58:59], v10 offset:2048
    s_waitcnt lgkmcnt(10)
    v_mfma_f32_32x32x16_bf16 v[80:95], v[60:63], v[28:31], v[80:95]
    ds_read_b64_tr_b16 v[60:61], v11 offset:0
    ds_read_b64_tr_b16 v[62:63], v11 offset:2048
    s_waitcnt lgkmcnt(11)
    v_mfma_f32_32x32x16_bf16 v[80:95], v[64:67], v[32:35], v[80:95]
    ds_read_b64_tr_b16 v[64:65], v8 offset:4096
    ds_read_b64_tr_b16 v[66:67], v8 offset:6144
    s_waitcnt lgkmcnt(12)
    v_mfma_f32_32x32x16_bf16 v[80:95], v[68:71], v[36:39], v[80:95]
    ds_read_b64_tr_b16 v[68:69], v9 offset:4096
    ds_read_b64_tr_b16 v[70:71], v9 offset:6144
    s_waitcnt lgkmcnt(13)
    v_mfma_f32_32x32x16_bf16 v[80:95], v[72:75], v[40:43], v[80:95]
    ds_read_b64_tr_b16 v[72:73], v10 offset:4096
    ds_read_b64_tr_b16 v[74:75], v10 offset:6144
    s_waitcnt lgkmcnt(14)
    v_mfma_f32_32x32x16_bf16 v[80:95], v[76:79], v[44:47], v[80:95]
    ds_read_b64_tr_b16 v[76:77], v11 offset:4096
    ds_read_b64_tr_b16 v[78:79], v11 offset:6144
    s_setprio 0
    s_nop 8
    v_exp_f32 v80, v80
    v_exp_f32 v81, v81
    v_exp_f32 v82, v82
    v_exp_f32 v83, v83
    v_exp_f32 v84, v84
    v_exp_f32 v85, v85
    v_exp_f32 v86, v86
    v_exp_f32 v87, v87
    v_add_f32 v12, v12, v80
    v_add_f32 v13, v13, v81
    v_add_f32 v12, v12, v82
    v_add_f32 v13, v13, v83
    v_add_f32 v12, v12, v84
    v_add_f32 v13, v13, v85
    v_add_f32 v12, v12, v86
    v_add_f32 v13, v13, v87
    v_cvt_pk_bf16_f32 v80, v80, v81
    v_cvt_pk_bf16_f32 v81, v82, v83
    v_cvt_pk_bf16_f32 v82, v84, v85
    v_cvt_pk_bf16_f32 v83, v86, v87
    v_exp_f32 v88, v88
    v_exp_f32 v89, v89
    s_waitcnt lgkmcnt(14)
    v_mfma_f32_32x32x16_bf16 v[96:111], v[48:51], v[80:83], v[96:111]
    v_add_f32 v12, v12, v88
    v_add_f32 v13, v13, v89
    v_cvt_pk_bf16_f32 v88, v88, v89
    v_exp_f32 v90, v90
    v_exp_f32 v91, v91
    s_waitcnt lgkmcnt(12)
    v_mfma_f32_32x32x16_bf16 v[112:127], v[52:55], v[80:83], v[112:127]
    v_add_f32 v12, v12, v90
    v_add_f32 v13, v13, v91
    v_cvt_pk_bf16_f32 v89, v90, v91
    v_exp_f32 v92, v92
    v_exp_f32 v93, v93
    s_waitcnt lgkmcnt(10)
    v_mfma_f32_32x32x16_bf16 v[128:143], v[56:59], v[80:83], v[128:143]
    v_add_f32 v12, v12, v92
    v_add_f32 v13, v13, v93
    v_cvt_pk_bf16_f32 v90, v92, v93
    v_exp_f32 v94, v94
    v_exp_f32 v95, v95
    s_waitcnt lgkmcnt(8)
    v_mfma_f32_32x32x16_bf16 v[144:159], v[60:63], v[80:83], v[144:159]
    v_add_f32 v12, v12, v94
    v_add_f32 v13, v13, v95
    v_cvt_pk_bf16_f32 v91, v94, v95
    s_waitcnt lgkmcnt(6)
    s_nop 0
    v_mfma_f32_32x32x16_bf16 v[96:111], v[64:67], v[88:91], v[96:111]
    s_waitcnt lgkmcnt(4)
    v_mfma_f32_32x32x16_bf16 v[112:127], v[68:71], v[88:91], v[112:127]
    s_waitcnt lgkmcnt(0)
    s_barrier
    ds_read_b128 v[48:51], v4 offset:40960
    ds_read_b128 v[52:55], v5 offset:40960
    ds_read_b128 v[56:59], v6 offset:40960
    ds_read_b128 v[60:63], v7 offset:40960
    ds_read_b128 v[64:67], v4 offset:49152
    ds_read_b128 v[68:71], v5 offset:49152
    v_mfma_f32_32x32x16_bf16 v[128:143], v[72:75], v[88:91], v[128:143]
    ds_read_b128 v[72:75], v6 offset:49152
    v_mfma_f32_32x32x16_bf16 v[144:159], v[76:79], v[88:91], v[144:159]
    ds_read_b128 v[76:79], v7 offset:49152
    s_setprio 1
    s_waitcnt lgkmcnt(7)
    v_mfma_f32_32x32x16_bf16 v[80:95], v[48:51], v[16:19], 0
    ds_read_b64_tr_b16 v[48:49], v8 offset:40960
    ds_read_b64_tr_b16 v[50:51], v8 offset:43008
    s_waitcnt lgkmcnt(8)
    v_mfma_f32_32x32x16_bf16 v[80:95], v[52:55], v[20:23], v[80:95]
    ds_read_b64_tr_b16 v[52:53], v9 offset:40960
    ds_read_b64_tr_b16 v[54:55], v9 offset:43008
    s_waitcnt lgkmcnt(9)
    v_mfma_f32_32x32x16_bf16 v[80:95], v[56:59], v[24:27], v[80:95]
    ds_read_b64_tr_b16 v[56:57], v10 offset:40960
    ds_read_b64_tr_b16 v[58:59], v10 offset:43008
    s_waitcnt lgkmcnt(10)
    v_mfma_f32_32x32x16_bf16 v[80:95], v[60:63], v[28:31], v[80:95]
    ds_read_b64_tr_b16 v[60:61], v11 offset:40960
    ds_read_b64_tr_b16 v[62:63], v11 offset:43008
    s_waitcnt lgkmcnt(11)
    v_mfma_f32_32x32x16_bf16 v[80:95], v[64:67], v[32:35], v[80:95]
    ds_read_b64_tr_b16 v[64:65], v8 offset:45056
    ds_read_b64_tr_b16 v[66:67], v8 offset:47104
    s_waitcnt lgkmcnt(12)
    v_mfma_f32_32x32x16_bf16 v[80:95], v[68:71], v[36:39], v[80:95]
    ds_read_b64_tr_b16 v[68:69], v9 offset:45056
    ds_read_b64_tr_b16 v[70:71], v9 offset:47104
    s_waitcnt lgkmcnt(13)
    v_mfma_f32_32x32x16_bf16 v[80:95], v[72:75], v[40:43], v[80:95]
    ds_read_b64_tr_b16 v[72:73], v10 offset:45056
    ds_read_b64_tr_b16 v[74:75], v10 offset:47104
    s_waitcnt lgkmcnt(14)
    v_mfma_f32_32x32x16_bf16 v[80:95], v[76:79], v[44:47], v[80:95]
    ds_read_b64_tr_b16 v[76:77], v11 offset:45056
    ds_read_b64_tr_b16 v[78:79], v11 offset:47104
    s_setprio 0
    v_add_u32 v4, 73728, v4
    v_add_u32 v5, 73728, v5
    v_add_u32 v6, 73728, v6
    v_add_u32 v7, 73728, v7
    v_add_u32 v8, 73728, v8
    v_add_u32 v9, 73728, v9
    v_add_u32 v10, 73728, v10
    v_add_u32 v11, 73728, v11
    s_nop 0
    v_exp_f32 v80, v80
    v_exp_f32 v81, v81
    v_exp_f32 v82, v82
    v_exp_f32 v83, v83
    v_exp_f32 v84, v84
    v_exp_f32 v85, v85
    v_exp_f32 v86, v86
    v_exp_f32 v87, v87
    v_add_f32 v12, v12, v80
    v_add_f32 v13, v13, v81
    v_add_f32 v12, v12, v82
    v_add_f32 v13, v13, v83
    v_add_f32 v12, v12, v84
    v_add_f32 v13, v13, v85
    v_add_f32 v12, v12, v86
    v_add_f32 v13, v13, v87
    v_cvt_pk_bf16_f32 v80, v80, v81
    v_cvt_pk_bf16_f32 v81, v82, v83
    v_cvt_pk_bf16_f32 v82, v84, v85
    v_cvt_pk_bf16_f32 v83, v86, v87
    v_exp_f32 v88, v88
    v_exp_f32 v89, v89
    s_waitcnt lgkmcnt(14)
    v_mfma_f32_32x32x16_bf16 v[96:111], v[48:51], v[80:83], v[96:111]
    v_add_f32 v12, v12, v88
    v_add_f32 v13, v13, v89
    v_cvt_pk_bf16_f32 v88, v88, v89
    v_exp_f32 v90, v90
    v_exp_f32 v91, v91
    s_waitcnt lgkmcnt(12)
    v_mfma_f32_32x32x16_bf16 v[112:127], v[52:55], v[80:83], v[112:127]
    v_add_f32 v12, v12, v90
    v_add_f32 v13, v13, v91
    v_cvt_pk_bf16_f32 v89, v90, v91
    v_exp_f32 v92, v92
    v_exp_f32 v93, v93
    s_waitcnt lgkmcnt(10)
    v_mfma_f32_32x32x16_bf16 v[128:143], v[56:59], v[80:83], v[128:143]
    v_add_f32 v12, v12, v92
    v_add_f32 v13, v13, v93
    v_cvt_pk_bf16_f32 v90, v92, v93
    v_exp_f32 v94, v94
    v_exp_f32 v95, v95
    s_waitcnt lgkmcnt(8)
    v_mfma_f32_32x32x16_bf16 v[144:159], v[60:63], v[80:83], v[144:159]
    v_add_f32 v12, v12, v94
    v_add_f32 v13, v13, v95
    v_cvt_pk_bf16_f32 v91, v94, v95
    s_waitcnt lgkmcnt(6)
    s_nop 0
    v_mfma_f32_32x32x16_bf16 v[96:111], v[64:67], v[88:91], v[96:111]
    s_waitcnt lgkmcnt(4)
    v_mfma_f32_32x32x16_bf16 v[112:127], v[68:71], v[88:91], v[112:127]
    s_waitcnt lgkmcnt(0)
    s_barrier
    ds_read_b128 v[48:51], v4 offset:40960
    ds_read_b128 v[52:55], v5 offset:40960
    ds_read_b128 v[56:59], v6 offset:40960
    ds_read_b128 v[60:63], v7 offset:40960
    ds_read_b128 v[64:67], v4 offset:49152
    ds_read_b128 v[68:71], v5 offset:49152
    v_mfma_f32_32x32x16_bf16 v[128:143], v[72:75], v[88:91], v[128:143]
    ds_read_b128 v[72:75], v6 offset:49152
    v_mfma_f32_32x32x16_bf16 v[144:159], v[76:79], v[88:91], v[144:159]
    ds_read_b128 v[76:79], v7 offset:49152
    s_setprio 1
    s_waitcnt lgkmcnt(7)
    v_mfma_f32_32x32x16_bf16 v[80:95], v[48:51], v[16:19], 0
    ds_read_b64_tr_b16 v[48:49], v8 offset:40960
    ds_read_b64_tr_b16 v[50:51], v8 offset:43008
    s_waitcnt lgkmcnt(8)
    v_mfma_f32_32x32x16_bf16 v[80:95], v[52:55], v[20:23], v[80:95]
    ds_read_b64_tr_b16 v[52:53], v9 offset:40960
    ds_read_b64_tr_b16 v[54:55], v9 offset:43008
    s_add_u32 m0, s79, 0
    s_add_u32 s28, s72, 0
    buffer_load_dwordx4 v160, s[56:59], s28 offen lds
    s_waitcnt lgkmcnt(9)
    v_mfma_f32_32x32x16_bf16 v[80:95], v[56:59], v[24:27], v[80:95]
    ds_read_b64_tr_b16 v[56:57], v10 offset:40960
    ds_read_b64_tr_b16 v[58:59], v10 offset:43008
    s_waitcnt lgkmcnt(10)
    v_mfma_f32_32x32x16_bf16 v[80:95], v[60:63], v[28:31], v[80:95]
    ds_read_b64_tr_b16 v[60:61], v11 offset:40960
    ds_read_b64_tr_b16 v[62:63], v11 offset:43008
    s_waitcnt lgkmcnt(11)
    v_mfma_f32_32x32x16_bf16 v[80:95], v[64:67], v[32:35], v[80:95]
    ds_read_b64_tr_b16 v[64:65], v8 offset:45056
    ds_read_b64_tr_b16 v[66:67], v8 offset:47104
    s_waitcnt lgkmcnt(12)
    v_mfma_f32_32x32x16_bf16 v[80:95], v[68:71], v[36:39], v[80:95]
    ds_read_b64_tr_b16 v[68:69], v9 offset:45056
    ds_read_b64_tr_b16 v[70:71], v9 offset:47104
    s_waitcnt lgkmcnt(13)
    v_mfma_f32_32x32x16_bf16 v[80:95], v[72:75], v[40:43], v[80:95]
    ds_read_b64_tr_b16 v[72:73], v10 offset:45056
    ds_read_b64_tr_b16 v[74:75], v10 offset:47104
    s_add_u32 m0, s79, 1024
    s_add_u32 s28, s72, 0
    buffer_load_dwordx4 v161, s[56:59], s28 offen lds
    s_waitcnt lgkmcnt(14)
    v_mfma_f32_32x32x16_bf16 v[80:95], v[76:79], v[44:47], v[80:95]
    ds_read_b64_tr_b16 v[76:77], v11 offset:45056
    ds_read_b64_tr_b16 v[78:79], v11 offset:47104
    s_setprio 0
    s_nop 8
    v_exp_f32 v80, v80
    v_exp_f32 v81, v81
    v_exp_f32 v82, v82
    v_exp_f32 v83, v83
    v_exp_f32 v84, v84
    v_exp_f32 v85, v85
    v_exp_f32 v86, v86
    v_exp_f32 v87, v87
    v_add_f32 v12, v12, v80
    v_add_f32 v13, v13, v81
    v_add_f32 v12, v12, v82
    v_add_f32 v13, v13, v83
    v_add_f32 v12, v12, v84
    v_add_f32 v13, v13, v85
    v_add_f32 v12, v12, v86
    v_add_f32 v13, v13, v87
    v_cvt_pk_bf16_f32 v80, v80, v81
    v_cvt_pk_bf16_f32 v81, v82, v83
    v_cvt_pk_bf16_f32 v82, v84, v85
    v_cvt_pk_bf16_f32 v83, v86, v87
    v_exp_f32 v88, v88
    v_exp_f32 v89, v89
    s_waitcnt lgkmcnt(14)
    v_mfma_f32_32x32x16_bf16 v[96:111], v[48:51], v[80:83], v[96:111]
    v_add_f32 v12, v12, v88
    v_add_f32 v13, v13, v89
    v_cvt_pk_bf16_f32 v88, v88, v89
    v_exp_f32 v90, v90
    v_exp_f32 v91, v91
    s_waitcnt lgkmcnt(12)
    v_mfma_f32_32x32x16_bf16 v[112:127], v[52:55], v[80:83], v[112:127]
    v_add_f32 v12, v12, v90
    v_add_f32 v13, v13, v91
    v_cvt_pk_bf16_f32 v89, v90, v91
    v_exp_f32 v92, v92
    v_exp_f32 v93, v93
    s_waitcnt lgkmcnt(10)
    v_mfma_f32_32x32x16_bf16 v[128:143], v[56:59], v[80:83], v[128:143]
    v_add_f32 v12, v12, v92
    v_add_f32 v13, v13, v93
    v_cvt_pk_bf16_f32 v90, v92, v93
    v_exp_f32 v94, v94
    v_exp_f32 v95, v95
    s_waitcnt lgkmcnt(8)
    v_mfma_f32_32x32x16_bf16 v[144:159], v[60:63], v[80:83], v[144:159]
    v_add_f32 v12, v12, v94
    v_add_f32 v13, v13, v95
    v_cvt_pk_bf16_f32 v91, v94, v95
    s_waitcnt lgkmcnt(6)
    s_nop 0
    v_mfma_f32_32x32x16_bf16 v[96:111], v[64:67], v[88:91], v[96:111]
    s_waitcnt lgkmcnt(4)
    v_mfma_f32_32x32x16_bf16 v[112:127], v[68:71], v[88:91], v[112:127]
    s_waitcnt lgkmcnt(0)
    s_barrier
    ds_read_b128 v[48:51], v4 offset:0
    ds_read_b128 v[52:55], v5 offset:0
    ds_read_b128 v[56:59], v6 offset:0
    ds_read_b128 v[60:63], v7 offset:0
    ds_read_b128 v[64:67], v4 offset:8192
    ds_read_b128 v[68:71], v5 offset:8192
    v_mfma_f32_32x32x16_bf16 v[128:143], v[72:75], v[88:91], v[128:143]
    ds_read_b128 v[72:75], v6 offset:8192
    s_add_u32 m0, s79, 2048
    s_add_u32 s28, s72, 0
    buffer_load_dwordx4 v162, s[56:59], s28 offen lds
    v_mfma_f32_32x32x16_bf16 v[144:159], v[76:79], v[88:91], v[144:159]
    ds_read_b128 v[76:79], v7 offset:8192
    s_setprio 1
    s_waitcnt lgkmcnt(7)
    v_mfma_f32_32x32x16_bf16 v[80:95], v[48:51], v[16:19], 0
    ds_read_b64_tr_b16 v[48:49], v8 offset:0
    ds_read_b64_tr_b16 v[50:51], v8 offset:2048
    s_waitcnt lgkmcnt(8)
    v_mfma_f32_32x32x16_bf16 v[80:95], v[52:55], v[20:23], v[80:95]
    ds_read_b64_tr_b16 v[52:53], v9 offset:0
    ds_read_b64_tr_b16 v[54:55], v9 offset:2048
    s_add_u32 m0, s79, 36864
    s_add_u32 s28, s72, 73728
    buffer_load_dwordx4 v160, s[56:59], s28 offen lds
    s_waitcnt lgkmcnt(9)
    v_mfma_f32_32x32x16_bf16 v[80:95], v[56:59], v[24:27], v[80:95]
    ds_read_b64_tr_b16 v[56:57], v10 offset:0
    ds_read_b64_tr_b16 v[58:59], v10 offset:2048
    s_waitcnt lgkmcnt(10)
    v_mfma_f32_32x32x16_bf16 v[80:95], v[60:63], v[28:31], v[80:95]
    ds_read_b64_tr_b16 v[60:61], v11 offset:0
    ds_read_b64_tr_b16 v[62:63], v11 offset:2048
    s_waitcnt lgkmcnt(11)
    v_mfma_f32_32x32x16_bf16 v[80:95], v[64:67], v[32:35], v[80:95]
    ds_read_b64_tr_b16 v[64:65], v8 offset:4096
    ds_read_b64_tr_b16 v[66:67], v8 offset:6144
    s_add_u32 m0, s79, 37888
    s_add_u32 s28, s72, 73728
    buffer_load_dwordx4 v161, s[56:59], s28 offen lds
    s_waitcnt lgkmcnt(12)
    v_mfma_f32_32x32x16_bf16 v[80:95], v[68:71], v[36:39], v[80:95]
    ds_read_b64_tr_b16 v[68:69], v9 offset:4096
    ds_read_b64_tr_b16 v[70:71], v9 offset:6144
    s_waitcnt lgkmcnt(13)
    v_mfma_f32_32x32x16_bf16 v[80:95], v[72:75], v[40:43], v[80:95]
    ds_read_b64_tr_b16 v[72:73], v10 offset:4096
    ds_read_b64_tr_b16 v[74:75], v10 offset:6144
    s_waitcnt lgkmcnt(14)
    v_mfma_f32_32x32x16_bf16 v[80:95], v[76:79], v[44:47], v[80:95]
    ds_read_b64_tr_b16 v[76:77], v11 offset:4096
    ds_read_b64_tr_b16 v[78:79], v11 offset:6144
    s_add_u32 m0, s79, 38912
    s_add_u32 s28, s72, 73728
    buffer_load_dwordx4 v162, s[56:59], s28 offen lds
    s_setprio 0
    s_nop 5
    v_exp_f32 v80, v80
    v_exp_f32 v81, v81
    v_exp_f32 v82, v82
    v_exp_f32 v83, v83
    v_exp_f32 v84, v84
    v_exp_f32 v85, v85
    v_exp_f32 v86, v86
    v_exp_f32 v87, v87
    v_add_f32 v12, v12, v80
    v_add_f32 v13, v13, v81
    v_add_f32 v12, v12, v82
    v_add_f32 v13, v13, v83
    v_add_f32 v12, v12, v84
    v_add_f32 v13, v13, v85
    v_add_f32 v12, v12, v86
    v_add_f32 v13, v13, v87
    v_cvt_pk_bf16_f32 v80, v80, v81
    v_cvt_pk_bf16_f32 v81, v82, v83
    v_cvt_pk_bf16_f32 v82, v84, v85
    v_cvt_pk_bf16_f32 v83, v86, v87
    v_exp_f32 v88, v88
    v_exp_f32 v89, v89
    s_waitcnt lgkmcnt(14)
    v_mfma_f32_32x32x16_bf16 v[96:111], v[48:51], v[80:83], v[96:111]
    v_add_f32 v12, v12, v88
    v_add_f32 v13, v13, v89
    v_cvt_pk_bf16_f32 v88, v88, v89
    v_exp_f32 v90, v90
    v_exp_f32 v91, v91
    s_waitcnt lgkmcnt(12)
    v_mfma_f32_32x32x16_bf16 v[112:127], v[52:55], v[80:83], v[112:127]
    v_add_f32 v12, v12, v90
    v_add_f32 v13, v13, v91
    v_cvt_pk_bf16_f32 v89, v90, v91
    v_exp_f32 v92, v92
    v_exp_f32 v93, v93
    s_waitcnt lgkmcnt(10)
    v_mfma_f32_32x32x16_bf16 v[128:143], v[56:59], v[80:83], v[128:143]
    v_add_f32 v12, v12, v92
    v_add_f32 v13, v13, v93
    v_cvt_pk_bf16_f32 v90, v92, v93
    v_exp_f32 v94, v94
    v_exp_f32 v95, v95
    s_waitcnt lgkmcnt(8)
    v_mfma_f32_32x32x16_bf16 v[144:159], v[60:63], v[80:83], v[144:159]
    v_add_f32 v12, v12, v94
    v_add_f32 v13, v13, v95
    v_cvt_pk_bf16_f32 v91, v94, v95
    s_waitcnt lgkmcnt(6)
    s_nop 0
    v_mfma_f32_32x32x16_bf16 v[96:111], v[64:67], v[88:91], v[96:111]
    s_waitcnt lgkmcnt(4)
    v_mfma_f32_32x32x16_bf16 v[112:127], v[68:71], v[88:91], v[112:127]
    s_waitcnt lgkmcnt(2)
    v_mfma_f32_32x32x16_bf16 v[128:143], v[72:75], v[88:91], v[128:143]
    s_waitcnt lgkmcnt(0)
    v_mfma_f32_32x32x16_bf16 v[144:159], v[76:79], v[88:91], v[144:159]
    s_nop 11
L_fin:
    s_cmp_ge_u32 s30, 3
    s_cselect_b32 s25, 1, 0
    s_cselect_b32 s26, 3, 0
    s_sub_u32 s26, s30, s26
    s_lshl_b32 s26, s26, 11
    v_bfe_u32 v4, v0, 4, 1
    v_lshlrev_b32 v4, 10, v4
    v_lshrrev_b32 v5, 5, v0
    v_lshl_add_u32 v4, v5, 8, v4
    v_and_b32 v5, 15, v0
    v_lshl_add_u32 v4, v5, 4, v4
    v_add_u32 v4, s26, v4
    s_lshr_b32 s31, s21, 1
    s_xor_b32 s31, s31, s25
    s_mul_i32 s26, s31, 24576
    s_add_u32 s26, s26, 110592
    v_add_u32 v5, s26, v4
    s_lshl_b32 s26, s22, 5
    s_add_u32 s26, s26, s23
    s_mul_i32 s35, s26, 3072
    s_mul_i32 s39, s25, 1536
    s_add_u32 s35, s35, s39
    s_add_u32 s35, s35, 41943040
    s_mul_i32 s39, s25, 6
    s_sub_u32 s39, s24, s39
    s_lshl_b32 s39, s39, 8
    v_lshl_add_u32 v11, v0, 2, s39
    s_add_u32 s39, s39, s35
    s_sub_u32 s39, s39, 41943040
    s_lshr_b32 s39, s39, 1
    s_add_u32 s39, s39, 42991616
    s_lshl_b32 s26, s26, 2
    s_lshl_b32 s25, s25, 1
    s_add_u32 s26, s26, s25
    s_add_u32 s26, s26, s29
    s_mul_i32 s34, s26, 12288
    v_add_f32 v12, v12, v13
    s_lshl_b32 s25, s24, 8
    s_add_u32 s25, s25, 159744
    v_lshl_add_u32 v3, v0, 2, s25
    ds_write_b32 v3, v12
    s_mov_b32 s25, 0x30800000
    s_mov_b32 s26, 0x4d800000
    v_cmp_ge_f32 vcc, v12, s25
    v_cmp_le_f32 s[32:33], v12, s26
    s_and_b64 vcc, vcc, s[32:33]
    s_cmp_eq_u64 vcc, -1
    s_cselect_b32 s25, 0, 1
    s_cmp_eq_u32 s3, 0
    s_cselect_b32 s25, s25, 0
    s_lshl_b32 s26, s24, 2
    s_add_u32 s26, s26, 162816
    v_mov_b32 v6, s26
    v_mov_b32 v7, s25
    v_mov_b32 v8, s36
    v_mov_b32 v9, s37
    s_mov_b64 exec, 1
    ds_write_b32 v6, v7
    s_cmp_eq_u32 s24, 0
    s_cselect_b64 exec, 1, 0
    ds_write_b64 v6, v[8:9] offset:128
    s_mov_b64 exec, -1
    s_lshl_b32 s25, s30, 9
    s_add_u32 s25, s25, 159744
    v_and_b32 v3, 31, v0
    v_lshl_add_u32 v3, v3, 2, s25
    v_min_u32 v2, 11, v0
    v_lshlrev_b32 v2, 2, v2
    v_add_u32 v2, 162816, v2
    v_mov_b32 v1, 162944
    s_mov_b32 s32, 0x00003f80
    s_mov_b32 s33, 0x3f800000
    s_cmp_eq_u32 s29, 0
    s_cbranch_scc1 L_x_kh0
    v_cvt_pk_bf16_f32 v16, v96, v97
    v_cvt_pk_bf16_f32 v17, v98, v99
    v_cvt_pk_bf16_f32 v18, v100, v101
    v_cvt_pk_bf16_f32 v19, v102, v103
    ds_write_b128 v5, v[16:19] offset:0
    v_cvt_pk_bf16_f32 v20, v104, v105
    v_cvt_pk_bf16_f32 v21, v106, v107
    v_cvt_pk_bf16_f32 v22, v108, v109
    v_cvt_pk_bf16_f32 v23, v110, v111
    ds_write_b128 v5, v[20:23] offset:512
    v_cvt_pk_bf16_f32 v24, v112, v113
    v_cvt_pk_bf16_f32 v25, v114, v115
    v_cvt_pk_bf16_f32 v26, v116, v117
    v_cvt_pk_bf16_f32 v27, v118, v119
    ds_write_b128 v5, v[24:27] offset:6144
    v_cvt_pk_bf16_f32 v28, v120, v121
    v_cvt_pk_bf16_f32 v29, v122, v123
    v_cvt_pk_bf16_f32 v30, v124, v125
    v_cvt_pk_bf16_f32 v31, v126, v127
    ds_write_b128 v5, v[28:31] offset:6656
    s_waitcnt lgkmcnt(0)
    s_barrier
    ds_read_b32 v10, v2
    ds_read2_b32 v[6:7], v3 offset0:0 offset1:32
    ds_read2_b32 v[8:9], v3 offset0:64 offset1:96
    ds_read_b64 v[12:13], v1
    ds_read_b128 v[48:51], v5 offset:12288
    ds_read_b128 v[52:55], v5 offset:12800
    ds_read_b128 v[56:59], v5 offset:18432
    ds_read_b128 v[60:63], v5 offset:18944
    s_waitcnt lgkmcnt(7)
    v_cmp_ne_u32 vcc, 0, v10
    s_waitcnt lgkmcnt(6)
    v_add_f32 v6, v6, v7
    s_waitcnt lgkmcnt(5)
    v_add_f32 v8, v8, v9
    v_add_f32 v6, v6, v8
    v_rcp_f32 v6, v6
    s_waitcnt lgkmcnt(4)
    v_readfirstlane_b32 s36, v12
    s_waitcnt lgkmcnt(0)
    s_nop 3
    s_cbranch_vccnz L_restart
    v_mov_b32 v7, v6
    v_mov_b32 v13, v12
    v_dot2c_f32_bf16 v128, s32, v48
    v_dot2c_f32_bf16 v129, s33, v48
    v_dot2c_f32_bf16 v130, s32, v49
    v_dot2c_f32_bf16 v131, s33, v49
    v_dot2c_f32_bf16 v132, s32, v50
    v_dot2c_f32_bf16 v133, s33, v50
    v_dot2c_f32_bf16 v134, s32, v51
    v_dot2c_f32_bf16 v135, s33, v51
    v_dot2c_f32_bf16 v136, s32, v52
    v_dot2c_f32_bf16 v137, s33, v52
    v_dot2c_f32_bf16 v138, s32, v53
    v_dot2c_f32_bf16 v139, s33, v53
    v_dot2c_f32_bf16 v140, s32, v54
    v_dot2c_f32_bf16 v141, s33, v54
    v_dot2c_f32_bf16 v142, s32, v55
    v_dot2c_f32_bf16 v143, s33, v55
    v_dot2c_f32_bf16 v144, s32, v56
    v_dot2c_f32_bf16 v145, s33, v56
    v_dot2c_f32_bf16 v146, s32, v57
    v_dot2c_f32_bf16 v147, s33, v57
    v_dot2c_f32_bf16 v148, s32, v58
    v_dot2c_f32_bf16 v149, s33, v58
    v_dot2c_f32_bf16 v150, s32, v59
    v_dot2c_f32_bf16 v151, s33, v59
    v_dot2c_f32_bf16 v152, s32, v60
    v_dot2c_f32_bf16 v153, s33, v60
    v_dot2c_f32_bf16 v154, s32, v61
    v_dot2c_f32_bf16 v155, s33, v61
    v_dot2c_f32_bf16 v156, s32, v62
    v_dot2c_f32_bf16 v157, s33, v62
    v_dot2c_f32_bf16 v158, s32, v63
    v_dot2c_f32_bf16 v159, s33, v63
    v_pk_mul_f32 v[128:129], v[128:129], v[6:7]
    v_pk_mul_f32 v[130:131], v[130:131], v[6:7]
    v_pk_mul_f32 v[132:133], v[132:133], v[6:7]
    v_pk_mul_f32 v[134:135], v[134:135], v[6:7]
    v_cvt_pk_bf16_f32 v16, v128, v129
    v_cvt_pk_bf16_f32 v17, v130, v131
    v_cvt_pk_bf16_f32 v18, v132, v133
    v_cvt_pk_bf16_f32 v19, v134, v135
    ds_write_b128 v5, v[16:19] offset:12288
    s_add_u32 s28, s34, 0
    buffer_store_dwordx4 v[16:19], v4, s[60:63], s28 offen offset:0 sc1
    v_lshl_add_u32 v12, v16, 0, v12
    v_lshl_add_u32 v12, v17, 1, v12
    v_lshl_add_u32 v12, v18, 2, v12
    v_lshl_add_u32 v12, v19, 3, v12
    v_pk_mul_f32 v[136:137], v[136:137], v[6:7]
    v_pk_mul_f32 v[138:139], v[138:139], v[6:7]
    v_pk_mul_f32 v[140:141], v[140:141], v[6:7]
    v_pk_mul_f32 v[142:143], v[142:143], v[6:7]
    v_cvt_pk_bf16_f32 v20, v136, v137
    v_cvt_pk_bf16_f32 v21, v138, v139
    v_cvt_pk_bf16_f32 v22, v140, v141
    v_cvt_pk_bf16_f32 v23, v142, v143
    ds_write_b128 v5, v[20:23] offset:12800
    s_add_u32 s28, s34, 0
    buffer_store_dwordx4 v[20:23], v4, s[60:63], s28 offen offset:512 sc1
    v_lshl_add_u32 v12, v20, 0, v12
    v_lshl_add_u32 v12, v21, 1, v12
    v_lshl_add_u32 v12, v22, 2, v12
    v_lshl_add_u32 v12, v23, 3, v12
    v_pk_mul_f32 v[144:145], v[144:145], v[6:7]
    v_pk_mul_f32 v[146:147], v[146:147], v[6:7]
    v_pk_mul_f32 v[148:149], v[148:149], v[6:7]
    v_pk_mul_f32 v[150:151], v[150:151], v[6:7]
    v_cvt_pk_bf16_f32 v24, v144, v145
    v_cvt_pk_bf16_f32 v25, v146, v147
    v_cvt_pk_bf16_f32 v26, v148, v149
    v_cvt_pk_bf16_f32 v27, v150, v151
    ds_write_b128 v5, v[24:27] offset:18432
    s_add_u32 s28, s34, 6144
    buffer_store_dwordx4 v[24:27], v4, s[60:63], s28 offen offset:0 sc1
    v_lshl_add_u32 v12, v24, 0, v12
    v_lshl_add_u32 v12, v25, 1, v12
    v_lshl_add_u32 v12, v26, 2, v12
    v_lshl_add_u32 v12, v27, 3, v12
    v_pk_mul_f32 v[152:153], v[152:153], v[6:7]
    v_pk_mul_f32 v[154:155], v[154:155], v[6:7]
    v_pk_mul_f32 v[156:157], v[156:157], v[6:7]
    v_pk_mul_f32 v[158:159], v[158:159], v[6:7]
    v_cvt_pk_bf16_f32 v28, v152, v153
    v_cvt_pk_bf16_f32 v29, v154, v155
    v_cvt_pk_bf16_f32 v30, v156, v157
    v_cvt_pk_bf16_f32 v31, v158, v159
    ds_write_b128 v5, v[28:31] offset:18944
    s_add_u32 s28, s34, 6144
    buffer_store_dwordx4 v[28:31], v4, s[60:63], s28 offen offset:512 sc1
    v_lshl_add_u32 v12, v28, 0, v12
    v_lshl_add_u32 v12, v29, 1, v12
    v_lshl_add_u32 v12, v30, 2, v12
    v_lshl_add_u32 v12, v31, 3, v12
    buffer_store_dword v12, v11, s[60:63], s35 offen sc1
    s_nop 0
    s_branch L_x_done
L_x_kh0:
    v_cvt_pk_bf16_f32 v16, v128, v129
    v_cvt_pk_bf16_f32 v17, v130, v131
    v_cvt_pk_bf16_f32 v18, v132, v133
    v_cvt_pk_bf16_f32 v19, v134, v135
    ds_write_b128 v5, v[16:19] offset:12288
    v_cvt_pk_bf16_f32 v20, v136, v137
    v_cvt_pk_bf16_f32 v21, v138, v139
    v_cvt_pk_bf16_f32 v22, v140, v141
    v_cvt_pk_bf16_f32 v23, v142, v143
    ds_write_b128 v5, v[20:23] offset:12800
    v_cvt_pk_bf16_f32 v24, v144, v145
    v_cvt_pk_bf16_f32 v25, v146, v147
    v_cvt_pk_bf16_f32 v26, v148, v149
    v_cvt_pk_bf16_f32 v27, v150, v151
    ds_write_b128 v5, v[24:27] offset:18432
    v_cvt_pk_bf16_f32 v28, v152, v153
    v_cvt_pk_bf16_f32 v29, v154, v155
    v_cvt_pk_bf16_f32 v30, v156, v157
    v_cvt_pk_bf16_f32 v31, v158, v159
    ds_write_b128 v5, v[28:31] offset:18944
    s_waitcnt lgkmcnt(0)
    s_barrier
    ds_read_b32 v10, v2
    ds_read2_b32 v[6:7], v3 offset0:0 offset1:32
    ds_read2_b32 v[8:9], v3 offset0:64 offset1:96
    ds_read_b64 v[12:13], v1
    ds_read_b128 v[48:51], v5 offset:0
    ds_read_b128 v[52:55], v5 offset:512
    ds_read_b128 v[56:59], v5 offset:6144
    ds_read_b128 v[60:63], v5 offset:6656
    s_waitcnt lgkmcnt(7)
    v_cmp_ne_u32 vcc, 0, v10
    s_waitcnt lgkmcnt(6)
    v_add_f32 v6, v6, v7
    s_waitcnt lgkmcnt(5)
    v_add_f32 v8, v8, v9
    v_add_f32 v6, v6, v8
    v_rcp_f32 v6, v6
    s_waitcnt lgkmcnt(4)
    v_readfirstlane_b32 s36, v12
    s_waitcnt lgkmcnt(0)
    s_nop 3
    s_cbranch_vccnz L_restart
    v_mov_b32 v7, v6
    v_mov_b32 v13, v12
    v_dot2c_f32_bf16 v96, s32, v48
    v_dot2c_f32_bf16 v97, s33, v48
    v_dot2c_f32_bf16 v98, s32, v49
    v_dot2c_f32_bf16 v99, s33, v49
    v_dot2c_f32_bf16 v100, s32, v50
    v_dot2c_f32_bf16 v101, s33, v50
    v_dot2c_f32_bf16 v102, s32, v51
    v_dot2c_f32_bf16 v103, s33, v51
    v_dot2c_f32_bf16 v104, s32, v52
    v_dot2c_f32_bf16 v105, s33, v52
    v_dot2c_f32_bf16 v106, s32, v53
    v_dot2c_f32_bf16 v107, s33, v53
    v_dot2c_f32_bf16 v108, s32, v54
    v_dot2c_f32_bf16 v109, s33, v54
    v_dot2c_f32_bf16 v110, s32, v55
    v_dot2c_f32_bf16 v111, s33, v55
    v_dot2c_f32_bf16 v112, s32, v56
    v_dot2c_f32_bf16 v113, s33, v56
    v_dot2c_f32_bf16 v114, s32, v57
    v_dot2c_f32_bf16 v115, s33, v57
    v_dot2c_f32_bf16 v116, s32, v58
    v_dot2c_f32_bf16 v117, s33, v58
    v_dot2c_f32_bf16 v118, s32, v59
    v_dot2c_f32_bf16 v119, s33, v59
    v_dot2c_f32_bf16 v120, s32, v60
    v_dot2c_f32_bf16 v121, s33, v60
    v_dot2c_f32_bf16 v122, s32, v61
    v_dot2c_f32_bf16 v123, s33, v61
    v_dot2c_f32_bf16 v124, s32, v62
    v_dot2c_f32_bf16 v125, s33, v62
    v_dot2c_f32_bf16 v126, s32, v63
    v_dot2c_f32_bf16 v127, s33, v63
    v_pk_mul_f32 v[96:97], v[96:97], v[6:7]
    v_pk_mul_f32 v[98:99], v[98:99], v[6:7]
    v_pk_mul_f32 v[100:101], v[100:101], v[6:7]
    v_pk_mul_f32 v[102:103], v[102:103], v[6:7]
    v_cvt_pk_bf16_f32 v16, v96, v97
    v_cvt_pk_bf16_f32 v17, v98, v99
    v_cvt_pk_bf16_f32 v18, v100, v101
    v_cvt_pk_bf16_f32 v19, v102, v103
    ds_write_b128 v5, v[16:19] offset:0
    s_add_u32 s28, s34, 0
    buffer_store_dwordx4 v[16:19], v4, s[60:63], s28 offen offset:0 sc1
    v_lshl_add_u32 v12, v16, 0, v12
    v_lshl_add_u32 v12, v17, 1, v12
    v_lshl_add_u32 v12, v18, 2, v12
    v_lshl_add_u32 v12, v19, 3, v12
    v_pk_mul_f32 v[104:105], v[104:105], v[6:7]
    v_pk_mul_f32 v[106:107], v[106:107], v[6:7]
    v_pk_mul_f32 v[108:109], v[108:109], v[6:7]
    v_pk_mul_f32 v[110:111], v[110:111], v[6:7]
    v_cvt_pk_bf16_f32 v20, v104, v105
    v_cvt_pk_bf16_f32 v21, v106, v107
    v_cvt_pk_bf16_f32 v22, v108, v109
    v_cvt_pk_bf16_f32 v23, v110, v111
    ds_write_b128 v5, v[20:23] offset:512
    s_add_u32 s28, s34, 0
    buffer_store_dwordx4 v[20:23], v4, s[60:63], s28 offen offset:512 sc1
    v_lshl_add_u32 v12, v20, 0, v12
    v_lshl_add_u32 v12, v21, 1, v12
    v_lshl_add_u32 v12, v22, 2, v12
    v_lshl_add_u32 v12, v23, 3, v12
    v_pk_mul_f32 v[112:113], v[112:113], v[6:7]
    v_pk_mul_f32 v[114:115], v[114:115], v[6:7]
    v_pk_mul_f32 v[116:117], v[116:117], v[6:7]
    v_pk_mul_f32 v[118:119], v[118:119], v[6:7]
    v_cvt_pk_bf16_f32 v24, v112, v113
    v_cvt_pk_bf16_f32 v25, v114, v115
    v_cvt_pk_bf16_f32 v26, v116, v117
    v_cvt_pk_bf16_f32 v27, v118, v119
    ds_write_b128 v5, v[24:27] offset:6144
    s_add_u32 s28, s34, 6144
    buffer_store_dwordx4 v[24:27], v4, s[60:63], s28 offen offset:0 sc1
    v_lshl_add_u32 v12, v24, 0, v12
    v_lshl_add_u32 v12, v25, 1, v12
    v_lshl_add_u32 v12, v26, 2, v12
    v_lshl_add_u32 v12, v27, 3, v12
    v_pk_mul_f32 v[120:121], v[120:121], v[6:7]
    v_pk_mul_f32 v[122:123], v[122:123], v[6:7]
    v_pk_mul_f32 v[124:125], v[124:125], v[6:7]
    v_pk_mul_f32 v[126:127], v[126:127], v[6:7]
    v_cvt_pk_bf16_f32 v28, v120, v121
    v_cvt_pk_bf16_f32 v29, v122, v123
    v_cvt_pk_bf16_f32 v30, v124, v125
    v_cvt_pk_bf16_f32 v31, v126, v127
    ds_write_b128 v5, v[28:31] offset:6656
    s_add_u32 s28, s34, 6144
    buffer_store_dwordx4 v[28:31], v4, s[60:63], s28 offen offset:512 sc1
    v_lshl_add_u32 v12, v28, 0, v12
    v_lshl_add_u32 v12, v29, 1, v12
    v_lshl_add_u32 v12, v30, 2, v12
    v_lshl_add_u32 v12, v31, 3, v12
    buffer_store_dword v12, v11, s[60:63], s35 offen sc1
    s_nop 0
L_x_done:
    s_waitcnt vmcnt(8) lgkmcnt(0)
    s_cmp_lt_u32 s24, 4
    s_cbranch_scc1 L_oc
    s_cmp_lt_u32 s24, 10
    s_cbranch_scc1 L_ow
    s_barrier
    s_sub_u32 s25, s24, 10
    s_mul_i32 s79, s25, 18432
    s_mul_i32 s25, s25, 36864
    v_mul_u32_u24 v1, 1821, v0
    v_lshl_add_u32 v2, v0, 4, s25
    s_movk_i32 s26, 576
    v_add_u32 v3, 0, v1
    v_lshrrev_b32 v4, 16, v3
    v_mad_u32_u24 v13, v4, s26, v2
    v_lshrrev_b32 v3, 13, v3
    v_bitop3_b32 v13, v13, v3, 32 bitop3:0x78
    v_add_u32 v3, 116544, v1
    v_lshrrev_b32 v4, 16, v3
    v_mad_u32_u24 v14, v4, s26, v2
    v_lshrrev_b32 v3, 13, v3
    v_bitop3_b32 v14, v14, v3, 32 bitop3:0x78
    v_add_u32 v3, 233088, v1
    v_lshrrev_b32 v4, 16, v3
    v_mad_u32_u24 v15, v4, s26, v2
    v_lshrrev_b32 v3, 13, v3
    v_bitop3_b32 v15, v15, v3, 32 bitop3:0x78
    v_add_u32 v3, 349632, v1
    v_lshrrev_b32 v4, 16, v3
    v_mad_u32_u24 v16, v4, s26, v2
    v_lshrrev_b32 v3, 13, v3
    v_bitop3_b32 v16, v16, v3, 32 bitop3:0x78
    v_add_u32 v3, 466176, v1
    v_lshrrev_b32 v4, 16, v3
    v_mad_u32_u24 v17, v4, s26, v2
    v_lshrrev_b32 v3, 13, v3
    v_bitop3_b32 v17, v17, v3, 32 bitop3:0x78
    v_add_u32 v3, 582720, v1
    v_lshrrev_b32 v4, 16, v3
    v_mad_u32_u24 v18, v4, s26, v2
    v_lshrrev_b32 v3, 13, v3
    v_bitop3_b32 v18, v18, v3, 32 bitop3:0x78
    v_add_u32 v3, 699264, v1
    v_lshrrev_b32 v4, 16, v3
    v_mad_u32_u24 v19, v4, s26, v2
    v_lshrrev_b32 v3, 13, v3
    v_bitop3_b32 v19, v19, v3, 32 bitop3:0x78
    v_add_u32 v3, 815808, v1
    v_lshrrev_b32 v4, 16, v3
    v_mad_u32_u24 v20, v4, s26, v2
    v_lshrrev_b32 v3, 13, v3
    v_bitop3_b32 v20, v20, v3, 32 bitop3:0x78
    v_add_u32 v3, 932352, v1
    v_lshrrev_b32 v4, 16, v3
    v_mad_u32_u24 v21, v4, s26, v2
    v_lshrrev_b32 v3, 13, v3
    v_bitop3_b32 v21, v21, v3, 32 bitop3:0x78
    s_add_u32 m0, s79, 73728
    s_add_u32 s28, s73, 0
    buffer_load_dwordx4 v13, s[56:59], s28 offen lds
    s_add_u32 m0, s79, 74752
    s_add_u32 s28, s73, 1024
    buffer_load_dwordx4 v14, s[56:59], s28 offen lds
    s_add_u32 m0, s79, 75776
    s_add_u32 s28, s73, 2048
    buffer_load_dwordx4 v15, s[56:59], s28 offen lds
    s_add_u32 m0, s79, 76800
    s_add_u32 s28, s73, 3072
    buffer_load_dwordx4 v16, s[56:59], s28 offen lds
    s_add_u32 m0, s79, 77824
    s_add_u32 s28, s73, 4096
    buffer_load_dwordx4 v17, s[56:59], s28 offen lds
    s_add_u32 m0, s79, 78848
    s_add_u32 s28, s73, 5120
    buffer_load_dwordx4 v18, s[56:59], s28 offen lds
    s_add_u32 m0, s79, 79872
    s_add_u32 s28, s73, 6144
    buffer_load_dwordx4 v19, s[56:59], s28 offen lds
    s_add_u32 m0, s79, 80896
    s_add_u32 s28, s73, 7168
    buffer_load_dwordx4 v20, s[56:59], s28 offen lds
    s_add_u32 m0, s79, 81920
    s_add_u32 s28, s73, 8192
    buffer_load_dwordx4 v21, s[56:59], s28 offen lds
    s_add_u32 m0, s79, 82944
    s_add_u32 s28, s73, 18432
    buffer_load_dwordx4 v13, s[56:59], s28 offen lds
    s_add_u32 m0, s79, 83968
    s_add_u32 s28, s73, 19456
    buffer_load_dwordx4 v14, s[56:59], s28 offen lds
    s_add_u32 m0, s79, 84992
    s_add_u32 s28, s73, 20480
    buffer_load_dwordx4 v15, s[56:59], s28 offen lds
    s_add_u32 m0, s79, 86016
    s_add_u32 s28, s73, 21504
    buffer_load_dwordx4 v16, s[56:59], s28 offen lds
    s_add_u32 m0, s79, 87040
    s_add_u32 s28, s73, 22528
    buffer_load_dwordx4 v17, s[56:59], s28 offen lds
    s_add_u32 m0, s79, 88064
    s_add_u32 s28, s73, 23552
    buffer_load_dwordx4 v18, s[56:59], s28 offen lds
    s_add_u32 m0, s79, 89088
    s_add_u32 s28, s73, 24576
    buffer_load_dwordx4 v19, s[56:59], s28 offen lds
    s_add_u32 m0, s79, 90112
    s_add_u32 s28, s73, 25600
    buffer_load_dwordx4 v20, s[56:59], s28 offen lds
    s_add_u32 m0, s79, 91136
    s_add_u32 s28, s73, 26624
    buffer_load_dwordx4 v21, s[56:59], s28 offen lds
    s_waitcnt vmcnt(23)
    s_barrier
    s_add_u32 m0, s79, 0
    s_add_u32 s28, s73, 73728
    buffer_load_dwordx4 v13, s[56:59], s28 offen lds
    s_add_u32 m0, s79, 1024
    s_add_u32 s28, s73, 74752
    buffer_load_dwordx4 v14, s[56:59], s28 offen lds
    s_add_u32 m0, s79, 2048
    s_add_u32 s28, s73, 75776
    buffer_load_dwordx4 v15, s[56:59], s28 offen lds
    s_add_u32 m0, s79, 3072
    s_add_u32 s28, s73, 76800
    buffer_load_dwordx4 v16, s[56:59], s28 offen lds
    s_add_u32 m0, s79, 4096
    s_add_u32 s28, s73, 77824
    buffer_load_dwordx4 v17, s[56:59], s28 offen lds
    s_add_u32 m0, s79, 5120
    s_add_u32 s28, s73, 78848
    buffer_load_dwordx4 v18, s[56:59], s28 offen lds
    s_add_u32 m0, s79, 6144
    s_add_u32 s28, s73, 79872
    buffer_load_dwordx4 v19, s[56:59], s28 offen lds
    s_add_u32 m0, s79, 7168
    s_add_u32 s28, s73, 80896
    buffer_load_dwordx4 v20, s[56:59], s28 offen lds
    s_add_u32 m0, s79, 8192
    s_add_u32 s28, s73, 81920
    buffer_load_dwordx4 v21, s[56:59], s28 offen lds
    s_add_u32 m0, s79, 9216
    s_add_u32 s28, s73, 92160
    buffer_load_dwordx4 v13, s[56:59], s28 offen lds
    s_add_u32 m0, s79, 10240
    s_add_u32 s28, s73, 93184
    buffer_load_dwordx4 v14, s[56:59], s28 offen lds
    s_add_u32 m0, s79, 11264
    s_add_u32 s28, s73, 94208
    buffer_load_dwordx4 v15, s[56:59], s28 offen lds
    s_add_u32 m0, s79, 12288
    s_add_u32 s28, s73, 95232
    buffer_load_dwordx4 v16, s[56:59], s28 offen lds
    s_add_u32 m0, s79, 13312
    s_add_u32 s28, s73, 96256
    buffer_load_dwordx4 v17, s[56:59], s28 offen lds
    s_add_u32 m0, s79, 14336
    s_add_u32 s28, s73, 97280
    buffer_load_dwordx4 v18, s[56:59], s28 offen lds
    s_add_u32 m0, s79, 15360
    s_add_u32 s28, s73, 98304
    buffer_load_dwordx4 v19, s[56:59], s28 offen lds
    s_add_u32 m0, s79, 16384
    s_add_u32 s28, s73, 99328
    buffer_load_dwordx4 v20, s[56:59], s28 offen lds
    s_add_u32 m0, s79, 17408
    s_add_u32 s28, s73, 100352
    buffer_load_dwordx4 v21, s[56:59], s28 offen lds
    v_subrev_u32 v13, s79, v13
    v_subrev_u32 v14, s79, v14
    v_subrev_u32 v15, s79, v15
    v_add_u32 v16, s79, v16
    v_add_u32 v17, s79, v17
    v_add_u32 v18, s79, v18
    v_add_u32 v19, s79, v19
    v_add_u32 v20, s79, v20
    v_add_u32 v21, s79, v21
    s_lshr_b32 s40, s79, 1
    s_add_u32 s41, s79, s40
    s_waitcnt vmcnt(18)
    s_barrier
    s_add_u32 m0, s40, 36864
    s_add_u32 s28, s74, 0
    buffer_load_dwordx4 v13, s[56:59], s28 offen lds
    s_add_u32 m0, s40, 37888
    s_add_u32 s28, s74, 1024
    buffer_load_dwordx4 v14, s[56:59], s28 offen lds
    s_add_u32 m0, s40, 38912
    s_add_u32 s28, s74, 2048
    buffer_load_dwordx4 v15, s[56:59], s28 offen lds
    s_add_u32 m0, s41, 39936
    s_add_u32 s28, s74, 3072
    buffer_load_dwordx4 v16, s[56:59], s28 offen lds
    s_add_u32 m0, s41, 40960
    s_add_u32 s28, s74, 4096
    buffer_load_dwordx4 v17, s[56:59], s28 offen lds
    s_add_u32 m0, s41, 41984
    s_add_u32 s28, s74, 5120
    buffer_load_dwordx4 v18, s[56:59], s28 offen lds
    s_add_u32 m0, s41, 43008
    s_add_u32 s28, s74, 6144
    buffer_load_dwordx4 v19, s[56:59], s28 offen lds
    s_add_u32 m0, s41, 44032
    s_add_u32 s28, s74, 7168
    buffer_load_dwordx4 v20, s[56:59], s28 offen lds
    s_add_u32 m0, s41, 45056
    s_add_u32 s28, s74, 8192
    buffer_load_dwordx4 v21, s[56:59], s28 offen lds
    s_waitcnt vmcnt(9)
    s_barrier
    s_add_u32 m0, s40, 73728
    s_add_u32 s28, s74, 73728
    buffer_load_dwordx4 v13, s[56:59], s28 offen lds
    s_add_u32 m0, s40, 74752
    s_add_u32 s28, s74, 74752
    buffer_load_dwordx4 v14, s[56:59], s28 offen lds
    s_add_u32 m0, s40, 75776
    s_add_u32 s28, s74, 75776
    buffer_load_dwordx4 v15, s[56:59], s28 offen lds
    s_add_u32 m0, s41, 76800
    s_add_u32 s28, s74, 76800
    buffer_load_dwordx4 v16, s[56:59], s28 offen lds
    s_add_u32 m0, s41, 77824
    s_add_u32 s28, s74, 77824
    buffer_load_dwordx4 v17, s[56:59], s28 offen lds
    s_add_u32 m0, s41, 78848
    s_add_u32 s28, s74, 78848
    buffer_load_dwordx4 v18, s[56:59], s28 offen lds
    s_add_u32 m0, s41, 79872
    s_add_u32 s28, s74, 79872
    buffer_load_dwordx4 v19, s[56:59], s28 offen lds
    s_add_u32 m0, s41, 80896
    s_add_u32 s28, s74, 80896
    buffer_load_dwordx4 v20, s[56:59], s28 offen lds
    s_add_u32 m0, s41, 81920
    s_add_u32 s28, s74, 81920
    buffer_load_dwordx4 v21, s[56:59], s28 offen lds
    s_waitcnt vmcnt(9)
    s_barrier
    s_add_u32 m0, s40, 0
    s_add_u32 s28, s75, 0
    buffer_load_dwordx4 v13, s[56:59], s28 offen lds
    s_add_u32 m0, s40, 1024
    s_add_u32 s28, s75, 1024
    buffer_load_dwordx4 v14, s[56:59], s28 offen lds
    s_add_u32 m0, s40, 2048
    s_add_u32 s28, s75, 2048
    buffer_load_dwordx4 v15, s[56:59], s28 offen lds
    s_add_u32 m0, s41, 3072
    s_add_u32 s28, s75, 3072
    buffer_load_dwordx4 v16, s[56:59], s28 offen lds
    s_add_u32 m0, s41, 4096
    s_add_u32 s28, s75, 4096
    buffer_load_dwordx4 v17, s[56:59], s28 offen lds
    s_add_u32 m0, s41, 5120
    s_add_u32 s28, s75, 5120
    buffer_load_dwordx4 v18, s[56:59], s28 offen lds
    s_add_u32 m0, s41, 6144
    s_add_u32 s28, s75, 6144
    buffer_load_dwordx4 v19, s[56:59], s28 offen lds
    s_add_u32 m0, s41, 7168
    s_add_u32 s28, s75, 7168
    buffer_load_dwordx4 v20, s[56:59], s28 offen lds
    s_add_u32 m0, s41, 8192
    s_add_u32 s28, s75, 8192
    buffer_load_dwordx4 v21, s[56:59], s28 offen lds
    s_waitcnt vmcnt(9)
    s_barrier
    s_add_u32 m0, s40, 36864
    s_add_u32 s28, s75, 73728
    buffer_load_dwordx4 v13, s[56:59], s28 offen lds
    s_add_u32 m0, s40, 37888
    s_add_u32 s28, s75, 74752
    buffer_load_dwordx4 v14, s[56:59], s28 offen lds
    s_add_u32 m0, s40, 38912
    s_add_u32 s28, s75, 75776
    buffer_load_dwordx4 v15, s[56:59], s28 offen lds
    s_add_u32 m0, s41, 39936
    s_add_u32 s28, s75, 76800
    buffer_load_dwordx4 v16, s[56:59], s28 offen lds
    s_add_u32 m0, s41, 40960
    s_add_u32 s28, s75, 77824
    buffer_load_dwordx4 v17, s[56:59], s28 offen lds
    s_add_u32 m0, s41, 41984
    s_add_u32 s28, s75, 78848
    buffer_load_dwordx4 v18, s[56:59], s28 offen lds
    s_add_u32 m0, s41, 43008
    s_add_u32 s28, s75, 79872
    buffer_load_dwordx4 v19, s[56:59], s28 offen lds
    s_add_u32 m0, s41, 44032
    s_add_u32 s28, s75, 80896
    buffer_load_dwordx4 v20, s[56:59], s28 offen lds
    s_add_u32 m0, s41, 45056
    s_add_u32 s28, s75, 81920
    buffer_load_dwordx4 v21, s[56:59], s28 offen lds
    s_waitcnt vmcnt(9)
    s_barrier
    s_waitcnt vmcnt(0)
    s_barrier
    s_branch L_red
L_ow:
    s_mul_i32 s25, s29, 12288
    v_add_u32 v4, s25, v4
    v_add_u32 v6, 6144, v4
    v_add_u32 v5, 110592, v4
    s_lshr_b32 s40, s76, 4
    s_add_u32 s40, s40, 41943040
    s_lshr_b32 s41, s77, 4
    s_add_u32 s41, s41, 41943040
    s_lshr_b32 s42, s78, 4
    s_add_u32 s42, s42, 41943040
    s_barrier
    s_waitcnt vmcnt(5)
    s_barrier
    buffer_load_dwordx4 v[16:19], v4, s[60:63], s76 offen offset:0 sc1
    buffer_load_dwordx4 v[20:23], v4, s[60:63], s76 offen offset:512 sc1
    buffer_load_dwordx4 v[24:27], v6, s[60:63], s76 offen offset:0 sc1
    buffer_load_dwordx4 v[28:31], v6, s[60:63], s76 offen offset:512 sc1
    buffer_load_dword v32, v11, s[60:63], s40 offen sc1
    s_mov_b32 s38, 65536
    s_waitcnt vmcnt(0)
L_op0:
    v_add_u32 v12, s36, v16
    v_lshl_add_u32 v13, v17, 1, v20
    v_lshl_add_u32 v12, v18, 2, v12
    v_lshl_add_u32 v13, v19, 3, v13
    v_lshl_add_u32 v12, v21, 1, v12
    v_lshl_add_u32 v13, v22, 2, v13
    v_lshl_add_u32 v12, v23, 3, v12
    v_lshl_add_u32 v13, v24, 0, v13
    v_lshl_add_u32 v12, v25, 1, v12
    v_lshl_add_u32 v13, v26, 2, v13
    v_lshl_add_u32 v12, v27, 3, v12
    v_lshl_add_u32 v13, v28, 0, v13
    v_lshl_add_u32 v12, v29, 1, v12
    v_lshl_add_u32 v13, v30, 2, v13
    v_lshl_add_u32 v12, v31, 3, v12
    v_add_u32 v12, v12, v13
    v_cmp_ne_u32 vcc, v12, v32
    s_nop 4
    s_cbranch_vccz L_opd0
    buffer_load_dwordx4 v[16:19], v4, s[60:63], s76 offen offset:0 sc1
    buffer_load_dwordx4 v[20:23], v4, s[60:63], s76 offen offset:512 sc1
    buffer_load_dwordx4 v[24:27], v6, s[60:63], s76 offen offset:0 sc1
    buffer_load_dwordx4 v[28:31], v6, s[60:63], s76 offen offset:512 sc1
    buffer_load_dword v32, v11, s[60:63], s40 offen sc1
L_opw0:
    s_sub_u32 s38, s38, 1
    s_waitcnt vmcnt(0)
    s_cbranch_scc0 L_op0
L_opd0:
    buffer_load_dwordx4 v[36:39], v4, s[60:63], s77 offen offset:0 sc1
    buffer_load_dwordx4 v[40:43], v4, s[60:63], s77 offen offset:512 sc1
    buffer_load_dwordx4 v[44:47], v6, s[60:63], s77 offen offset:0 sc1
    buffer_load_dwordx4 v[48:51], v6, s[60:63], s77 offen offset:512 sc1
    buffer_load_dword v52, v11, s[60:63], s41 offen sc1
    buffer_load_dwordx4 v[56:59], v4, s[60:63], s78 offen offset:0 sc1
    buffer_load_dwordx4 v[60:63], v4, s[60:63], s78 offen offset:512 sc1
    buffer_load_dwordx4 v[64:67], v6, s[60:63], s78 offen offset:0 sc1
    buffer_load_dwordx4 v[68:71], v6, s[60:63], s78 offen offset:512 sc1
    buffer_load_dword v72, v11, s[60:63], s42 offen sc1
    ds_write_b128 v5, v[16:19] offset:24576
    ds_write_b128 v5, v[20:23] offset:25088
    ds_write_b128 v5, v[24:27] offset:30720
    ds_write_b128 v5, v[28:31] offset:31232
    s_waitcnt lgkmcnt(0)
    s_barrier
    s_add_u32 m0, s79, 36864
    s_add_u32 s28, s74, 0
    buffer_load_dwordx4 v160, s[56:59], s28 offen lds
    s_add_u32 m0, s79, 37888
    s_add_u32 s28, s74, 0
    buffer_load_dwordx4 v161, s[56:59], s28 offen lds
    s_add_u32 m0, s79, 38912
    s_add_u32 s28, s74, 0
    buffer_load_dwordx4 v162, s[56:59], s28 offen lds
    s_barrier
    s_add_u32 m0, s79, 73728
    s_add_u32 s28, s74, 73728
    buffer_load_dwordx4 v160, s[56:59], s28 offen lds
    s_add_u32 m0, s79, 74752
    s_add_u32 s28, s74, 73728
    buffer_load_dwordx4 v161, s[56:59], s28 offen lds
    s_add_u32 m0, s79, 75776
    s_add_u32 s28, s74, 73728
    buffer_load_dwordx4 v162, s[56:59], s28 offen lds
    s_mov_b32 s38, 65536
    s_waitcnt vmcnt(11)
L_op1:
    v_add_u32 v12, s36, v36
    v_lshl_add_u32 v13, v37, 1, v40
    v_lshl_add_u32 v12, v38, 2, v12
    v_lshl_add_u32 v13, v39, 3, v13
    v_lshl_add_u32 v12, v41, 1, v12
    v_lshl_add_u32 v13, v42, 2, v13
    v_lshl_add_u32 v12, v43, 3, v12
    v_lshl_add_u32 v13, v44, 0, v13
    v_lshl_add_u32 v12, v45, 1, v12
    v_lshl_add_u32 v13, v46, 2, v13
    v_lshl_add_u32 v12, v47, 3, v12
    v_lshl_add_u32 v13, v48, 0, v13
    v_lshl_add_u32 v12, v49, 1, v12
    v_lshl_add_u32 v13, v50, 2, v13
    v_lshl_add_u32 v12, v51, 3, v12
    v_add_u32 v12, v12, v13
    v_cmp_ne_u32 vcc, v12, v52
    s_nop 4
    s_cbranch_vccz L_opd1
    buffer_load_dwordx4 v[36:39], v4, s[60:63], s77 offen offset:0 sc1
    buffer_load_dwordx4 v[40:43], v4, s[60:63], s77 offen offset:512 sc1
    buffer_load_dwordx4 v[44:47], v6, s[60:63], s77 offen offset:0 sc1
    buffer_load_dwordx4 v[48:51], v6, s[60:63], s77 offen offset:512 sc1
    buffer_load_dword v52, v11, s[60:63], s41 offen sc1
L_opw1:
    s_sub_u32 s38, s38, 1
    s_waitcnt vmcnt(0)
    s_cbranch_scc0 L_op1
L_opd1:
    ds_write_b128 v5, v[36:39] offset:0
    ds_write_b128 v5, v[40:43] offset:512
    ds_write_b128 v5, v[44:47] offset:6144
    ds_write_b128 v5, v[48:51] offset:6656
    s_waitcnt lgkmcnt(0)
    s_waitcnt vmcnt(3)
    s_barrier
    s_add_u32 m0, s79, 0
    s_add_u32 s28, s75, 0
    buffer_load_dwordx4 v160, s[56:59], s28 offen lds
    s_add_u32 m0, s79, 1024
    s_add_u32 s28, s75, 0
    buffer_load_dwordx4 v161, s[56:59], s28 offen lds
    s_add_u32 m0, s79, 2048
    s_add_u32 s28, s75, 0
    buffer_load_dwordx4 v162, s[56:59], s28 offen lds
    s_waitcnt vmcnt(3)
    s_barrier
    s_add_u32 m0, s79, 36864
    s_add_u32 s28, s75, 73728
    buffer_load_dwordx4 v160, s[56:59], s28 offen lds
    s_add_u32 m0, s79, 37888
    s_add_u32 s28, s75, 73728
    buffer_load_dwordx4 v161, s[56:59], s28 offen lds
    s_add_u32 m0, s79, 38912
    s_add_u32 s28, s75, 73728
    buffer_load_dwordx4 v162, s[56:59], s28 offen lds
    s_mov_b32 s38, 65536
    s_waitcnt vmcnt(9)
L_op2:
    v_add_u32 v12, s36, v56
    v_lshl_add_u32 v13, v57, 1, v60
    v_lshl_add_u32 v12, v58, 2, v12
    v_lshl_add_u32 v13, v59, 3, v13
    v_lshl_add_u32 v12, v61, 1, v12
    v_lshl_add_u32 v13, v62, 2, v13
    v_lshl_add_u32 v12, v63, 3, v12
    v_lshl_add_u32 v13, v64, 0, v13
    v_lshl_add_u32 v12, v65, 1, v12
    v_lshl_add_u32 v13, v66, 2, v13
    v_lshl_add_u32 v12, v67, 3, v12
    v_lshl_add_u32 v13, v68, 0, v13
    v_lshl_add_u32 v12, v69, 1, v12
    v_lshl_add_u32 v13, v70, 2, v13
    v_lshl_add_u32 v12, v71, 3, v12
    v_add_u32 v12, v12, v13
    v_cmp_ne_u32 vcc, v12, v72
    s_nop 4
    s_cbranch_vccz L_opd2
    buffer_load_dwordx4 v[56:59], v4, s[60:63], s78 offen offset:0 sc1
    buffer_load_dwordx4 v[60:63], v4, s[60:63], s78 offen offset:512 sc1
    buffer_load_dwordx4 v[64:67], v6, s[60:63], s78 offen offset:0 sc1
    buffer_load_dwordx4 v[68:71], v6, s[60:63], s78 offen offset:512 sc1
    buffer_load_dword v72, v11, s[60:63], s42 offen sc1
L_opw2:
    s_sub_u32 s38, s38, 1
    s_waitcnt vmcnt(0)
    s_cbranch_scc0 L_op2
L_opd2:
    ds_write_b128 v5, v[56:59] offset:24576
    ds_write_b128 v5, v[60:63] offset:25088
    ds_write_b128 v5, v[64:67] offset:30720
    ds_write_b128 v5, v[68:71] offset:31232
    s_waitcnt lgkmcnt(0)
    s_waitcnt vmcnt(3)
    s_barrier
    s_waitcnt vmcnt(0)
    s_barrier
L_red:
    s_sub_u32 s27, s24, 4
    s_lshl_b32 s28, s22, 2
    s_add_u32 s28, s28, s21
    s_lshl_b32 s28, s28, 3
    s_add_u32 s28, s28, s20
    s_lshl_b32 s28, s28, 3
    s_add_u32 s28, s28, s27
    s_mul_i32 s28, s28, 7168
    s_add_u32 s72, s28, 16777216
    s_add_u32 s73, s72, 4096
    v_lshlrev_b32 v1, 4, v0
    s_mul_i32 s25, s27, 7168
    s_add_u32 s25, s25, 73728
    v_add_u32 v5, s25, v1
    s_lshl_b32 s25, s27, 10
    s_add_u32 s25, s25, 73728
    v_add_u32 v6, s25, v1
    s_mul_i32 s25, s22, 221184
    s_add_u32 s64, s14, s25
    s_addc_u32 s65, s15, 0
    s_mov_b32 s66, 221184
    s_mov_b32 s67, 0x20000
    s_lshr_b32 s26, s20, 1
    s_and_b32 s31, s20, 1
    s_mul_i32 s29, s31, 6
    s_add_u32 s29, s29, s27
    s_lshr_b32 s74, s29, 2
    s_and_b32 s75, s29, 3
    s_lshl_b32 s75, s75, 6
    s_cmp_eq_u32 s27, 6
    s_cselect_b32 s74, s31, s74
    s_cselect_b32 s75, 256, s75
    s_and_b32 s25, s21, 2
    s_lshr_b32 s29, s26, 1
    s_add_u32 s25, s25, s29
    s_mul_i32 s25, s25, 3
    s_add_u32 s25, s25, s74
    s_mul_i32 s25, s25, 18432
    s_add_u32 s25, s25, s75
    s_and_b32 s29, s21, 1
    s_lshl_b32 s29, s29, 1
    s_and_b32 s26, s26, 1
    s_add_u32 s29, s29, s26
    s_mul_i32 s29, s29, 288
    s_add_u32 s25, s25, s29
    v_and_b32 v2, 15, v0
    v_mul_u32_u24 v2, 1152, v2
    v_add_u32 v2, s25, v2
    v_lshrrev_b32 v3, 4, v0
    v_lshl_add_u32 v7, v3, 3, v2
    v_bfe_u32 v3, v0, 4, 1
    v_lshl_add_u32 v2, v3, 5, v2
    v_lshrrev_b32 v3, 5, v0
    v_lshl_add_u32 v2, v3, 4, v2
    s_mul_i32 s75, s31, 18428
    s_sub_u32 s75, 36864, s75
    v_mov_b32 v8, 0
    v_mov_b32 v9, 0
    v_mov_b32 v10, 0
    v_mov_b32 v11, 0
    v_mov_b32 v12, 0
    v_mov_b32 v13, 0
    v_mov_b32 v14, 0
    v_mov_b32 v15, 0
    s_mov_b32 s32, 0x00003f80
    s_mov_b32 s33, 0x3f800000
    s_mov_b32 s38, 65536
    s_barrier
    s_cmp_eq_u32 s27, s20
    s_cbranch_scc1 L_rown
    s_lshl_b32 s25, s22, 2
    s_add_u32 s25, s25, s21
    s_lshl_b32 s25, s25, 5
    s_add_u32 s25, s25, s27
    s_lshl_b32 s25, s25, 2
    s_add_u32 s35, s25, 33619968
    s_mov_b64 exec, 1
L_ph:
    buffer_load_dword v4, off, s[60:63], s35 sc1
    s_waitcnt vmcnt(0)
    v_cmp_eq_u32 vcc, s36, v4
    s_nop 4
    s_cbranch_vccnz L_phd
    s_sleep 2
    s_sub_u32 s38, s38, 1
    s_cbranch_scc0 L_ph
L_phd:
    s_mov_b64 exec, -1
    s_mov_b32 s38, 65536
L_pp:
    buffer_load_dwordx4 v[16:19], v1, s[60:63], s72 offen offset:0 sc1
    buffer_load_dwordx4 v[20:23], v1, s[60:63], s72 offen offset:1024 sc1
    buffer_load_dwordx4 v[24:27], v1, s[60:63], s72 offen offset:2048 sc1
    buffer_load_dwordx4 v[28:31], v1, s[60:63], s72 offen offset:3072 sc1
    buffer_load_dwordx4 v[32:35], v1, s[60:63], s73 offen offset:0 sc1
    buffer_load_dwordx4 v[36:39], v1, s[60:63], s73 offen offset:1024 sc1
    buffer_load_dwordx4 v[40:43], v1, s[60:63], s73 offen offset:2048 sc1
    s_waitcnt vmcnt(6)
    v_add_u32 v44, s36, v16
    s_waitcnt vmcnt(5)
    v_lshl_add_u32 v45, v17, 1, v20
    v_lshl_add_u32 v44, v18, 2, v44
    v_lshl_add_u32 v45, v19, 3, v45
    v_lshl_add_u32 v44, v21, 1, v44
    v_lshl_add_u32 v45, v22, 2, v45
    v_lshl_add_u32 v44, v23, 3, v44
    s_waitcnt vmcnt(4)
    v_lshl_add_u32 v45, v24, 0, v45
    v_lshl_add_u32 v44, v25, 1, v44
    v_lshl_add_u32 v45, v26, 2, v45
    v_lshl_add_u32 v44, v27, 3, v44
    s_waitcnt vmcnt(3)
    v_lshl_add_u32 v45, v28, 0, v45
    v_lshl_add_u32 v44, v29, 1, v44
    v_lshl_add_u32 v45, v30, 2, v45
    v_lshl_add_u32 v44, v31, 3, v44
    s_waitcnt vmcnt(2)
    v_lshl_add_u32 v45, v32, 0, v45
    v_lshl_add_u32 v44, v33, 1, v44
    v_lshl_add_u32 v45, v34, 2, v45
    v_lshl_add_u32 v44, v35, 3, v44
    s_waitcnt vmcnt(1)
    v_lshl_add_u32 v45, v36, 0, v45
    v_lshl_add_u32 v44, v37, 1, v44
    v_lshl_add_u32 v45, v38, 2, v45
    v_lshl_add_u32 v44, v39, 3, v44
    s_waitcnt vmcnt(0)
    v_lshl_add_u32 v45, v40, 0, v45
    v_lshl_add_u32 v44, v41, 1, v44
    v_lshl_add_u32 v45, v42, 2, v45
    v_add_u32 v44, v44, v45
    v_cmp_ne_u32 vcc, v44, v43
    s_nop 4
    s_cbranch_vccz L_ppd
    s_sub_u32 s38, s38, 1
    s_cbranch_scc0 L_pp
L_ppd:
    ds_write_b128 v5, v[16:19] offset:0
    ds_write_b128 v5, v[20:23] offset:1024
    ds_write_b128 v5, v[24:27] offset:2048
    ds_write_b128 v5, v[28:31] offset:3072
    ds_write_b128 v5, v[32:35] offset:4096
    ds_write_b128 v5, v[36:39] offset:5120
    ds_write_b128 v5, v[40:43] offset:6144
L_rown:
    s_waitcnt lgkmcnt(0)
    s_barrier
    s_cmp_eq_u32 s27, 7
    s_cbranch_scc1 L_out
    ds_read_b128 v[16:19], v6 offset:0
    ds_read_b128 v[20:23], v6 offset:7168
    ds_read_b128 v[24:27], v6 offset:14336
    ds_read_b128 v[28:31], v6 offset:21504
    ds_read_b128 v[32:35], v6 offset:28672
    ds_read_b128 v[36:39], v6 offset:35840
    ds_read_b128 v[40:43], v6 offset:43008
    ds_read_b128 v[44:47], v6 offset:50176
    s_waitcnt lgkmcnt(7)
    v_dot2c_f32_bf16 v8, s32, v16
    v_dot2c_f32_bf16 v9, s33, v16
    v_dot2c_f32_bf16 v10, s32, v17
    v_dot2c_f32_bf16 v11, s33, v17
    v_dot2c_f32_bf16 v12, s32, v18
    v_dot2c_f32_bf16 v13, s33, v18
    v_dot2c_f32_bf16 v14, s32, v19
    v_dot2c_f32_bf16 v15, s33, v19
    s_waitcnt lgkmcnt(6)
    v_dot2c_f32_bf16 v8, s32, v20
    v_dot2c_f32_bf16 v9, s33, v20
    v_dot2c_f32_bf16 v10, s32, v21
    v_dot2c_f32_bf16 v11, s33, v21
    v_dot2c_f32_bf16 v12, s32, v22
    v_dot2c_f32_bf16 v13, s33, v22
    v_dot2c_f32_bf16 v14, s32, v23
    v_dot2c_f32_bf16 v15, s33, v23
    s_waitcnt lgkmcnt(5)
    v_dot2c_f32_bf16 v8, s32, v24
    v_dot2c_f32_bf16 v9, s33, v24
    v_dot2c_f32_bf16 v10, s32, v25
    v_dot2c_f32_bf16 v11, s33, v25
    v_dot2c_f32_bf16 v12, s32, v26
    v_dot2c_f32_bf16 v13, s33, v26
    v_dot2c_f32_bf16 v14, s32, v27
    v_dot2c_f32_bf16 v15, s33, v27
    s_waitcnt lgkmcnt(4)
    v_dot2c_f32_bf16 v8, s32, v28
    v_dot2c_f32_bf16 v9, s33, v28
    v_dot2c_f32_bf16 v10, s32, v29
    v_dot2c_f32_bf16 v11, s33, v29
    v_dot2c_f32_bf16 v12, s32, v30
    v_dot2c_f32_bf16 v13, s33, v30
    v_dot2c_f32_bf16 v14, s32, v31
    v_dot2c_f32_bf16 v15, s33, v31
    s_waitcnt lgkmcnt(3)
    v_dot2c_f32_bf16 v8, s32, v32
    v_dot2c_f32_bf16 v9, s33, v32
    v_dot2c_f32_bf16 v10, s32, v33
    v_dot2c_f32_bf16 v11, s33, v33
    v_dot2c_f32_bf16 v12, s32, v34
    v_dot2c_f32_bf16 v13, s33, v34
    v_dot2c_f32_bf16 v14, s32, v35
    v_dot2c_f32_bf16 v15, s33, v35
    s_waitcnt lgkmcnt(2)
    v_dot2c_f32_bf16 v8, s32, v36
    v_dot2c_f32_bf16 v9, s33, v36
    v_dot2c_f32_bf16 v10, s32, v37
    v_dot2c_f32_bf16 v11, s33, v37
    v_dot2c_f32_bf16 v12, s32, v38
    v_dot2c_f32_bf16 v13, s33, v38
    v_dot2c_f32_bf16 v14, s32, v39
    v_dot2c_f32_bf16 v15, s33, v39
    s_waitcnt lgkmcnt(1)
    v_dot2c_f32_bf16 v8, s32, v40
    v_dot2c_f32_bf16 v9, s33, v40
    v_dot2c_f32_bf16 v10, s32, v41
    v_dot2c_f32_bf16 v11, s33, v41
    v_dot2c_f32_bf16 v12, s32, v42
    v_dot2c_f32_bf16 v13, s33, v42
    v_dot2c_f32_bf16 v14, s32, v43
    v_dot2c_f32_bf16 v15, s33, v43
    s_waitcnt lgkmcnt(0)
    v_dot2c_f32_bf16 v8, s32, v44
    v_dot2c_f32_bf16 v9, s33, v44
    v_dot2c_f32_bf16 v10, s32, v45
    v_dot2c_f32_bf16 v11, s33, v45
    v_dot2c_f32_bf16 v12, s32, v46
    v_dot2c_f32_bf16 v13, s33, v46
    v_dot2c_f32_bf16 v14, s32, v47
    v_dot2c_f32_bf16 v15, s33, v47
    v_cvt_pk_bf16_f32 v48, v8, v9
    v_cvt_pk_bf16_f32 v49, v10, v11
    v_cvt_pk_bf16_f32 v50, v12, v13
    v_cvt_pk_bf16_f32 v51, v14, v15
    s_cmp_eq_u32 s27, 6
    s_nop 0
    s_cbranch_scc1 L_r6
    v_permlane16_swap_b32 v48, v50
    v_permlane16_swap_b32 v49, v51
    buffer_store_dwordx4 v[48:51], v2, s[64:67], 0 offen
    s_nop 1
    s_branch L_out
L_r6:
    buffer_store_dwordx2 v[48:49], v7, s[64:67], 0 offen
    buffer_store_dword v50, v7, s[64:67], s75 offen
    s_branch L_out
L_oc:
    v_lshrrev_b32 v2, 5, v0
    v_lshlrev_b32 v2, 4, v2
    v_bfe_u32 v3, v0, 4, 1
    v_lshl_add_u32 v2, v3, 2, v2
    v_bfe_u32 v1, v0, 2, 2
    v_add_u32 v2, v2, v1
    v_mul_u32_u24 v2, 576, v2
    v_and_b32 v1, 3, v0
    v_lshl_add_u32 v2, v1, 3, v2
    s_and_b32 s25, s24, 1
    s_mul_i32 s26, s25, 288
    v_add_u32 v2, s26, v2
    v_lshlrev_b32 v3, 5, v3
    v_add_u32 v4, v2, v3
    v_sub_u32 v5, v2, v3
    s_cmp_eq_u32 s25, 0
    s_cselect_b64 vcc, -1, 0
    v_cndmask_b32 v6, v5, v4, vcc
    v_cndmask_b32 v5, v4, v5, vcc
    v_mov_b32 v4, v6
    v_add_u32 v6, 73728, v4
    v_add_u32 v7, 73728, v5
    s_lshr_b32 s25, s24, 1
    s_mul_i32 s25, s25, 3072
    s_add_u32 s25, s25, 110592
    v_lshl_add_u32 v8, v0, 4, s25
    s_lshl_b32 s25, s22, 2
    s_add_u32 s25, s25, s21
    s_lshl_b32 s26, s25, 2
    s_add_u32 s26, s26, s24
    s_lshl_b32 s26, s26, 4
    s_add_u32 s26, s26, s20
    s_mul_i32 s26, s26, 7168
    s_add_u32 s26, s26, 16777216
    s_lshl_b32 s25, s24, 1
    s_sub_u32 s31, s20, s25
    s_cmp_eq_u32 s31, 0
    s_cselect_b32 s25, 0x40000000, 0
    v_lshl_add_u32 v2, v0, 4, s25
    s_cmp_eq_u32 s31, 1
    s_cselect_b32 s25, 0x40000000, 0
    v_lshl_add_u32 v3, v0, 4, s25
    s_mul_i32 s25, s20, 7168
    s_add_u32 s25, s25, 73728
    v_lshl_add_u32 v1, v0, 4, s25
    s_lshl_b32 s25, s22, 2
    s_add_u32 s25, s25, s21
    s_lshl_b32 s25, s25, 5
    s_add_u32 s25, s25, s20
    s_lshl_b32 s25, s25, 2
    s_add_u32 s35, s25, 33619968
    v_or_b32 v9, s24, v0
    v_min_u32 v9, 1, v9
    v_lshlrev_b32 v9, 30, v9
    v_mov_b32 v10, s36
    s_barrier
    s_setprio 2
    ds_read_b64_tr_b16 v[36:37], v4 offset:0
    ds_read_b64_tr_b16 v[38:39], v4 offset:4608
    ds_read_b128 v[12:15], v8 offset:0
    ds_read_b128 v[16:19], v8 offset:1024
    ds_read_b128 v[20:23], v8 offset:2048
    ds_read_b64_tr_b16 v[40:41], v5 offset:32
    ds_read_b64_tr_b16 v[42:43], v5 offset:4640
    ds_read_b64_tr_b16 v[44:45], v4 offset:64
    ds_read_b64_tr_b16 v[46:47], v4 offset:4672
    ds_read_b64_tr_b16 v[48:49], v5 offset:96
    ds_read_b64_tr_b16 v[50:51], v5 offset:4704
    ds_read_b64_tr_b16 v[52:53], v4 offset:128
    ds_read_b64_tr_b16 v[54:55], v4 offset:4736
    s_waitcnt lgkmcnt(10)
    v_mfma_f32_16x16x32_bf16 v[60:63], v[36:39], v[12:15], 0
    ds_read_b64_tr_b16 v[56:57], v5 offset:160
    s_waitcnt lgkmcnt(10)
    v_mfma_f32_16x16x32_bf16 v[96:99], v[36:39], v[16:19], 0
    ds_read_b64_tr_b16 v[58:59], v5 offset:4768
    s_waitcnt lgkmcnt(10)
    v_mfma_f32_16x16x32_bf16 v[132:135], v[36:39], v[20:23], 0
    s_waitcnt lgkmcnt(8)
    v_mfma_f32_16x16x32_bf16 v[64:67], v[40:43], v[12:15], 0
    ds_read_b128 v[24:27], v8 offset:6144
    ds_read_b128 v[28:31], v8 offset:7168
    ds_read_b128 v[32:35], v8 offset:8192
    v_mfma_f32_16x16x32_bf16 v[100:103], v[40:43], v[16:19], 0
    ds_read_b64_tr_b16 v[36:37], v4 offset:192
    v_mfma_f32_16x16x32_bf16 v[136:139], v[40:43], v[20:23], 0
    ds_read_b64_tr_b16 v[38:39], v4 offset:4800
    s_waitcnt lgkmcnt(11)
    v_mfma_f32_16x16x32_bf16 v[68:71], v[44:47], v[12:15], 0
    ds_read_b64_tr_b16 v[40:41], v5 offset:224
    v_mfma_f32_16x16x32_bf16 v[104:107], v[44:47], v[16:19], 0
    ds_read_b64_tr_b16 v[42:43], v5 offset:4832
    v_mfma_f32_16x16x32_bf16 v[140:143], v[44:47], v[20:23], 0
    s_waitcnt lgkmcnt(11)
    v_mfma_f32_16x16x32_bf16 v[72:75], v[48:51], v[12:15], 0
    ds_read_b64_tr_b16 v[44:45], v4 offset:256
    v_mfma_f32_16x16x32_bf16 v[108:111], v[48:51], v[16:19], 0
    ds_read_b64_tr_b16 v[46:47], v4 offset:4864
    v_mfma_f32_16x16x32_bf16 v[144:147], v[48:51], v[20:23], 0
    s_waitcnt lgkmcnt(11)
    v_mfma_f32_16x16x32_bf16 v[76:79], v[52:55], v[12:15], 0
    ds_read_b64_tr_b16 v[48:49], v4 offset:18432
    v_mfma_f32_16x16x32_bf16 v[112:115], v[52:55], v[16:19], 0
    ds_read_b64_tr_b16 v[50:51], v4 offset:23040
    v_mfma_f32_16x16x32_bf16 v[148:151], v[52:55], v[20:23], 0
    s_waitcnt lgkmcnt(11)
    v_mfma_f32_16x16x32_bf16 v[80:83], v[56:59], v[12:15], 0
    ds_read_b64_tr_b16 v[52:53], v5 offset:18464
    v_mfma_f32_16x16x32_bf16 v[116:119], v[56:59], v[16:19], 0
    ds_read_b64_tr_b16 v[54:55], v5 offset:23072
    v_mfma_f32_16x16x32_bf16 v[152:155], v[56:59], v[20:23], 0
    s_waitcnt lgkmcnt(8)
    v_mfma_f32_16x16x32_bf16 v[84:87], v[36:39], v[12:15], 0
    ds_read_b64_tr_b16 v[56:57], v4 offset:18496
    v_mfma_f32_16x16x32_bf16 v[120:123], v[36:39], v[16:19], 0
    ds_read_b64_tr_b16 v[58:59], v4 offset:23104
    v_mfma_f32_16x16x32_bf16 v[156:159], v[36:39], v[20:23], 0
    s_waitcnt lgkmcnt(8)
    v_mfma_f32_16x16x32_bf16 v[88:91], v[40:43], v[12:15], 0
    ds_read_b64_tr_b16 v[36:37], v5 offset:18528
    v_mfma_f32_16x16x32_bf16 v[124:127], v[40:43], v[16:19], 0
    ds_read_b64_tr_b16 v[38:39], v5 offset:23136
    v_mfma_f32_16x16x32_bf16 v[160:163], v[40:43], v[20:23], 0
    s_waitcnt lgkmcnt(8)
    v_mfma_f32_16x16x32_bf16 v[92:95], v[44:47], v[12:15], 0
    ds_read_b64_tr_b16 v[40:41], v4 offset:18560
    v_mfma_f32_16x16x32_bf16 v[128:131], v[44:47], v[16:19], 0
    ds_read_b64_tr_b16 v[42:43], v4 offset:23168
    v_mfma_f32_16x16x32_bf16 v[164:167], v[44:47], v[20:23], 0
    s_waitcnt lgkmcnt(8)
    v_mfma_f32_16x16x32_bf16 v[60:63], v[48:51], v[24:27], v[60:63]
    ds_read_b64_tr_b16 v[44:45], v5 offset:18592
    v_mfma_f32_16x16x32_bf16 v[96:99], v[48:51], v[28:31], v[96:99]
    ds_read_b64_tr_b16 v[46:47], v5 offset:23200
    v_mfma_f32_16x16x32_bf16 v[132:135], v[48:51], v[32:35], v[132:135]
    s_waitcnt lgkmcnt(8)
    v_mfma_f32_16x16x32_bf16 v[64:67], v[52:55], v[24:27], v[64:67]
    ds_read_b64_tr_b16 v[48:49], v4 offset:18624
    v_mfma_f32_16x16x32_bf16 v[100:103], v[52:55], v[28:31], v[100:103]
    ds_read_b64_tr_b16 v[50:51], v4 offset:23232
    v_mfma_f32_16x16x32_bf16 v[136:139], v[52:55], v[32:35], v[136:139]
    s_waitcnt lgkmcnt(8)
    v_mfma_f32_16x16x32_bf16 v[68:71], v[56:59], v[24:27], v[68:71]
    ds_read_b64_tr_b16 v[52:53], v5 offset:18656
    v_mfma_f32_16x16x32_bf16 v[104:107], v[56:59], v[28:31], v[104:107]
    ds_read_b64_tr_b16 v[54:55], v5 offset:23264
    v_mfma_f32_16x16x32_bf16 v[140:143], v[56:59], v[32:35], v[140:143]
    s_waitcnt lgkmcnt(8)
    v_mfma_f32_16x16x32_bf16 v[72:75], v[36:39], v[24:27], v[72:75]
    ds_read_b64_tr_b16 v[56:57], v4 offset:18688
    v_mfma_f32_16x16x32_bf16 v[108:111], v[36:39], v[28:31], v[108:111]
    ds_read_b64_tr_b16 v[58:59], v4 offset:23296
    v_mfma_f32_16x16x32_bf16 v[144:147], v[36:39], v[32:35], v[144:147]
    s_waitcnt lgkmcnt(8)
    v_mfma_f32_16x16x32_bf16 v[76:79], v[40:43], v[24:27], v[76:79]
    v_mfma_f32_16x16x32_bf16 v[112:115], v[40:43], v[28:31], v[112:115]
    v_mfma_f32_16x16x32_bf16 v[148:151], v[40:43], v[32:35], v[148:151]
    s_waitcnt lgkmcnt(6)
    v_mfma_f32_16x16x32_bf16 v[80:83], v[44:47], v[24:27], v[80:83]
    v_mfma_f32_16x16x32_bf16 v[116:119], v[44:47], v[28:31], v[116:119]
    v_mfma_f32_16x16x32_bf16 v[152:155], v[44:47], v[32:35], v[152:155]
    s_waitcnt vmcnt(5)
    s_waitcnt lgkmcnt(0)
    s_barrier
    v_mfma_f32_16x16x32_bf16 v[84:87], v[48:51], v[24:27], v[84:87]
    ds_read_b64_tr_b16 v[36:37], v4 offset:36864
    ds_read_b64_tr_b16 v[38:39], v4 offset:41472
    ds_read_b128 v[12:15], v8 offset:12288
    v_mfma_f32_16x16x32_bf16 v[120:123], v[48:51], v[28:31], v[120:123]
    ds_read_b128 v[16:19], v8 offset:13312
    ds_read_b128 v[20:23], v8 offset:14336
    ds_read_b64_tr_b16 v[40:41], v5 offset:36896
    v_mfma_f32_16x16x32_bf16 v[156:159], v[48:51], v[32:35], v[156:159]
    ds_read_b64_tr_b16 v[42:43], v5 offset:41504
    ds_read_b64_tr_b16 v[44:45], v4 offset:36928
    v_mfma_f32_16x16x32_bf16 v[88:91], v[52:55], v[24:27], v[88:91]
    ds_read_b64_tr_b16 v[46:47], v4 offset:41536
    ds_read_b64_tr_b16 v[48:49], v5 offset:36960
    v_mfma_f32_16x16x32_bf16 v[124:127], v[52:55], v[28:31], v[124:127]
    ds_read_b64_tr_b16 v[50:51], v5 offset:41568
    v_mfma_f32_16x16x32_bf16 v[160:163], v[52:55], v[32:35], v[160:163]
    v_mfma_f32_16x16x32_bf16 v[92:95], v[56:59], v[24:27], v[92:95]
    ds_read_b64_tr_b16 v[52:53], v4 offset:36992
    v_mfma_f32_16x16x32_bf16 v[128:131], v[56:59], v[28:31], v[128:131]
    ds_read_b64_tr_b16 v[54:55], v4 offset:41600
    v_mfma_f32_16x16x32_bf16 v[164:167], v[56:59], v[32:35], v[164:167]
    s_waitcnt lgkmcnt(10)
    v_mfma_f32_16x16x32_bf16 v[60:63], v[36:39], v[12:15], v[60:63]
    ds_read_b64_tr_b16 v[56:57], v5 offset:37024
    s_waitcnt lgkmcnt(10)
    v_mfma_f32_16x16x32_bf16 v[96:99], v[36:39], v[16:19], v[96:99]
    ds_read_b64_tr_b16 v[58:59], v5 offset:41632
    s_waitcnt lgkmcnt(10)
    v_mfma_f32_16x16x32_bf16 v[132:135], v[36:39], v[20:23], v[132:135]
    s_waitcnt lgkmcnt(8)
    v_mfma_f32_16x16x32_bf16 v[64:67], v[40:43], v[12:15], v[64:67]
    ds_read_b128 v[24:27], v8 offset:18432
    ds_read_b128 v[28:31], v8 offset:19456
    ds_read_b128 v[32:35], v8 offset:20480
    v_mfma_f32_16x16x32_bf16 v[100:103], v[40:43], v[16:19], v[100:103]
    ds_read_b64_tr_b16 v[36:37], v4 offset:37056
    v_mfma_f32_16x16x32_bf16 v[136:139], v[40:43], v[20:23], v[136:139]
    ds_read_b64_tr_b16 v[38:39], v4 offset:41664
    s_waitcnt lgkmcnt(11)
    v_mfma_f32_16x16x32_bf16 v[68:71], v[44:47], v[12:15], v[68:71]
    ds_read_b64_tr_b16 v[40:41], v5 offset:37088
    v_mfma_f32_16x16x32_bf16 v[104:107], v[44:47], v[16:19], v[104:107]
    ds_read_b64_tr_b16 v[42:43], v5 offset:41696
    v_mfma_f32_16x16x32_bf16 v[140:143], v[44:47], v[20:23], v[140:143]
    s_waitcnt lgkmcnt(11)
    v_mfma_f32_16x16x32_bf16 v[72:75], v[48:51], v[12:15], v[72:75]
    ds_read_b64_tr_b16 v[44:45], v4 offset:37120
    v_mfma_f32_16x16x32_bf16 v[108:111], v[48:51], v[16:19], v[108:111]
    ds_read_b64_tr_b16 v[46:47], v4 offset:41728
    v_mfma_f32_16x16x32_bf16 v[144:147], v[48:51], v[20:23], v[144:147]
    s_waitcnt lgkmcnt(11)
    v_mfma_f32_16x16x32_bf16 v[76:79], v[52:55], v[12:15], v[76:79]
    ds_read_b64_tr_b16 v[48:49], v4 offset:55296
    v_mfma_f32_16x16x32_bf16 v[112:115], v[52:55], v[16:19], v[112:115]
    ds_read_b64_tr_b16 v[50:51], v4 offset:59904
    v_mfma_f32_16x16x32_bf16 v[148:151], v[52:55], v[20:23], v[148:151]
    s_waitcnt lgkmcnt(11)
    v_mfma_f32_16x16x32_bf16 v[80:83], v[56:59], v[12:15], v[80:83]
    ds_read_b64_tr_b16 v[52:53], v5 offset:55328
    v_mfma_f32_16x16x32_bf16 v[116:119], v[56:59], v[16:19], v[116:119]
    ds_read_b64_tr_b16 v[54:55], v5 offset:59936
    v_mfma_f32_16x16x32_bf16 v[152:155], v[56:59], v[20:23], v[152:155]
    s_waitcnt lgkmcnt(8)
    v_mfma_f32_16x16x32_bf16 v[84:87], v[36:39], v[12:15], v[84:87]
    ds_read_b64_tr_b16 v[56:57], v4 offset:55360
    v_mfma_f32_16x16x32_bf16 v[120:123], v[36:39], v[16:19], v[120:123]
    ds_read_b64_tr_b16 v[58:59], v4 offset:59968
    v_mfma_f32_16x16x32_bf16 v[156:159], v[36:39], v[20:23], v[156:159]
    s_waitcnt lgkmcnt(8)
    v_mfma_f32_16x16x32_bf16 v[88:91], v[40:43], v[12:15], v[88:91]
    ds_read_b64_tr_b16 v[36:37], v5 offset:55392
    v_mfma_f32_16x16x32_bf16 v[124:127], v[40:43], v[16:19], v[124:127]
    ds_read_b64_tr_b16 v[38:39], v5 offset:60000
    v_mfma_f32_16x16x32_bf16 v[160:163], v[40:43], v[20:23], v[160:163]
    s_waitcnt lgkmcnt(8)
    v_mfma_f32_16x16x32_bf16 v[92:95], v[44:47], v[12:15], v[92:95]
    ds_read_b64_tr_b16 v[40:41], v4 offset:55424
    v_mfma_f32_16x16x32_bf16 v[128:131], v[44:47], v[16:19], v[128:131]
    ds_read_b64_tr_b16 v[42:43], v4 offset:60032
    v_mfma_f32_16x16x32_bf16 v[164:167], v[44:47], v[20:23], v[164:167]
    s_waitcnt lgkmcnt(8)
    v_mfma_f32_16x16x32_bf16 v[60:63], v[48:51], v[24:27], v[60:63]
    ds_read_b64_tr_b16 v[44:45], v5 offset:55456
    v_mfma_f32_16x16x32_bf16 v[96:99], v[48:51], v[28:31], v[96:99]
    ds_read_b64_tr_b16 v[46:47], v5 offset:60064
    v_mfma_f32_16x16x32_bf16 v[132:135], v[48:51], v[32:35], v[132:135]
    s_waitcnt lgkmcnt(8)
    v_mfma_f32_16x16x32_bf16 v[64:67], v[52:55], v[24:27], v[64:67]
    ds_read_b64_tr_b16 v[48:49], v4 offset:55488
    v_mfma_f32_16x16x32_bf16 v[100:103], v[52:55], v[28:31], v[100:103]
    ds_read_b64_tr_b16 v[50:51], v4 offset:60096
    v_mfma_f32_16x16x32_bf16 v[136:139], v[52:55], v[32:35], v[136:139]
    s_waitcnt lgkmcnt(8)
    v_mfma_f32_16x16x32_bf16 v[68:71], v[56:59], v[24:27], v[68:71]
    ds_read_b64_tr_b16 v[52:53], v5 offset:55520
    v_mfma_f32_16x16x32_bf16 v[104:107], v[56:59], v[28:31], v[104:107]
    ds_read_b64_tr_b16 v[54:55], v5 offset:60128
    v_mfma_f32_16x16x32_bf16 v[140:143], v[56:59], v[32:35], v[140:143]
    s_waitcnt lgkmcnt(8)
    v_mfma_f32_16x16x32_bf16 v[72:75], v[36:39], v[24:27], v[72:75]
    ds_read_b64_tr_b16 v[56:57], v4 offset:55552
    v_mfma_f32_16x16x32_bf16 v[108:111], v[36:39], v[28:31], v[108:111]
    ds_read_b64_tr_b16 v[58:59], v4 offset:60160
    v_mfma_f32_16x16x32_bf16 v[144:147], v[36:39], v[32:35], v[144:147]
    s_waitcnt lgkmcnt(8)
    v_mfma_f32_16x16x32_bf16 v[76:79], v[40:43], v[24:27], v[76:79]
    v_mfma_f32_16x16x32_bf16 v[112:115], v[40:43], v[28:31], v[112:115]
    v_mfma_f32_16x16x32_bf16 v[148:151], v[40:43], v[32:35], v[148:151]
    s_waitcnt lgkmcnt(6)
    v_mfma_f32_16x16x32_bf16 v[80:83], v[44:47], v[24:27], v[80:83]
    v_mfma_f32_16x16x32_bf16 v[116:119], v[44:47], v[28:31], v[116:119]
    v_mfma_f32_16x16x32_bf16 v[152:155], v[44:47], v[32:35], v[152:155]
    s_waitcnt lgkmcnt(0)
    s_barrier
    v_mfma_f32_16x16x32_bf16 v[84:87], v[48:51], v[24:27], v[84:87]
    ds_read_b64_tr_b16 v[36:37], v6 offset:0
    ds_read_b64_tr_b16 v[38:39], v6 offset:4608
    ds_read_b128 v[12:15], v8 offset:24576
    v_mfma_f32_16x16x32_bf16 v[120:123], v[48:51], v[28:31], v[120:123]
    ds_read_b128 v[16:19], v8 offset:25600
    ds_read_b128 v[20:23], v8 offset:26624
    ds_read_b64_tr_b16 v[40:41], v7 offset:32
    v_mfma_f32_16x16x32_bf16 v[156:159], v[48:51], v[32:35], v[156:159]
    ds_read_b64_tr_b16 v[42:43], v7 offset:4640
    ds_read_b64_tr_b16 v[44:45], v6 offset:64
    v_mfma_f32_16x16x32_bf16 v[88:91], v[52:55], v[24:27], v[88:91]
    ds_read_b64_tr_b16 v[46:47], v6 offset:4672
    ds_read_b64_tr_b16 v[48:49], v7 offset:96
    v_mfma_f32_16x16x32_bf16 v[124:127], v[52:55], v[28:31], v[124:127]
    ds_read_b64_tr_b16 v[50:51], v7 offset:4704
    v_mfma_f32_16x16x32_bf16 v[160:163], v[52:55], v[32:35], v[160:163]
    v_mfma_f32_16x16x32_bf16 v[92:95], v[56:59], v[24:27], v[92:95]
    ds_read_b64_tr_b16 v[52:53], v6 offset:128
    v_mfma_f32_16x16x32_bf16 v[128:131], v[56:59], v[28:31], v[128:131]
    ds_read_b64_tr_b16 v[54:55], v6 offset:4736
    v_mfma_f32_16x16x32_bf16 v[164:167], v[56:59], v[32:35], v[164:167]
    s_waitcnt lgkmcnt(10)
    v_mfma_f32_16x16x32_bf16 v[60:63], v[36:39], v[12:15], v[60:63]
    ds_read_b64_tr_b16 v[56:57], v7 offset:160
    s_waitcnt lgkmcnt(10)
    v_mfma_f32_16x16x32_bf16 v[96:99], v[36:39], v[16:19], v[96:99]
    ds_read_b64_tr_b16 v[58:59], v7 offset:4768
    s_waitcnt lgkmcnt(10)
    v_mfma_f32_16x16x32_bf16 v[132:135], v[36:39], v[20:23], v[132:135]
    s_waitcnt lgkmcnt(8)
    v_mfma_f32_16x16x32_bf16 v[64:67], v[40:43], v[12:15], v[64:67]
    ds_read_b128 v[24:27], v8 offset:30720
    ds_read_b128 v[28:31], v8 offset:31744
    ds_read_b128 v[32:35], v8 offset:32768
    v_mfma_f32_16x16x32_bf16 v[100:103], v[40:43], v[16:19], v[100:103]
    ds_read_b64_tr_b16 v[36:37], v6 offset:192
    v_mfma_f32_16x16x32_bf16 v[136:139], v[40:43], v[20:23], v[136:139]
    ds_read_b64_tr_b16 v[38:39], v6 offset:4800
    s_waitcnt lgkmcnt(11)
    v_mfma_f32_16x16x32_bf16 v[68:71], v[44:47], v[12:15], v[68:71]
    ds_read_b64_tr_b16 v[40:41], v7 offset:224
    v_mfma_f32_16x16x32_bf16 v[104:107], v[44:47], v[16:19], v[104:107]
    ds_read_b64_tr_b16 v[42:43], v7 offset:4832
    v_mfma_f32_16x16x32_bf16 v[140:143], v[44:47], v[20:23], v[140:143]
    s_waitcnt lgkmcnt(11)
    v_mfma_f32_16x16x32_bf16 v[72:75], v[48:51], v[12:15], v[72:75]
    ds_read_b64_tr_b16 v[44:45], v6 offset:256
    v_mfma_f32_16x16x32_bf16 v[108:111], v[48:51], v[16:19], v[108:111]
    ds_read_b64_tr_b16 v[46:47], v6 offset:4864
    v_mfma_f32_16x16x32_bf16 v[144:147], v[48:51], v[20:23], v[144:147]
    s_waitcnt lgkmcnt(11)
    v_mfma_f32_16x16x32_bf16 v[76:79], v[52:55], v[12:15], v[76:79]
    ds_read_b64_tr_b16 v[48:49], v6 offset:18432
    v_mfma_f32_16x16x32_bf16 v[112:115], v[52:55], v[16:19], v[112:115]
    ds_read_b64_tr_b16 v[50:51], v6 offset:23040
    v_mfma_f32_16x16x32_bf16 v[148:151], v[52:55], v[20:23], v[148:151]
    s_waitcnt lgkmcnt(11)
    v_mfma_f32_16x16x32_bf16 v[80:83], v[56:59], v[12:15], v[80:83]
    ds_read_b64_tr_b16 v[52:53], v7 offset:18464
    v_mfma_f32_16x16x32_bf16 v[116:119], v[56:59], v[16:19], v[116:119]
    ds_read_b64_tr_b16 v[54:55], v7 offset:23072
    v_mfma_f32_16x16x32_bf16 v[152:155], v[56:59], v[20:23], v[152:155]
    s_waitcnt lgkmcnt(8)
    v_mfma_f32_16x16x32_bf16 v[84:87], v[36:39], v[12:15], v[84:87]
    ds_read_b64_tr_b16 v[56:57], v6 offset:18496
    v_mfma_f32_16x16x32_bf16 v[120:123], v[36:39], v[16:19], v[120:123]
    ds_read_b64_tr_b16 v[58:59], v6 offset:23104
    v_mfma_f32_16x16x32_bf16 v[156:159], v[36:39], v[20:23], v[156:159]
    s_waitcnt lgkmcnt(8)
    v_mfma_f32_16x16x32_bf16 v[88:91], v[40:43], v[12:15], v[88:91]
    ds_read_b64_tr_b16 v[36:37], v7 offset:18528
    v_mfma_f32_16x16x32_bf16 v[124:127], v[40:43], v[16:19], v[124:127]
    ds_read_b64_tr_b16 v[38:39], v7 offset:23136
    v_mfma_f32_16x16x32_bf16 v[160:163], v[40:43], v[20:23], v[160:163]
    s_waitcnt lgkmcnt(8)
    v_mfma_f32_16x16x32_bf16 v[92:95], v[44:47], v[12:15], v[92:95]
    ds_read_b64_tr_b16 v[40:41], v6 offset:18560
    v_mfma_f32_16x16x32_bf16 v[128:131], v[44:47], v[16:19], v[128:131]
    ds_read_b64_tr_b16 v[42:43], v6 offset:23168
    v_mfma_f32_16x16x32_bf16 v[164:167], v[44:47], v[20:23], v[164:167]
    s_waitcnt lgkmcnt(8)
    v_mfma_f32_16x16x32_bf16 v[60:63], v[48:51], v[24:27], v[60:63]
    ds_read_b64_tr_b16 v[44:45], v7 offset:18592
    v_mfma_f32_16x16x32_bf16 v[96:99], v[48:51], v[28:31], v[96:99]
    ds_read_b64_tr_b16 v[46:47], v7 offset:23200
    v_mfma_f32_16x16x32_bf16 v[132:135], v[48:51], v[32:35], v[132:135]
    s_waitcnt lgkmcnt(8)
    v_mfma_f32_16x16x32_bf16 v[64:67], v[52:55], v[24:27], v[64:67]
    ds_read_b64_tr_b16 v[48:49], v6 offset:18624
    v_mfma_f32_16x16x32_bf16 v[100:103], v[52:55], v[28:31], v[100:103]
    ds_read_b64_tr_b16 v[50:51], v6 offset:23232
    v_mfma_f32_16x16x32_bf16 v[136:139], v[52:55], v[32:35], v[136:139]
    s_waitcnt lgkmcnt(8)
    v_mfma_f32_16x16x32_bf16 v[68:71], v[56:59], v[24:27], v[68:71]
    ds_read_b64_tr_b16 v[52:53], v7 offset:18656
    v_mfma_f32_16x16x32_bf16 v[104:107], v[56:59], v[28:31], v[104:107]
    ds_read_b64_tr_b16 v[54:55], v7 offset:23264
    v_mfma_f32_16x16x32_bf16 v[140:143], v[56:59], v[32:35], v[140:143]
    s_waitcnt lgkmcnt(8)
    v_mfma_f32_16x16x32_bf16 v[72:75], v[36:39], v[24:27], v[72:75]
    ds_read_b64_tr_b16 v[56:57], v6 offset:18688
    v_mfma_f32_16x16x32_bf16 v[108:111], v[36:39], v[28:31], v[108:111]
    ds_read_b64_tr_b16 v[58:59], v6 offset:23296
    v_mfma_f32_16x16x32_bf16 v[144:147], v[36:39], v[32:35], v[144:147]
    s_waitcnt lgkmcnt(8)
    v_mfma_f32_16x16x32_bf16 v[76:79], v[40:43], v[24:27], v[76:79]
    v_mfma_f32_16x16x32_bf16 v[112:115], v[40:43], v[28:31], v[112:115]
    v_mfma_f32_16x16x32_bf16 v[148:151], v[40:43], v[32:35], v[148:151]
    s_waitcnt lgkmcnt(6)
    v_mfma_f32_16x16x32_bf16 v[80:83], v[44:47], v[24:27], v[80:83]
    v_mfma_f32_16x16x32_bf16 v[116:119], v[44:47], v[28:31], v[116:119]
    v_mfma_f32_16x16x32_bf16 v[152:155], v[44:47], v[32:35], v[152:155]
    s_waitcnt lgkmcnt(0)
    s_barrier
    v_mfma_f32_16x16x32_bf16 v[84:87], v[48:51], v[24:27], v[84:87]
    ds_read_b64_tr_b16 v[36:37], v4 offset:0
    ds_read_b64_tr_b16 v[38:39], v4 offset:4608
    ds_read_b128 v[12:15], v8 offset:36864
    v_mfma_f32_16x16x32_bf16 v[120:123], v[48:51], v[28:31], v[120:123]
    ds_read_b128 v[16:19], v8 offset:37888
    ds_read_b128 v[20:23], v8 offset:38912
    ds_read_b64_tr_b16 v[40:41], v5 offset:32
    v_mfma_f32_16x16x32_bf16 v[156:159], v[48:51], v[32:35], v[156:159]
    ds_read_b64_tr_b16 v[42:43], v5 offset:4640
    ds_read_b64_tr_b16 v[44:45], v4 offset:64
    v_mfma_f32_16x16x32_bf16 v[88:91], v[52:55], v[24:27], v[88:91]
    ds_read_b64_tr_b16 v[46:47], v4 offset:4672
    ds_read_b64_tr_b16 v[48:49], v5 offset:96
    v_mfma_f32_16x16x32_bf16 v[124:127], v[52:55], v[28:31], v[124:127]
    ds_read_b64_tr_b16 v[50:51], v5 offset:4704
    v_mfma_f32_16x16x32_bf16 v[160:163], v[52:55], v[32:35], v[160:163]
    v_mfma_f32_16x16x32_bf16 v[92:95], v[56:59], v[24:27], v[92:95]
    ds_read_b64_tr_b16 v[52:53], v4 offset:128
    v_mfma_f32_16x16x32_bf16 v[128:131], v[56:59], v[28:31], v[128:131]
    ds_read_b64_tr_b16 v[54:55], v4 offset:4736
    v_mfma_f32_16x16x32_bf16 v[164:167], v[56:59], v[32:35], v[164:167]
    s_waitcnt lgkmcnt(10)
    v_mfma_f32_16x16x32_bf16 v[60:63], v[36:39], v[12:15], v[60:63]
    ds_read_b64_tr_b16 v[56:57], v5 offset:160
    s_waitcnt lgkmcnt(10)
    v_mfma_f32_16x16x32_bf16 v[96:99], v[36:39], v[16:19], v[96:99]
    ds_read_b64_tr_b16 v[58:59], v5 offset:4768
    s_waitcnt lgkmcnt(10)
    v_mfma_f32_16x16x32_bf16 v[132:135], v[36:39], v[20:23], v[132:135]
    s_waitcnt lgkmcnt(8)
    v_mfma_f32_16x16x32_bf16 v[64:67], v[40:43], v[12:15], v[64:67]
    ds_read_b128 v[24:27], v8 offset:43008
    ds_read_b128 v[28:31], v8 offset:44032
    ds_read_b128 v[32:35], v8 offset:45056
    v_mfma_f32_16x16x32_bf16 v[100:103], v[40:43], v[16:19], v[100:103]
    ds_read_b64_tr_b16 v[36:37], v4 offset:192
    v_mfma_f32_16x16x32_bf16 v[136:139], v[40:43], v[20:23], v[136:139]
    ds_read_b64_tr_b16 v[38:39], v4 offset:4800
    s_waitcnt lgkmcnt(11)
    v_mfma_f32_16x16x32_bf16 v[68:71], v[44:47], v[12:15], v[68:71]
    ds_read_b64_tr_b16 v[40:41], v5 offset:224
    v_mfma_f32_16x16x32_bf16 v[104:107], v[44:47], v[16:19], v[104:107]
    ds_read_b64_tr_b16 v[42:43], v5 offset:4832
    v_mfma_f32_16x16x32_bf16 v[140:143], v[44:47], v[20:23], v[140:143]
    s_waitcnt lgkmcnt(11)
    v_mfma_f32_16x16x32_bf16 v[72:75], v[48:51], v[12:15], v[72:75]
    ds_read_b64_tr_b16 v[44:45], v4 offset:256
    v_mfma_f32_16x16x32_bf16 v[108:111], v[48:51], v[16:19], v[108:111]
    ds_read_b64_tr_b16 v[46:47], v4 offset:4864
    v_mfma_f32_16x16x32_bf16 v[144:147], v[48:51], v[20:23], v[144:147]
    s_waitcnt lgkmcnt(11)
    v_mfma_f32_16x16x32_bf16 v[76:79], v[52:55], v[12:15], v[76:79]
    ds_read_b64_tr_b16 v[48:49], v4 offset:18432
    v_mfma_f32_16x16x32_bf16 v[112:115], v[52:55], v[16:19], v[112:115]
    ds_read_b64_tr_b16 v[50:51], v4 offset:23040
    v_mfma_f32_16x16x32_bf16 v[148:151], v[52:55], v[20:23], v[148:151]
    s_waitcnt lgkmcnt(11)
    v_mfma_f32_16x16x32_bf16 v[80:83], v[56:59], v[12:15], v[80:83]
    ds_read_b64_tr_b16 v[52:53], v5 offset:18464
    v_mfma_f32_16x16x32_bf16 v[116:119], v[56:59], v[16:19], v[116:119]
    ds_read_b64_tr_b16 v[54:55], v5 offset:23072
    v_mfma_f32_16x16x32_bf16 v[152:155], v[56:59], v[20:23], v[152:155]
    s_waitcnt lgkmcnt(8)
    v_mfma_f32_16x16x32_bf16 v[84:87], v[36:39], v[12:15], v[84:87]
    ds_read_b64_tr_b16 v[56:57], v4 offset:18496
    v_mfma_f32_16x16x32_bf16 v[120:123], v[36:39], v[16:19], v[120:123]
    ds_read_b64_tr_b16 v[58:59], v4 offset:23104
    v_mfma_f32_16x16x32_bf16 v[156:159], v[36:39], v[20:23], v[156:159]
    s_waitcnt lgkmcnt(8)
    v_mfma_f32_16x16x32_bf16 v[88:91], v[40:43], v[12:15], v[88:91]
    ds_read_b64_tr_b16 v[36:37], v5 offset:18528
    v_mfma_f32_16x16x32_bf16 v[124:127], v[40:43], v[16:19], v[124:127]
    ds_read_b64_tr_b16 v[38:39], v5 offset:23136
    v_mfma_f32_16x16x32_bf16 v[160:163], v[40:43], v[20:23], v[160:163]
    s_waitcnt lgkmcnt(8)
    v_mfma_f32_16x16x32_bf16 v[92:95], v[44:47], v[12:15], v[92:95]
    ds_read_b64_tr_b16 v[40:41], v4 offset:18560
    v_mfma_f32_16x16x32_bf16 v[128:131], v[44:47], v[16:19], v[128:131]
    ds_read_b64_tr_b16 v[42:43], v4 offset:23168
    v_mfma_f32_16x16x32_bf16 v[164:167], v[44:47], v[20:23], v[164:167]
    s_waitcnt lgkmcnt(8)
    v_mfma_f32_16x16x32_bf16 v[60:63], v[48:51], v[24:27], v[60:63]
    ds_read_b64_tr_b16 v[44:45], v5 offset:18592
    v_mfma_f32_16x16x32_bf16 v[96:99], v[48:51], v[28:31], v[96:99]
    ds_read_b64_tr_b16 v[46:47], v5 offset:23200
    v_mfma_f32_16x16x32_bf16 v[132:135], v[48:51], v[32:35], v[132:135]
    s_waitcnt lgkmcnt(8)
    v_mfma_f32_16x16x32_bf16 v[64:67], v[52:55], v[24:27], v[64:67]
    ds_read_b64_tr_b16 v[48:49], v4 offset:18624
    v_mfma_f32_16x16x32_bf16 v[100:103], v[52:55], v[28:31], v[100:103]
    ds_read_b64_tr_b16 v[50:51], v4 offset:23232
    v_mfma_f32_16x16x32_bf16 v[136:139], v[52:55], v[32:35], v[136:139]
    s_waitcnt lgkmcnt(8)
    v_mfma_f32_16x16x32_bf16 v[68:71], v[56:59], v[24:27], v[68:71]
    ds_read_b64_tr_b16 v[52:53], v5 offset:18656
    v_mfma_f32_16x16x32_bf16 v[104:107], v[56:59], v[28:31], v[104:107]
    ds_read_b64_tr_b16 v[54:55], v5 offset:23264
    v_mfma_f32_16x16x32_bf16 v[140:143], v[56:59], v[32:35], v[140:143]
    s_waitcnt lgkmcnt(8)
    v_mfma_f32_16x16x32_bf16 v[72:75], v[36:39], v[24:27], v[72:75]
    ds_read_b64_tr_b16 v[56:57], v4 offset:18688
    v_mfma_f32_16x16x32_bf16 v[108:111], v[36:39], v[28:31], v[108:111]
    ds_read_b64_tr_b16 v[58:59], v4 offset:23296
    v_mfma_f32_16x16x32_bf16 v[144:147], v[36:39], v[32:35], v[144:147]
    s_waitcnt lgkmcnt(8)
    v_mfma_f32_16x16x32_bf16 v[76:79], v[40:43], v[24:27], v[76:79]
    v_mfma_f32_16x16x32_bf16 v[112:115], v[40:43], v[28:31], v[112:115]
    v_mfma_f32_16x16x32_bf16 v[148:151], v[40:43], v[32:35], v[148:151]
    s_waitcnt lgkmcnt(6)
    v_mfma_f32_16x16x32_bf16 v[80:83], v[44:47], v[24:27], v[80:83]
    v_mfma_f32_16x16x32_bf16 v[116:119], v[44:47], v[28:31], v[116:119]
    v_mfma_f32_16x16x32_bf16 v[152:155], v[44:47], v[32:35], v[152:155]
    s_waitcnt lgkmcnt(0)
    s_barrier
    v_mfma_f32_16x16x32_bf16 v[84:87], v[48:51], v[24:27], v[84:87]
    ds_read_b64_tr_b16 v[36:37], v4 offset:36864
    ds_read_b64_tr_b16 v[38:39], v4 offset:41472
    ds_read_b128 v[12:15], v8 offset:0
    v_mfma_f32_16x16x32_bf16 v[120:123], v[48:51], v[28:31], v[120:123]
    ds_read_b128 v[16:19], v8 offset:1024
    ds_read_b128 v[20:23], v8 offset:2048
    ds_read_b64_tr_b16 v[40:41], v5 offset:36896
    v_mfma_f32_16x16x32_bf16 v[156:159], v[48:51], v[32:35], v[156:159]
    ds_read_b64_tr_b16 v[42:43], v5 offset:41504
    ds_read_b64_tr_b16 v[44:45], v4 offset:36928
    v_mfma_f32_16x16x32_bf16 v[88:91], v[52:55], v[24:27], v[88:91]
    ds_read_b64_tr_b16 v[46:47], v4 offset:41536
    ds_read_b64_tr_b16 v[48:49], v5 offset:36960
    v_mfma_f32_16x16x32_bf16 v[124:127], v[52:55], v[28:31], v[124:127]
    ds_read_b64_tr_b16 v[50:51], v5 offset:41568
    v_mfma_f32_16x16x32_bf16 v[160:163], v[52:55], v[32:35], v[160:163]
    v_mfma_f32_16x16x32_bf16 v[92:95], v[56:59], v[24:27], v[92:95]
    ds_read_b64_tr_b16 v[52:53], v4 offset:36992
    v_mfma_f32_16x16x32_bf16 v[128:131], v[56:59], v[28:31], v[128:131]
    ds_read_b64_tr_b16 v[54:55], v4 offset:41600
    v_mfma_f32_16x16x32_bf16 v[164:167], v[56:59], v[32:35], v[164:167]
    s_waitcnt lgkmcnt(10)
    v_mfma_f32_16x16x32_bf16 v[60:63], v[36:39], v[12:15], v[60:63]
    ds_read_b64_tr_b16 v[56:57], v5 offset:37024
    s_waitcnt lgkmcnt(10)
    v_mfma_f32_16x16x32_bf16 v[96:99], v[36:39], v[16:19], v[96:99]
    ds_read_b64_tr_b16 v[58:59], v5 offset:41632
    s_waitcnt lgkmcnt(10)
    v_mfma_f32_16x16x32_bf16 v[132:135], v[36:39], v[20:23], v[132:135]
    s_waitcnt lgkmcnt(8)
    v_mfma_f32_16x16x32_bf16 v[64:67], v[40:43], v[12:15], v[64:67]
    ds_read_b128 v[24:27], v8 offset:6144
    ds_read_b128 v[28:31], v8 offset:7168
    ds_read_b128 v[32:35], v8 offset:8192
    v_mfma_f32_16x16x32_bf16 v[100:103], v[40:43], v[16:19], v[100:103]
    ds_read_b64_tr_b16 v[36:37], v4 offset:37056
    v_mfma_f32_16x16x32_bf16 v[136:139], v[40:43], v[20:23], v[136:139]
    ds_read_b64_tr_b16 v[38:39], v4 offset:41664
    s_waitcnt lgkmcnt(11)
    v_mfma_f32_16x16x32_bf16 v[68:71], v[44:47], v[12:15], v[68:71]
    ds_read_b64_tr_b16 v[40:41], v5 offset:37088
    v_mfma_f32_16x16x32_bf16 v[104:107], v[44:47], v[16:19], v[104:107]
    ds_read_b64_tr_b16 v[42:43], v5 offset:41696
    v_mfma_f32_16x16x32_bf16 v[140:143], v[44:47], v[20:23], v[140:143]
    s_waitcnt lgkmcnt(11)
    v_mfma_f32_16x16x32_bf16 v[72:75], v[48:51], v[12:15], v[72:75]
    ds_read_b64_tr_b16 v[44:45], v4 offset:37120
    v_mfma_f32_16x16x32_bf16 v[108:111], v[48:51], v[16:19], v[108:111]
    ds_read_b64_tr_b16 v[46:47], v4 offset:41728
    v_mfma_f32_16x16x32_bf16 v[144:147], v[48:51], v[20:23], v[144:147]
    s_waitcnt lgkmcnt(11)
    v_mfma_f32_16x16x32_bf16 v[76:79], v[52:55], v[12:15], v[76:79]
    ds_read_b64_tr_b16 v[48:49], v4 offset:55296
    v_mfma_f32_16x16x32_bf16 v[112:115], v[52:55], v[16:19], v[112:115]
    ds_read_b64_tr_b16 v[50:51], v4 offset:59904
    v_mfma_f32_16x16x32_bf16 v[148:151], v[52:55], v[20:23], v[148:151]
    s_waitcnt lgkmcnt(11)
    v_mfma_f32_16x16x32_bf16 v[80:83], v[56:59], v[12:15], v[80:83]
    ds_read_b64_tr_b16 v[52:53], v5 offset:55328
    v_mfma_f32_16x16x32_bf16 v[116:119], v[56:59], v[16:19], v[116:119]
    ds_read_b64_tr_b16 v[54:55], v5 offset:59936
    v_mfma_f32_16x16x32_bf16 v[152:155], v[56:59], v[20:23], v[152:155]
    s_waitcnt lgkmcnt(8)
    v_mfma_f32_16x16x32_bf16 v[84:87], v[36:39], v[12:15], v[84:87]
    ds_read_b64_tr_b16 v[56:57], v4 offset:55360
    v_mfma_f32_16x16x32_bf16 v[120:123], v[36:39], v[16:19], v[120:123]
    ds_read_b64_tr_b16 v[58:59], v4 offset:59968
    v_mfma_f32_16x16x32_bf16 v[156:159], v[36:39], v[20:23], v[156:159]
    s_waitcnt lgkmcnt(8)
    v_mfma_f32_16x16x32_bf16 v[88:91], v[40:43], v[12:15], v[88:91]
    ds_read_b64_tr_b16 v[36:37], v5 offset:55392
    v_mfma_f32_16x16x32_bf16 v[124:127], v[40:43], v[16:19], v[124:127]
    ds_read_b64_tr_b16 v[38:39], v5 offset:60000
    v_mfma_f32_16x16x32_bf16 v[160:163], v[40:43], v[20:23], v[160:163]
    s_waitcnt lgkmcnt(8)
    v_mfma_f32_16x16x32_bf16 v[92:95], v[44:47], v[12:15], v[92:95]
    ds_read_b64_tr_b16 v[40:41], v4 offset:55424
    v_mfma_f32_16x16x32_bf16 v[128:131], v[44:47], v[16:19], v[128:131]
    ds_read_b64_tr_b16 v[42:43], v4 offset:60032
    v_mfma_f32_16x16x32_bf16 v[164:167], v[44:47], v[20:23], v[164:167]
    s_waitcnt lgkmcnt(8)
    v_mfma_f32_16x16x32_bf16 v[60:63], v[48:51], v[24:27], v[60:63]
    ds_read_b64_tr_b16 v[44:45], v5 offset:55456
    v_mfma_f32_16x16x32_bf16 v[96:99], v[48:51], v[28:31], v[96:99]
    ds_read_b64_tr_b16 v[46:47], v5 offset:60064
    v_mfma_f32_16x16x32_bf16 v[132:135], v[48:51], v[32:35], v[132:135]
    s_waitcnt lgkmcnt(8)
    v_mfma_f32_16x16x32_bf16 v[64:67], v[52:55], v[24:27], v[64:67]
    ds_read_b64_tr_b16 v[48:49], v4 offset:55488
    v_mfma_f32_16x16x32_bf16 v[100:103], v[52:55], v[28:31], v[100:103]
    ds_read_b64_tr_b16 v[50:51], v4 offset:60096
    v_mfma_f32_16x16x32_bf16 v[136:139], v[52:55], v[32:35], v[136:139]
    s_waitcnt lgkmcnt(8)
    v_mfma_f32_16x16x32_bf16 v[68:71], v[56:59], v[24:27], v[68:71]
    ds_read_b64_tr_b16 v[52:53], v5 offset:55520
    v_mfma_f32_16x16x32_bf16 v[104:107], v[56:59], v[28:31], v[104:107]
    ds_read_b64_tr_b16 v[54:55], v5 offset:60128
    v_mfma_f32_16x16x32_bf16 v[140:143], v[56:59], v[32:35], v[140:143]
    s_waitcnt lgkmcnt(8)
    v_mfma_f32_16x16x32_bf16 v[72:75], v[36:39], v[24:27], v[72:75]
    ds_read_b64_tr_b16 v[56:57], v4 offset:55552
    v_mfma_f32_16x16x32_bf16 v[108:111], v[36:39], v[28:31], v[108:111]
    ds_read_b64_tr_b16 v[58:59], v4 offset:60160
    v_mfma_f32_16x16x32_bf16 v[144:147], v[36:39], v[32:35], v[144:147]
    s_waitcnt lgkmcnt(8)
    v_mfma_f32_16x16x32_bf16 v[76:79], v[40:43], v[24:27], v[76:79]
    v_mfma_f32_16x16x32_bf16 v[112:115], v[40:43], v[28:31], v[112:115]
    v_mfma_f32_16x16x32_bf16 v[148:151], v[40:43], v[32:35], v[148:151]
    s_waitcnt lgkmcnt(6)
    v_mfma_f32_16x16x32_bf16 v[80:83], v[44:47], v[24:27], v[80:83]
    v_mfma_f32_16x16x32_bf16 v[116:119], v[44:47], v[28:31], v[116:119]
    v_mfma_f32_16x16x32_bf16 v[152:155], v[44:47], v[32:35], v[152:155]
    s_waitcnt lgkmcnt(0)
    s_barrier
    v_mfma_f32_16x16x32_bf16 v[84:87], v[48:51], v[24:27], v[84:87]
    ds_read_b64_tr_b16 v[36:37], v6 offset:0
    ds_read_b64_tr_b16 v[38:39], v6 offset:4608
    ds_read_b128 v[12:15], v8 offset:12288
    v_mfma_f32_16x16x32_bf16 v[120:123], v[48:51], v[28:31], v[120:123]
    ds_read_b128 v[16:19], v8 offset:13312
    ds_read_b128 v[20:23], v8 offset:14336
    ds_read_b64_tr_b16 v[40:41], v7 offset:32
    v_mfma_f32_16x16x32_bf16 v[156:159], v[48:51], v[32:35], v[156:159]
    ds_read_b64_tr_b16 v[42:43], v7 offset:4640
    ds_read_b64_tr_b16 v[44:45], v6 offset:64
    v_mfma_f32_16x16x32_bf16 v[88:91], v[52:55], v[24:27], v[88:91]
    ds_read_b64_tr_b16 v[46:47], v6 offset:4672
    ds_read_b64_tr_b16 v[48:49], v7 offset:96
    v_mfma_f32_16x16x32_bf16 v[124:127], v[52:55], v[28:31], v[124:127]
    ds_read_b64_tr_b16 v[50:51], v7 offset:4704
    v_mfma_f32_16x16x32_bf16 v[160:163], v[52:55], v[32:35], v[160:163]
    v_mfma_f32_16x16x32_bf16 v[92:95], v[56:59], v[24:27], v[92:95]
    ds_read_b64_tr_b16 v[52:53], v6 offset:128
    v_mfma_f32_16x16x32_bf16 v[128:131], v[56:59], v[28:31], v[128:131]
    ds_read_b64_tr_b16 v[54:55], v6 offset:4736
    v_mfma_f32_16x16x32_bf16 v[164:167], v[56:59], v[32:35], v[164:167]
    s_waitcnt lgkmcnt(10)
    v_mfma_f32_16x16x32_bf16 v[60:63], v[36:39], v[12:15], v[60:63]
    ds_read_b64_tr_b16 v[56:57], v7 offset:160
    s_waitcnt lgkmcnt(10)
    v_mfma_f32_16x16x32_bf16 v[96:99], v[36:39], v[16:19], v[96:99]
    ds_read_b64_tr_b16 v[58:59], v7 offset:4768
    s_waitcnt lgkmcnt(10)
    v_mfma_f32_16x16x32_bf16 v[132:135], v[36:39], v[20:23], v[132:135]
    s_waitcnt lgkmcnt(8)
    v_mfma_f32_16x16x32_bf16 v[64:67], v[40:43], v[12:15], v[64:67]
    ds_read_b128 v[24:27], v8 offset:18432
    ds_read_b128 v[28:31], v8 offset:19456
    ds_read_b128 v[32:35], v8 offset:20480
    v_mfma_f32_16x16x32_bf16 v[100:103], v[40:43], v[16:19], v[100:103]
    ds_read_b64_tr_b16 v[36:37], v6 offset:192
    v_mfma_f32_16x16x32_bf16 v[136:139], v[40:43], v[20:23], v[136:139]
    ds_read_b64_tr_b16 v[38:39], v6 offset:4800
    s_waitcnt lgkmcnt(11)
    v_mfma_f32_16x16x32_bf16 v[68:71], v[44:47], v[12:15], v[68:71]
    ds_read_b64_tr_b16 v[40:41], v7 offset:224
    v_mfma_f32_16x16x32_bf16 v[104:107], v[44:47], v[16:19], v[104:107]
    ds_read_b64_tr_b16 v[42:43], v7 offset:4832
    v_mfma_f32_16x16x32_bf16 v[140:143], v[44:47], v[20:23], v[140:143]
    s_waitcnt lgkmcnt(11)
    v_mfma_f32_16x16x32_bf16 v[72:75], v[48:51], v[12:15], v[72:75]
    ds_read_b64_tr_b16 v[44:45], v6 offset:256
    v_mfma_f32_16x16x32_bf16 v[108:111], v[48:51], v[16:19], v[108:111]
    ds_read_b64_tr_b16 v[46:47], v6 offset:4864
    v_mfma_f32_16x16x32_bf16 v[144:147], v[48:51], v[20:23], v[144:147]
    s_waitcnt lgkmcnt(11)
    v_mfma_f32_16x16x32_bf16 v[76:79], v[52:55], v[12:15], v[76:79]
    ds_read_b64_tr_b16 v[48:49], v6 offset:18432
    v_mfma_f32_16x16x32_bf16 v[112:115], v[52:55], v[16:19], v[112:115]
    ds_read_b64_tr_b16 v[50:51], v6 offset:23040
    v_mfma_f32_16x16x32_bf16 v[148:151], v[52:55], v[20:23], v[148:151]
    s_waitcnt lgkmcnt(11)
    v_mfma_f32_16x16x32_bf16 v[80:83], v[56:59], v[12:15], v[80:83]
    ds_read_b64_tr_b16 v[52:53], v7 offset:18464
    v_mfma_f32_16x16x32_bf16 v[116:119], v[56:59], v[16:19], v[116:119]
    ds_read_b64_tr_b16 v[54:55], v7 offset:23072
    v_mfma_f32_16x16x32_bf16 v[152:155], v[56:59], v[20:23], v[152:155]
    s_waitcnt lgkmcnt(8)
    v_mfma_f32_16x16x32_bf16 v[84:87], v[36:39], v[12:15], v[84:87]
    ds_read_b64_tr_b16 v[56:57], v6 offset:18496
    v_mfma_f32_16x16x32_bf16 v[120:123], v[36:39], v[16:19], v[120:123]
    ds_read_b64_tr_b16 v[58:59], v6 offset:23104
    v_mfma_f32_16x16x32_bf16 v[156:159], v[36:39], v[20:23], v[156:159]
    s_waitcnt lgkmcnt(8)
    v_mfma_f32_16x16x32_bf16 v[88:91], v[40:43], v[12:15], v[88:91]
    ds_read_b64_tr_b16 v[36:37], v7 offset:18528
    v_mfma_f32_16x16x32_bf16 v[124:127], v[40:43], v[16:19], v[124:127]
    ds_read_b64_tr_b16 v[38:39], v7 offset:23136
    v_mfma_f32_16x16x32_bf16 v[160:163], v[40:43], v[20:23], v[160:163]
    s_waitcnt lgkmcnt(8)
    v_mfma_f32_16x16x32_bf16 v[92:95], v[44:47], v[12:15], v[92:95]
    ds_read_b64_tr_b16 v[40:41], v6 offset:18560
    v_mfma_f32_16x16x32_bf16 v[128:131], v[44:47], v[16:19], v[128:131]
    ds_read_b64_tr_b16 v[42:43], v6 offset:23168
    v_mfma_f32_16x16x32_bf16 v[164:167], v[44:47], v[20:23], v[164:167]
    s_waitcnt lgkmcnt(8)
    v_mfma_f32_16x16x32_bf16 v[60:63], v[48:51], v[24:27], v[60:63]
    ds_read_b64_tr_b16 v[44:45], v7 offset:18592
    v_mfma_f32_16x16x32_bf16 v[96:99], v[48:51], v[28:31], v[96:99]
    ds_read_b64_tr_b16 v[46:47], v7 offset:23200
    v_mfma_f32_16x16x32_bf16 v[132:135], v[48:51], v[32:35], v[132:135]
    s_waitcnt lgkmcnt(8)
    v_mfma_f32_16x16x32_bf16 v[64:67], v[52:55], v[24:27], v[64:67]
    ds_read_b64_tr_b16 v[48:49], v6 offset:18624
    v_mfma_f32_16x16x32_bf16 v[100:103], v[52:55], v[28:31], v[100:103]
    ds_read_b64_tr_b16 v[50:51], v6 offset:23232
    v_mfma_f32_16x16x32_bf16 v[136:139], v[52:55], v[32:35], v[136:139]
    s_waitcnt lgkmcnt(8)
    v_mfma_f32_16x16x32_bf16 v[68:71], v[56:59], v[24:27], v[68:71]
    ds_read_b64_tr_b16 v[52:53], v7 offset:18656
    v_mfma_f32_16x16x32_bf16 v[104:107], v[56:59], v[28:31], v[104:107]
    ds_read_b64_tr_b16 v[54:55], v7 offset:23264
    v_mfma_f32_16x16x32_bf16 v[140:143], v[56:59], v[32:35], v[140:143]
    s_waitcnt lgkmcnt(8)
    v_mfma_f32_16x16x32_bf16 v[72:75], v[36:39], v[24:27], v[72:75]
    ds_read_b64_tr_b16 v[56:57], v6 offset:18688
    v_mfma_f32_16x16x32_bf16 v[108:111], v[36:39], v[28:31], v[108:111]
    ds_read_b64_tr_b16 v[58:59], v6 offset:23296
    v_mfma_f32_16x16x32_bf16 v[144:147], v[36:39], v[32:35], v[144:147]
    s_waitcnt lgkmcnt(8)
    v_mfma_f32_16x16x32_bf16 v[76:79], v[40:43], v[24:27], v[76:79]
    v_mfma_f32_16x16x32_bf16 v[112:115], v[40:43], v[28:31], v[112:115]
    v_mfma_f32_16x16x32_bf16 v[148:151], v[40:43], v[32:35], v[148:151]
    s_waitcnt lgkmcnt(6)
    v_mfma_f32_16x16x32_bf16 v[80:83], v[44:47], v[24:27], v[80:83]
    v_mfma_f32_16x16x32_bf16 v[116:119], v[44:47], v[28:31], v[116:119]
    v_mfma_f32_16x16x32_bf16 v[152:155], v[44:47], v[32:35], v[152:155]
    s_waitcnt lgkmcnt(0)
    s_barrier
    v_mfma_f32_16x16x32_bf16 v[84:87], v[48:51], v[24:27], v[84:87]
    ds_read_b64_tr_b16 v[36:37], v4 offset:0
    ds_read_b64_tr_b16 v[38:39], v4 offset:4608
    ds_read_b128 v[12:15], v8 offset:24576
    v_mfma_f32_16x16x32_bf16 v[120:123], v[48:51], v[28:31], v[120:123]
    ds_read_b128 v[16:19], v8 offset:25600
    ds_read_b128 v[20:23], v8 offset:26624
    ds_read_b64_tr_b16 v[40:41], v5 offset:32
    v_mfma_f32_16x16x32_bf16 v[156:159], v[48:51], v[32:35], v[156:159]
    ds_read_b64_tr_b16 v[42:43], v5 offset:4640
    ds_read_b64_tr_b16 v[44:45], v4 offset:64
    v_mfma_f32_16x16x32_bf16 v[88:91], v[52:55], v[24:27], v[88:91]
    ds_read_b64_tr_b16 v[46:47], v4 offset:4672
    ds_read_b64_tr_b16 v[48:49], v5 offset:96
    v_mfma_f32_16x16x32_bf16 v[124:127], v[52:55], v[28:31], v[124:127]
    ds_read_b64_tr_b16 v[50:51], v5 offset:4704
    v_mfma_f32_16x16x32_bf16 v[160:163], v[52:55], v[32:35], v[160:163]
    v_mfma_f32_16x16x32_bf16 v[92:95], v[56:59], v[24:27], v[92:95]
    ds_read_b64_tr_b16 v[52:53], v4 offset:128
    v_mfma_f32_16x16x32_bf16 v[128:131], v[56:59], v[28:31], v[128:131]
    ds_read_b64_tr_b16 v[54:55], v4 offset:4736
    v_mfma_f32_16x16x32_bf16 v[164:167], v[56:59], v[32:35], v[164:167]
    s_waitcnt lgkmcnt(10)
    v_mfma_f32_16x16x32_bf16 v[60:63], v[36:39], v[12:15], v[60:63]
    ds_read_b64_tr_b16 v[56:57], v5 offset:160
    s_waitcnt lgkmcnt(10)
    v_mfma_f32_16x16x32_bf16 v[96:99], v[36:39], v[16:19], v[96:99]
    ds_read_b64_tr_b16 v[58:59], v5 offset:4768
    s_waitcnt lgkmcnt(10)
    v_mfma_f32_16x16x32_bf16 v[132:135], v[36:39], v[20:23], v[132:135]
    s_waitcnt lgkmcnt(8)
    v_mfma_f32_16x16x32_bf16 v[64:67], v[40:43], v[12:15], v[64:67]
    ds_read_b128 v[24:27], v8 offset:30720
    ds_read_b128 v[28:31], v8 offset:31744
    ds_read_b128 v[32:35], v8 offset:32768
    v_mfma_f32_16x16x32_bf16 v[100:103], v[40:43], v[16:19], v[100:103]
    ds_read_b64_tr_b16 v[36:37], v4 offset:192
    v_mfma_f32_16x16x32_bf16 v[136:139], v[40:43], v[20:23], v[136:139]
    ds_read_b64_tr_b16 v[38:39], v4 offset:4800
    s_waitcnt lgkmcnt(11)
    v_mfma_f32_16x16x32_bf16 v[68:71], v[44:47], v[12:15], v[68:71]
    ds_read_b64_tr_b16 v[40:41], v5 offset:224
    v_mfma_f32_16x16x32_bf16 v[104:107], v[44:47], v[16:19], v[104:107]
    ds_read_b64_tr_b16 v[42:43], v5 offset:4832
    v_mfma_f32_16x16x32_bf16 v[140:143], v[44:47], v[20:23], v[140:143]
    s_waitcnt lgkmcnt(11)
    v_mfma_f32_16x16x32_bf16 v[72:75], v[48:51], v[12:15], v[72:75]
    ds_read_b64_tr_b16 v[44:45], v4 offset:256
    v_mfma_f32_16x16x32_bf16 v[108:111], v[48:51], v[16:19], v[108:111]
    ds_read_b64_tr_b16 v[46:47], v4 offset:4864
    v_mfma_f32_16x16x32_bf16 v[144:147], v[48:51], v[20:23], v[144:147]
    s_waitcnt lgkmcnt(11)
    v_mfma_f32_16x16x32_bf16 v[76:79], v[52:55], v[12:15], v[76:79]
    ds_read_b64_tr_b16 v[48:49], v4 offset:18432
    v_mfma_f32_16x16x32_bf16 v[112:115], v[52:55], v[16:19], v[112:115]
    ds_read_b64_tr_b16 v[50:51], v4 offset:23040
    v_mfma_f32_16x16x32_bf16 v[148:151], v[52:55], v[20:23], v[148:151]
    s_waitcnt lgkmcnt(11)
    v_mfma_f32_16x16x32_bf16 v[80:83], v[56:59], v[12:15], v[80:83]
    ds_read_b64_tr_b16 v[52:53], v5 offset:18464
    v_mfma_f32_16x16x32_bf16 v[116:119], v[56:59], v[16:19], v[116:119]
    ds_read_b64_tr_b16 v[54:55], v5 offset:23072
    v_mfma_f32_16x16x32_bf16 v[152:155], v[56:59], v[20:23], v[152:155]
    s_waitcnt lgkmcnt(8)
    v_mfma_f32_16x16x32_bf16 v[84:87], v[36:39], v[12:15], v[84:87]
    ds_read_b64_tr_b16 v[56:57], v4 offset:18496
    v_mfma_f32_16x16x32_bf16 v[120:123], v[36:39], v[16:19], v[120:123]
    ds_read_b64_tr_b16 v[58:59], v4 offset:23104
    v_mfma_f32_16x16x32_bf16 v[156:159], v[36:39], v[20:23], v[156:159]
    s_waitcnt lgkmcnt(8)
    v_mfma_f32_16x16x32_bf16 v[88:91], v[40:43], v[12:15], v[88:91]
    ds_read_b64_tr_b16 v[36:37], v5 offset:18528
    v_mfma_f32_16x16x32_bf16 v[124:127], v[40:43], v[16:19], v[124:127]
    ds_read_b64_tr_b16 v[38:39], v5 offset:23136
    v_mfma_f32_16x16x32_bf16 v[160:163], v[40:43], v[20:23], v[160:163]
    s_waitcnt lgkmcnt(8)
    v_mfma_f32_16x16x32_bf16 v[92:95], v[44:47], v[12:15], v[92:95]
    ds_read_b64_tr_b16 v[40:41], v4 offset:18560
    v_mfma_f32_16x16x32_bf16 v[128:131], v[44:47], v[16:19], v[128:131]
    ds_read_b64_tr_b16 v[42:43], v4 offset:23168
    v_mfma_f32_16x16x32_bf16 v[164:167], v[44:47], v[20:23], v[164:167]
    s_waitcnt lgkmcnt(8)
    v_mfma_f32_16x16x32_bf16 v[60:63], v[48:51], v[24:27], v[60:63]
    ds_read_b64_tr_b16 v[44:45], v5 offset:18592
    v_mfma_f32_16x16x32_bf16 v[96:99], v[48:51], v[28:31], v[96:99]
    ds_read_b64_tr_b16 v[46:47], v5 offset:23200
    v_mfma_f32_16x16x32_bf16 v[132:135], v[48:51], v[32:35], v[132:135]
    s_waitcnt lgkmcnt(8)
    v_mfma_f32_16x16x32_bf16 v[64:67], v[52:55], v[24:27], v[64:67]
    ds_read_b64_tr_b16 v[48:49], v4 offset:18624
    v_mfma_f32_16x16x32_bf16 v[100:103], v[52:55], v[28:31], v[100:103]
    ds_read_b64_tr_b16 v[50:51], v4 offset:23232
    v_mfma_f32_16x16x32_bf16 v[136:139], v[52:55], v[32:35], v[136:139]
    s_waitcnt lgkmcnt(8)
    v_mfma_f32_16x16x32_bf16 v[68:71], v[56:59], v[24:27], v[68:71]
    ds_read_b64_tr_b16 v[52:53], v5 offset:18656
    v_mfma_f32_16x16x32_bf16 v[104:107], v[56:59], v[28:31], v[104:107]
    ds_read_b64_tr_b16 v[54:55], v5 offset:23264
    v_mfma_f32_16x16x32_bf16 v[140:143], v[56:59], v[32:35], v[140:143]
    s_waitcnt lgkmcnt(8)
    v_mfma_f32_16x16x32_bf16 v[72:75], v[36:39], v[24:27], v[72:75]
    ds_read_b64_tr_b16 v[56:57], v4 offset:18688
    v_mfma_f32_16x16x32_bf16 v[108:111], v[36:39], v[28:31], v[108:111]
    ds_read_b64_tr_b16 v[58:59], v4 offset:23296
    v_mfma_f32_16x16x32_bf16 v[144:147], v[36:39], v[32:35], v[144:147]
    s_waitcnt lgkmcnt(8)
    v_mfma_f32_16x16x32_bf16 v[76:79], v[40:43], v[24:27], v[76:79]
    v_mfma_f32_16x16x32_bf16 v[112:115], v[40:43], v[28:31], v[112:115]
    v_mfma_f32_16x16x32_bf16 v[148:151], v[40:43], v[32:35], v[148:151]
    s_waitcnt lgkmcnt(6)
    v_mfma_f32_16x16x32_bf16 v[80:83], v[44:47], v[24:27], v[80:83]
    v_mfma_f32_16x16x32_bf16 v[116:119], v[44:47], v[28:31], v[116:119]
    v_mfma_f32_16x16x32_bf16 v[152:155], v[44:47], v[32:35], v[152:155]
    s_waitcnt lgkmcnt(0)
    s_barrier
    v_mfma_f32_16x16x32_bf16 v[84:87], v[48:51], v[24:27], v[84:87]
    ds_read_b64_tr_b16 v[36:37], v4 offset:36864
    ds_read_b64_tr_b16 v[38:39], v4 offset:41472
    ds_read_b128 v[12:15], v8 offset:36864
    v_mfma_f32_16x16x32_bf16 v[120:123], v[48:51], v[28:31], v[120:123]
    ds_read_b128 v[16:19], v8 offset:37888
    ds_read_b128 v[20:23], v8 offset:38912
    ds_read_b64_tr_b16 v[40:41], v5 offset:36896
    v_mfma_f32_16x16x32_bf16 v[156:159], v[48:51], v[32:35], v[156:159]
    ds_read_b64_tr_b16 v[42:43], v5 offset:41504
    ds_read_b64_tr_b16 v[44:45], v4 offset:36928
    v_mfma_f32_16x16x32_bf16 v[88:91], v[52:55], v[24:27], v[88:91]
    ds_read_b64_tr_b16 v[46:47], v4 offset:41536
    ds_read_b64_tr_b16 v[48:49], v5 offset:36960
    v_mfma_f32_16x16x32_bf16 v[124:127], v[52:55], v[28:31], v[124:127]
    ds_read_b64_tr_b16 v[50:51], v5 offset:41568
    v_mfma_f32_16x16x32_bf16 v[160:163], v[52:55], v[32:35], v[160:163]
    v_mfma_f32_16x16x32_bf16 v[92:95], v[56:59], v[24:27], v[92:95]
    ds_read_b64_tr_b16 v[52:53], v4 offset:36992
    v_mfma_f32_16x16x32_bf16 v[128:131], v[56:59], v[28:31], v[128:131]
    ds_read_b64_tr_b16 v[54:55], v4 offset:41600
    v_mfma_f32_16x16x32_bf16 v[164:167], v[56:59], v[32:35], v[164:167]
    s_waitcnt lgkmcnt(10)
    v_mfma_f32_16x16x32_bf16 v[60:63], v[36:39], v[12:15], v[60:63]
    ds_read_b64_tr_b16 v[56:57], v5 offset:37024
    s_waitcnt lgkmcnt(10)
    v_mfma_f32_16x16x32_bf16 v[96:99], v[36:39], v[16:19], v[96:99]
    ds_read_b64_tr_b16 v[58:59], v5 offset:41632
    s_waitcnt lgkmcnt(10)
    v_mfma_f32_16x16x32_bf16 v[132:135], v[36:39], v[20:23], v[132:135]
    s_waitcnt lgkmcnt(8)
    v_mfma_f32_16x16x32_bf16 v[64:67], v[40:43], v[12:15], v[64:67]
    ds_read_b128 v[24:27], v8 offset:43008
    ds_read_b128 v[28:31], v8 offset:44032
    ds_read_b128 v[32:35], v8 offset:45056
    v_mfma_f32_16x16x32_bf16 v[100:103], v[40:43], v[16:19], v[100:103]
    ds_read_b64_tr_b16 v[36:37], v4 offset:37056
    v_mfma_f32_16x16x32_bf16 v[136:139], v[40:43], v[20:23], v[136:139]
    ds_read_b64_tr_b16 v[38:39], v4 offset:41664
    s_waitcnt lgkmcnt(11)
    v_mfma_f32_16x16x32_bf16 v[68:71], v[44:47], v[12:15], v[68:71]
    ds_read_b64_tr_b16 v[40:41], v5 offset:37088
    v_mfma_f32_16x16x32_bf16 v[104:107], v[44:47], v[16:19], v[104:107]
    ds_read_b64_tr_b16 v[42:43], v5 offset:41696
    v_mfma_f32_16x16x32_bf16 v[140:143], v[44:47], v[20:23], v[140:143]
    s_waitcnt lgkmcnt(11)
    v_mfma_f32_16x16x32_bf16 v[72:75], v[48:51], v[12:15], v[72:75]
    ds_read_b64_tr_b16 v[44:45], v4 offset:37120
    v_mfma_f32_16x16x32_bf16 v[108:111], v[48:51], v[16:19], v[108:111]
    ds_read_b64_tr_b16 v[46:47], v4 offset:41728
    v_mfma_f32_16x16x32_bf16 v[144:147], v[48:51], v[20:23], v[144:147]
    s_waitcnt lgkmcnt(11)
    v_mfma_f32_16x16x32_bf16 v[76:79], v[52:55], v[12:15], v[76:79]
    ds_read_b64_tr_b16 v[48:49], v4 offset:55296
    v_mfma_f32_16x16x32_bf16 v[112:115], v[52:55], v[16:19], v[112:115]
    ds_read_b64_tr_b16 v[50:51], v4 offset:59904
    v_mfma_f32_16x16x32_bf16 v[148:151], v[52:55], v[20:23], v[148:151]
    s_waitcnt lgkmcnt(11)
    v_mfma_f32_16x16x32_bf16 v[80:83], v[56:59], v[12:15], v[80:83]
    ds_read_b64_tr_b16 v[52:53], v5 offset:55328
    v_mfma_f32_16x16x32_bf16 v[116:119], v[56:59], v[16:19], v[116:119]
    ds_read_b64_tr_b16 v[54:55], v5 offset:59936
    v_mfma_f32_16x16x32_bf16 v[152:155], v[56:59], v[20:23], v[152:155]
    s_waitcnt lgkmcnt(8)
    v_mfma_f32_16x16x32_bf16 v[84:87], v[36:39], v[12:15], v[84:87]
    ds_read_b64_tr_b16 v[56:57], v4 offset:55360
    v_mfma_f32_16x16x32_bf16 v[120:123], v[36:39], v[16:19], v[120:123]
    ds_read_b64_tr_b16 v[58:59], v4 offset:59968
    v_mfma_f32_16x16x32_bf16 v[156:159], v[36:39], v[20:23], v[156:159]
    s_waitcnt lgkmcnt(8)
    v_mfma_f32_16x16x32_bf16 v[88:91], v[40:43], v[12:15], v[88:91]
    ds_read_b64_tr_b16 v[36:37], v5 offset:55392
    v_mfma_f32_16x16x32_bf16 v[124:127], v[40:43], v[16:19], v[124:127]
    ds_read_b64_tr_b16 v[38:39], v5 offset:60000
    v_mfma_f32_16x16x32_bf16 v[160:163], v[40:43], v[20:23], v[160:163]
    s_waitcnt lgkmcnt(8)
    v_mfma_f32_16x16x32_bf16 v[92:95], v[44:47], v[12:15], v[92:95]
    ds_read_b64_tr_b16 v[40:41], v4 offset:55424
    v_mfma_f32_16x16x32_bf16 v[128:131], v[44:47], v[16:19], v[128:131]
    ds_read_b64_tr_b16 v[42:43], v4 offset:60032
    v_mfma_f32_16x16x32_bf16 v[164:167], v[44:47], v[20:23], v[164:167]
    s_waitcnt lgkmcnt(8)
    v_mfma_f32_16x16x32_bf16 v[60:63], v[48:51], v[24:27], v[60:63]
    ds_read_b64_tr_b16 v[44:45], v5 offset:55456
    v_mfma_f32_16x16x32_bf16 v[96:99], v[48:51], v[28:31], v[96:99]
    ds_read_b64_tr_b16 v[46:47], v5 offset:60064
    v_mfma_f32_16x16x32_bf16 v[132:135], v[48:51], v[32:35], v[132:135]
    s_waitcnt lgkmcnt(8)
    v_mfma_f32_16x16x32_bf16 v[64:67], v[52:55], v[24:27], v[64:67]
    ds_read_b64_tr_b16 v[48:49], v4 offset:55488
    v_mfma_f32_16x16x32_bf16 v[100:103], v[52:55], v[28:31], v[100:103]
    ds_read_b64_tr_b16 v[50:51], v4 offset:60096
    v_mfma_f32_16x16x32_bf16 v[136:139], v[52:55], v[32:35], v[136:139]
    s_waitcnt lgkmcnt(8)
    v_mfma_f32_16x16x32_bf16 v[68:71], v[56:59], v[24:27], v[68:71]
    ds_read_b64_tr_b16 v[52:53], v5 offset:55520
    v_mfma_f32_16x16x32_bf16 v[104:107], v[56:59], v[28:31], v[104:107]
    ds_read_b64_tr_b16 v[54:55], v5 offset:60128
    v_mfma_f32_16x16x32_bf16 v[140:143], v[56:59], v[32:35], v[140:143]
    s_waitcnt lgkmcnt(8)
    v_mfma_f32_16x16x32_bf16 v[72:75], v[36:39], v[24:27], v[72:75]
    ds_read_b64_tr_b16 v[56:57], v4 offset:55552
    v_mfma_f32_16x16x32_bf16 v[108:111], v[36:39], v[28:31], v[108:111]
    ds_read_b64_tr_b16 v[58:59], v4 offset:60160
    v_mfma_f32_16x16x32_bf16 v[144:147], v[36:39], v[32:35], v[144:147]
    s_waitcnt lgkmcnt(8)
    v_mfma_f32_16x16x32_bf16 v[76:79], v[40:43], v[24:27], v[76:79]
    v_mfma_f32_16x16x32_bf16 v[112:115], v[40:43], v[28:31], v[112:115]
    v_mfma_f32_16x16x32_bf16 v[148:151], v[40:43], v[32:35], v[148:151]
    s_waitcnt lgkmcnt(6)
    v_mfma_f32_16x16x32_bf16 v[80:83], v[44:47], v[24:27], v[80:83]
    v_mfma_f32_16x16x32_bf16 v[116:119], v[44:47], v[28:31], v[116:119]
    v_mfma_f32_16x16x32_bf16 v[152:155], v[44:47], v[32:35], v[152:155]
    s_waitcnt lgkmcnt(4)
    v_mfma_f32_16x16x32_bf16 v[84:87], v[48:51], v[24:27], v[84:87]
    v_mfma_f32_16x16x32_bf16 v[120:123], v[48:51], v[28:31], v[120:123]
    v_mfma_f32_16x16x32_bf16 v[156:159], v[48:51], v[32:35], v[156:159]
    s_waitcnt lgkmcnt(2)
    v_mfma_f32_16x16x32_bf16 v[88:91], v[52:55], v[24:27], v[88:91]
    v_mfma_f32_16x16x32_bf16 v[124:127], v[52:55], v[28:31], v[124:127]
    v_mfma_f32_16x16x32_bf16 v[160:163], v[52:55], v[32:35], v[160:163]
    s_waitcnt lgkmcnt(0)
    v_mfma_f32_16x16x32_bf16 v[92:95], v[56:59], v[24:27], v[92:95]
    v_mfma_f32_16x16x32_bf16 v[128:131], v[56:59], v[28:31], v[128:131]
    v_mfma_f32_16x16x32_bf16 v[164:167], v[56:59], v[32:35], v[164:167]
    v_mov_b32 v0, v9
    v_mov_b32 v31, s36
    v_cvt_pk_bf16_f32 v4, v60, v61
    v_cvt_pk_bf16_f32 v5, v62, v63
    v_cvt_pk_bf16_f32 v6, v64, v65
    v_cvt_pk_bf16_f32 v7, v66, v67
    s_add_u32 s28, s26, 0
    buffer_store_dwordx4 v[4:7], v2, s[60:63], s28 offen offset:0 sc1
    v_lshl_add_u32 v31, v4, 0, v31
    v_lshl_add_u32 v31, v5, 1, v31
    v_lshl_add_u32 v31, v6, 2, v31
    v_lshl_add_u32 v31, v7, 3, v31
    v_cvt_pk_bf16_f32 v8, v68, v69
    v_cvt_pk_bf16_f32 v9, v70, v71
    v_cvt_pk_bf16_f32 v10, v72, v73
    v_cvt_pk_bf16_f32 v11, v74, v75
    buffer_store_dwordx4 v[8:11], v2, s[60:63], s28 offen offset:1024 sc1
    v_lshl_add_u32 v31, v8, 0, v31
    v_lshl_add_u32 v31, v9, 1, v31
    v_lshl_add_u32 v31, v10, 2, v31
    v_lshl_add_u32 v31, v11, 3, v31
    v_cvt_pk_bf16_f32 v12, v76, v77
    v_cvt_pk_bf16_f32 v13, v78, v79
    v_cvt_pk_bf16_f32 v14, v80, v81
    v_cvt_pk_bf16_f32 v15, v82, v83
    buffer_store_dwordx4 v[12:15], v2, s[60:63], s28 offen offset:2048 sc1
    v_lshl_add_u32 v31, v12, 0, v31
    v_lshl_add_u32 v31, v13, 1, v31
    v_lshl_add_u32 v31, v14, 2, v31
    v_lshl_add_u32 v31, v15, 3, v31
    v_cvt_pk_bf16_f32 v16, v84, v85
    v_cvt_pk_bf16_f32 v17, v86, v87
    v_cvt_pk_bf16_f32 v18, v88, v89
    v_cvt_pk_bf16_f32 v19, v90, v91
    buffer_store_dwordx4 v[16:19], v2, s[60:63], s28 offen offset:3072 sc1
    v_lshl_add_u32 v31, v16, 0, v31
    v_lshl_add_u32 v31, v17, 1, v31
    v_lshl_add_u32 v31, v18, 2, v31
    v_lshl_add_u32 v31, v19, 3, v31
    v_cvt_pk_bf16_f32 v20, v96, v97
    v_cvt_pk_bf16_f32 v21, v98, v99
    v_cvt_pk_bf16_f32 v22, v100, v101
    v_cvt_pk_bf16_f32 v23, v102, v103
    s_add_u32 s28, s26, 4096
    buffer_store_dwordx4 v[20:23], v2, s[60:63], s28 offen offset:0 sc1
    v_lshl_add_u32 v31, v20, 0, v31
    v_lshl_add_u32 v31, v21, 1, v31
    v_lshl_add_u32 v31, v22, 2, v31
    v_lshl_add_u32 v31, v23, 3, v31
    v_cvt_pk_bf16_f32 v24, v104, v105
    v_cvt_pk_bf16_f32 v25, v106, v107
    v_cvt_pk_bf16_f32 v26, v108, v109
    v_cvt_pk_bf16_f32 v27, v110, v111
    buffer_store_dwordx4 v[24:27], v2, s[60:63], s28 offen offset:1024 sc1
    v_lshl_add_u32 v31, v24, 0, v31
    v_lshl_add_u32 v31, v25, 1, v31
    v_lshl_add_u32 v31, v26, 2, v31
    v_lshl_add_u32 v31, v27, 3, v31
    v_cvt_pk_bf16_f32 v28, v92, v93
    v_cvt_pk_bf16_f32 v29, v94, v95
    v_cvt_pk_bf16_f32 v30, v164, v165
    v_lshl_add_u32 v31, v28, 0, v31
    v_lshl_add_u32 v31, v29, 1, v31
    v_lshl_add_u32 v31, v30, 2, v31
    buffer_store_dwordx4 v[28:31], v2, s[60:63], s28 offen offset:2048 sc1
    v_mov_b32 v59, s36
    v_cvt_pk_bf16_f32 v32, v112, v113
    v_cvt_pk_bf16_f32 v33, v114, v115
    v_cvt_pk_bf16_f32 v34, v116, v117
    v_cvt_pk_bf16_f32 v35, v118, v119
    s_add_u32 s28, s26, 57344
    buffer_store_dwordx4 v[32:35], v3, s[60:63], s28 offen offset:0 sc1
    v_lshl_add_u32 v59, v32, 0, v59
    v_lshl_add_u32 v59, v33, 1, v59
    v_lshl_add_u32 v59, v34, 2, v59
    v_lshl_add_u32 v59, v35, 3, v59
    v_cvt_pk_bf16_f32 v36, v120, v121
    v_cvt_pk_bf16_f32 v37, v122, v123
    v_cvt_pk_bf16_f32 v38, v124, v125
    v_cvt_pk_bf16_f32 v39, v126, v127
    buffer_store_dwordx4 v[36:39], v3, s[60:63], s28 offen offset:1024 sc1
    v_lshl_add_u32 v59, v36, 0, v59
    v_lshl_add_u32 v59, v37, 1, v59
    v_lshl_add_u32 v59, v38, 2, v59
    v_lshl_add_u32 v59, v39, 3, v59
    v_cvt_pk_bf16_f32 v40, v132, v133
    v_cvt_pk_bf16_f32 v41, v134, v135
    v_cvt_pk_bf16_f32 v42, v136, v137
    v_cvt_pk_bf16_f32 v43, v138, v139
    buffer_store_dwordx4 v[40:43], v3, s[60:63], s28 offen offset:2048 sc1
    v_lshl_add_u32 v59, v40, 0, v59
    v_lshl_add_u32 v59, v41, 1, v59
    v_lshl_add_u32 v59, v42, 2, v59
    v_lshl_add_u32 v59, v43, 3, v59
    v_cvt_pk_bf16_f32 v44, v140, v141
    v_cvt_pk_bf16_f32 v45, v142, v143
    v_cvt_pk_bf16_f32 v46, v144, v145
    v_cvt_pk_bf16_f32 v47, v146, v147
    buffer_store_dwordx4 v[44:47], v3, s[60:63], s28 offen offset:3072 sc1
    v_lshl_add_u32 v59, v44, 0, v59
    v_lshl_add_u32 v59, v45, 1, v59
    v_lshl_add_u32 v59, v46, 2, v59
    v_lshl_add_u32 v59, v47, 3, v59
    v_cvt_pk_bf16_f32 v48, v148, v149
    v_cvt_pk_bf16_f32 v49, v150, v151
    v_cvt_pk_bf16_f32 v50, v152, v153
    v_cvt_pk_bf16_f32 v51, v154, v155
    s_add_u32 s28, s26, 61440
    buffer_store_dwordx4 v[48:51], v3, s[60:63], s28 offen offset:0 sc1
    v_lshl_add_u32 v59, v48, 0, v59
    v_lshl_add_u32 v59, v49, 1, v59
    v_lshl_add_u32 v59, v50, 2, v59
    v_lshl_add_u32 v59, v51, 3, v59
    v_cvt_pk_bf16_f32 v52, v156, v157
    v_cvt_pk_bf16_f32 v53, v158, v159
    v_cvt_pk_bf16_f32 v54, v160, v161
    v_cvt_pk_bf16_f32 v55, v162, v163
    buffer_store_dwordx4 v[52:55], v3, s[60:63], s28 offen offset:1024 sc1
    v_lshl_add_u32 v59, v52, 0, v59
    v_lshl_add_u32 v59, v53, 1, v59
    v_lshl_add_u32 v59, v54, 2, v59
    v_lshl_add_u32 v59, v55, 3, v59
    v_cvt_pk_bf16_f32 v56, v128, v129
    v_cvt_pk_bf16_f32 v57, v130, v131
    v_cvt_pk_bf16_f32 v58, v166, v167
    v_lshl_add_u32 v59, v56, 0, v59
    v_lshl_add_u32 v59, v57, 1, v59
    v_lshl_add_u32 v59, v58, 2, v59
    buffer_store_dwordx4 v[56:59], v3, s[60:63], s28 offen offset:2048 sc1
    v_mov_b32 v60, s36
    buffer_store_dword v60, v0, s[60:63], s35 offen sc1
    s_barrier
    s_cmp_eq_u32 s31, 0
    s_cbranch_scc0 L_pown0
    ds_write_b128 v1, v[4:7] offset:0
    ds_write_b128 v1, v[8:11] offset:1024
    ds_write_b128 v1, v[12:15] offset:2048
    ds_write_b128 v1, v[16:19] offset:3072
    ds_write_b128 v1, v[20:23] offset:4096
    ds_write_b128 v1, v[24:27] offset:5120
    ds_write_b128 v1, v[28:31] offset:6144
L_pown0:
    s_cmp_eq_u32 s31, 1
    s_cbranch_scc0 L_pown1
    ds_write_b128 v1, v[32:35] offset:0
    ds_write_b128 v1, v[36:39] offset:1024
    ds_write_b128 v1, v[40:43] offset:2048
    ds_write_b128 v1, v[44:47] offset:3072
    ds_write_b128 v1, v[48:51] offset:4096
    ds_write_b128 v1, v[52:55] offset:5120
    ds_write_b128 v1, v[56:59] offset:6144
L_pown1:
    s_waitcnt lgkmcnt(0)
    s_barrier
L_out:
L_end:
    s_endpgm
L_restart:
    s_waitcnt vmcnt(0) lgkmcnt(0)
    s_barrier
    s_mov_b32 s3, 1
    s_branch L_start
L_slow_l:
    ds_read_b128 v[16:19], v3 offset:0
    ds_read_b128 v[20:23], v3 offset:1024
    ds_read_b128 v[24:27], v3 offset:2048
    ds_read_b128 v[28:31], v3 offset:3072
    ds_read_b128 v[32:35], v3 offset:4096
    ds_read_b128 v[36:39], v3 offset:5120
    ds_read_b128 v[40:43], v3 offset:6144
    ds_read_b128 v[44:47], v3 offset:7168
    v_and_b32 v1, 31, v0
    v_lshlrev_b32 v1, 8, v1
    v_lshrrev_b32 v2, 5, v0
    v_lshl_add_u32 v1, v2, 4, v1
    v_mov_b32 v163, 0xff800000
    s_mov_b32 s28, 0
    s_waitcnt lgkmcnt(0)
L_max_l:
    buffer_load_dwordx4 v[48:51], v1, s[48:51], s28 offen offset:0
    buffer_load_dwordx4 v[52:55], v1, s[48:51], s28 offen offset:32
    buffer_load_dwordx4 v[56:59], v1, s[48:51], s28 offen offset:64
    buffer_load_dwordx4 v[60:63], v1, s[48:51], s28 offen offset:96
    buffer_load_dwordx4 v[64:67], v1, s[48:51], s28 offen offset:128
    buffer_load_dwordx4 v[68:71], v1, s[48:51], s28 offen offset:160
    buffer_load_dwordx4 v[72:75], v1, s[48:51], s28 offen offset:192
    buffer_load_dwordx4 v[76:79], v1, s[48:51], s28 offen offset:224
    s_waitcnt vmcnt(7)
    v_mfma_f32_32x32x16_bf16 v[80:95], v[48:51], v[16:19], 0
    s_waitcnt vmcnt(6)
    v_mfma_f32_32x32x16_bf16 v[80:95], v[52:55], v[20:23], v[80:95]
    s_waitcnt vmcnt(5)
    v_mfma_f32_32x32x16_bf16 v[80:95], v[56:59], v[24:27], v[80:95]
    s_waitcnt vmcnt(4)
    v_mfma_f32_32x32x16_bf16 v[80:95], v[60:63], v[28:31], v[80:95]
    s_waitcnt vmcnt(3)
    v_mfma_f32_32x32x16_bf16 v[80:95], v[64:67], v[32:35], v[80:95]
    s_waitcnt vmcnt(2)
    v_mfma_f32_32x32x16_bf16 v[80:95], v[68:71], v[36:39], v[80:95]
    s_waitcnt vmcnt(1)
    v_mfma_f32_32x32x16_bf16 v[80:95], v[72:75], v[40:43], v[80:95]
    s_waitcnt vmcnt(0)
    v_mfma_f32_32x32x16_bf16 v[80:95], v[76:79], v[44:47], v[80:95]
    s_nop 11
    v_max_f32 v163, v163, v80
    v_max_f32 v163, v163, v81
    v_max_f32 v163, v163, v82
    v_max_f32 v163, v163, v83
    v_max_f32 v163, v163, v84
    v_max_f32 v163, v163, v85
    v_max_f32 v163, v163, v86
    v_max_f32 v163, v163, v87
    v_max_f32 v163, v163, v88
    v_max_f32 v163, v163, v89
    v_max_f32 v163, v163, v90
    v_max_f32 v163, v163, v91
    v_max_f32 v163, v163, v92
    v_max_f32 v163, v163, v93
    v_max_f32 v163, v163, v94
    v_max_f32 v163, v163, v95
    s_add_u32 s28, s28, 8192
    s_cmp_lt_u32 s28, 131072
    s_cbranch_scc1 L_max_l
    v_mov_b32 v1, v163
    s_nop 1
    v_permlane32_swap_b32 v1, v163
    v_max_f32 v163, v163, v1
    v_sub_f32 v163, 0, v163
    ds_read_b128 v[48:51], v4 offset:0
    ds_read_b128 v[52:55], v5 offset:0
    ds_read_b128 v[56:59], v6 offset:0
    ds_read_b128 v[60:63], v7 offset:0
    ds_read_b128 v[64:67], v4 offset:8192
    ds_read_b128 v[68:71], v5 offset:8192
    ds_read_b128 v[72:75], v6 offset:8192
    ds_read_b128 v[76:79], v7 offset:8192
    v_mov_b32 v12, 0
    v_mov_b32 v13, 0
    v_mov_b32 v80, v163
    v_mov_b32 v81, v163
    v_mov_b32 v82, v163
    v_mov_b32 v83, v163
    v_mov_b32 v84, v163
    v_mov_b32 v85, v163
    v_mov_b32 v86, v163
    v_mov_b32 v87, v163
    v_mov_b32 v88, v163
    v_mov_b32 v89, v163
    v_mov_b32 v90, v163
    v_mov_b32 v91, v163
    v_mov_b32 v92, v163
    v_mov_b32 v93, v163
    v_mov_b32 v94, v163
    v_mov_b32 v95, v163
    s_setprio 1
    s_waitcnt lgkmcnt(7)
    v_mfma_f32_32x32x16_bf16 v[80:95], v[48:51], v[16:19], v[80:95]
    ds_read_b64_tr_b16 v[48:49], v8 offset:0
    ds_read_b64_tr_b16 v[50:51], v8 offset:2048
    s_waitcnt lgkmcnt(8)
    v_mfma_f32_32x32x16_bf16 v[80:95], v[52:55], v[20:23], v[80:95]
    ds_read_b64_tr_b16 v[52:53], v9 offset:0
    ds_read_b64_tr_b16 v[54:55], v9 offset:2048
    s_add_u32 m0, s27, 122880
    s_mov_b32 s28, 32896
    buffer_load_dwordx4 v14, s[48:51], s28 offen nt lds
    s_waitcnt lgkmcnt(9)
    v_mfma_f32_32x32x16_bf16 v[80:95], v[56:59], v[24:27], v[80:95]
    ds_read_b64_tr_b16 v[56:57], v10 offset:0
    ds_read_b64_tr_b16 v[58:59], v10 offset:2048
    s_waitcnt lgkmcnt(10)
    v_mfma_f32_32x32x16_bf16 v[80:95], v[60:63], v[28:31], v[80:95]
    ds_read_b64_tr_b16 v[60:61], v11 offset:0
    ds_read_b64_tr_b16 v[62:63], v11 offset:2048
    s_waitcnt lgkmcnt(11)
    v_mfma_f32_32x32x16_bf16 v[80:95], v[64:67], v[32:35], v[80:95]
    ds_read_b64_tr_b16 v[64:65], v8 offset:4096
    ds_read_b64_tr_b16 v[66:67], v8 offset:6144
    s_waitcnt lgkmcnt(12)
    v_mfma_f32_32x32x16_bf16 v[80:95], v[68:71], v[36:39], v[80:95]
    ds_read_b64_tr_b16 v[68:69], v9 offset:4096
    ds_read_b64_tr_b16 v[70:71], v9 offset:6144
    s_add_u32 m0, s27, 131072
    s_mov_b32 s28, 32768
    buffer_load_dwordx4 v15, s[52:55], s28 offen nt lds
    s_waitcnt lgkmcnt(13)
    v_mfma_f32_32x32x16_bf16 v[80:95], v[72:75], v[40:43], v[80:95]
    ds_read_b64_tr_b16 v[72:73], v10 offset:4096
    ds_read_b64_tr_b16 v[74:75], v10 offset:6144
    s_waitcnt lgkmcnt(14)
    v_mfma_f32_32x32x16_bf16 v[80:95], v[76:79], v[44:47], v[80:95]
    ds_read_b64_tr_b16 v[76:77], v11 offset:4096
    ds_read_b64_tr_b16 v[78:79], v11 offset:6144
    s_setprio 0
    s_nop 8
    v_exp_f32 v80, v80
    v_exp_f32 v81, v81
    v_exp_f32 v82, v82
    v_exp_f32 v83, v83
    v_exp_f32 v84, v84
    v_exp_f32 v85, v85
    v_exp_f32 v86, v86
    v_exp_f32 v87, v87
    v_add_f32 v12, v12, v80
    v_add_f32 v13, v13, v81
    v_add_f32 v12, v12, v82
    v_add_f32 v13, v13, v83
    v_add_f32 v12, v12, v84
    v_add_f32 v13, v13, v85
    v_add_f32 v12, v12, v86
    v_add_f32 v13, v13, v87
    v_cvt_pk_bf16_f32 v80, v80, v81
    v_cvt_pk_bf16_f32 v81, v82, v83
    v_cvt_pk_bf16_f32 v82, v84, v85
    v_cvt_pk_bf16_f32 v83, v86, v87
    v_exp_f32 v88, v88
    v_exp_f32 v89, v89
    s_waitcnt lgkmcnt(14)
    v_mfma_f32_32x32x16_bf16 v[96:111], v[48:51], v[80:83], 0
    v_add_f32 v12, v12, v88
    v_add_f32 v13, v13, v89
    v_cvt_pk_bf16_f32 v88, v88, v89
    v_exp_f32 v90, v90
    v_exp_f32 v91, v91
    s_waitcnt lgkmcnt(12)
    v_mfma_f32_32x32x16_bf16 v[112:127], v[52:55], v[80:83], 0
    v_add_f32 v12, v12, v90
    v_add_f32 v13, v13, v91
    v_cvt_pk_bf16_f32 v89, v90, v91
    v_exp_f32 v92, v92
    v_exp_f32 v93, v93
    s_waitcnt lgkmcnt(10)
    v_mfma_f32_32x32x16_bf16 v[128:143], v[56:59], v[80:83], 0
    v_add_f32 v12, v12, v92
    v_add_f32 v13, v13, v93
    v_cvt_pk_bf16_f32 v90, v92, v93
    s_add_u32 m0, s27, 139264
    s_mov_b32 s28, 40960
    buffer_load_dwordx4 v15, s[52:55], s28 offen nt lds
    v_exp_f32 v94, v94
    v_exp_f32 v95, v95
    s_waitcnt lgkmcnt(8)
    v_mfma_f32_32x32x16_bf16 v[144:159], v[60:63], v[80:83], 0
    v_add_f32 v12, v12, v94
    v_add_f32 v13, v13, v95
    v_cvt_pk_bf16_f32 v91, v94, v95
    s_waitcnt lgkmcnt(6)
    s_nop 0
    v_mfma_f32_32x32x16_bf16 v[96:111], v[64:67], v[88:91], v[96:111]
    s_waitcnt lgkmcnt(4)
    v_mfma_f32_32x32x16_bf16 v[112:127], v[68:71], v[88:91], v[112:127]
    s_waitcnt vmcnt(4) lgkmcnt(0)
    s_barrier
    ds_read_b128 v[48:51], v4 offset:40960
    ds_read_b128 v[52:55], v5 offset:40960
    ds_read_b128 v[56:59], v6 offset:40960
    ds_read_b128 v[60:63], v7 offset:40960
    ds_read_b128 v[64:67], v4 offset:49152
    ds_read_b128 v[68:71], v5 offset:49152
    v_mfma_f32_32x32x16_bf16 v[128:143], v[72:75], v[88:91], v[128:143]
    ds_read_b128 v[72:75], v6 offset:49152
    s_add_u32 m0, s27, 73728
    s_mov_b32 s28, 49152
    buffer_load_dwordx4 v14, s[48:51], s28 offen nt lds
    v_mfma_f32_32x32x16_bf16 v[144:159], v[76:79], v[88:91], v[144:159]
    ds_read_b128 v[76:79], v7 offset:49152
    v_mov_b32 v80, v163
    v_mov_b32 v81, v163
    v_mov_b32 v82, v163
    v_mov_b32 v83, v163
    v_mov_b32 v84, v163
    v_mov_b32 v85, v163
    v_mov_b32 v86, v163
    v_mov_b32 v87, v163
    v_mov_b32 v88, v163
    v_mov_b32 v89, v163
    v_mov_b32 v90, v163
    v_mov_b32 v91, v163
    v_mov_b32 v92, v163
    v_mov_b32 v93, v163
    v_mov_b32 v94, v163
    v_mov_b32 v95, v163
    s_setprio 1
    s_waitcnt lgkmcnt(7)
    v_mfma_f32_32x32x16_bf16 v[80:95], v[48:51], v[16:19], v[80:95]
    ds_read_b64_tr_b16 v[48:49], v8 offset:40960
    ds_read_b64_tr_b16 v[50:51], v8 offset:43008
    s_waitcnt lgkmcnt(8)
    v_mfma_f32_32x32x16_bf16 v[80:95], v[52:55], v[20:23], v[80:95]
    ds_read_b64_tr_b16 v[52:53], v9 offset:40960
    ds_read_b64_tr_b16 v[54:55], v9 offset:43008
    s_add_u32 m0, s27, 81920
    s_mov_b32 s28, 49280
    buffer_load_dwordx4 v14, s[48:51], s28 offen nt lds
    s_waitcnt lgkmcnt(9)
    v_mfma_f32_32x32x16_bf16 v[80:95], v[56:59], v[24:27], v[80:95]
    ds_read_b64_tr_b16 v[56:57], v10 offset:40960
    ds_read_b64_tr_b16 v[58:59], v10 offset:43008
    s_waitcnt lgkmcnt(10)
    v_mfma_f32_32x32x16_bf16 v[80:95], v[60:63], v[28:31], v[80:95]
    ds_read_b64_tr_b16 v[60:61], v11 offset:40960
    ds_read_b64_tr_b16 v[62:63], v11 offset:43008
    s_waitcnt lgkmcnt(11)
    v_mfma_f32_32x32x16_bf16 v[80:95], v[64:67], v[32:35], v[80:95]
    ds_read_b64_tr_b16 v[64:65], v8 offset:45056
    ds_read_b64_tr_b16 v[66:67], v8 offset:47104
    s_waitcnt lgkmcnt(12)
    v_mfma_f32_32x32x16_bf16 v[80:95], v[68:71], v[36:39], v[80:95]
    ds_read_b64_tr_b16 v[68:69], v9 offset:45056
    ds_read_b64_tr_b16 v[70:71], v9 offset:47104
    s_add_u32 m0, s27, 90112
    s_mov_b32 s28, 49152
    buffer_load_dwordx4 v15, s[52:55], s28 offen nt lds
    s_waitcnt lgkmcnt(13)
    v_mfma_f32_32x32x16_bf16 v[80:95], v[72:75], v[40:43], v[80:95]
    ds_read_b64_tr_b16 v[72:73], v10 offset:45056
    ds_read_b64_tr_b16 v[74:75], v10 offset:47104
    s_waitcnt lgkmcnt(14)
    v_mfma_f32_32x32x16_bf16 v[80:95], v[76:79], v[44:47], v[80:95]
    ds_read_b64_tr_b16 v[76:77], v11 offset:45056
    ds_read_b64_tr_b16 v[78:79], v11 offset:47104
    s_setprio 0
    v_add_u32 v4, 73728, v4
    v_add_u32 v5, 73728, v5
    v_add_u32 v6, 73728, v6
    v_add_u32 v7, 73728, v7
    v_add_u32 v8, 73728, v8
    v_add_u32 v9, 73728, v9
    v_add_u32 v10, 73728, v10
    v_add_u32 v11, 73728, v11
    s_nop 0
    v_exp_f32 v80, v80
    v_exp_f32 v81, v81
    v_exp_f32 v82, v82
    v_exp_f32 v83, v83
    v_exp_f32 v84, v84
    v_exp_f32 v85, v85
    v_exp_f32 v86, v86
    v_exp_f32 v87, v87
    v_add_f32 v12, v12, v80
    v_add_f32 v13, v13, v81
    v_add_f32 v12, v12, v82
    v_add_f32 v13, v13, v83
    v_add_f32 v12, v12, v84
    v_add_f32 v13, v13, v85
    v_add_f32 v12, v12, v86
    v_add_f32 v13, v13, v87
    v_cvt_pk_bf16_f32 v80, v80, v81
    v_cvt_pk_bf16_f32 v81, v82, v83
    v_cvt_pk_bf16_f32 v82, v84, v85
    v_cvt_pk_bf16_f32 v83, v86, v87
    v_exp_f32 v88, v88
    v_exp_f32 v89, v89
    s_waitcnt lgkmcnt(14)
    v_mfma_f32_32x32x16_bf16 v[96:111], v[48:51], v[80:83], v[96:111]
    v_add_f32 v12, v12, v88
    v_add_f32 v13, v13, v89
    v_cvt_pk_bf16_f32 v88, v88, v89
    v_exp_f32 v90, v90
    v_exp_f32 v91, v91
    s_waitcnt lgkmcnt(12)
    v_mfma_f32_32x32x16_bf16 v[112:127], v[52:55], v[80:83], v[112:127]
    v_add_f32 v12, v12, v90
    v_add_f32 v13, v13, v91
    v_cvt_pk_bf16_f32 v89, v90, v91
    v_exp_f32 v92, v92
    v_exp_f32 v93, v93
    s_waitcnt lgkmcnt(10)
    v_mfma_f32_32x32x16_bf16 v[128:143], v[56:59], v[80:83], v[128:143]
    v_add_f32 v12, v12, v92
    v_add_f32 v13, v13, v93
    v_cvt_pk_bf16_f32 v90, v92, v93
    s_add_u32 m0, s27, 98304
    s_mov_b32 s28, 57344
    buffer_load_dwordx4 v15, s[52:55], s28 offen nt lds
    v_exp_f32 v94, v94
    v_exp_f32 v95, v95
    s_waitcnt lgkmcnt(8)
    v_mfma_f32_32x32x16_bf16 v[144:159], v[60:63], v[80:83], v[144:159]
    v_add_f32 v12, v12, v94
    v_add_f32 v13, v13, v95
    v_cvt_pk_bf16_f32 v91, v94, v95
    s_waitcnt lgkmcnt(6)
    s_nop 0
    v_mfma_f32_32x32x16_bf16 v[96:111], v[64:67], v[88:91], v[96:111]
    s_waitcnt lgkmcnt(4)
    v_mfma_f32_32x32x16_bf16 v[112:127], v[68:71], v[88:91], v[112:127]
    s_waitcnt vmcnt(4) lgkmcnt(0)
    s_barrier
    ds_read_b128 v[48:51], v4 offset:40960
    ds_read_b128 v[52:55], v5 offset:40960
    ds_read_b128 v[56:59], v6 offset:40960
    ds_read_b128 v[60:63], v7 offset:40960
    ds_read_b128 v[64:67], v4 offset:49152
    ds_read_b128 v[68:71], v5 offset:49152
    v_mfma_f32_32x32x16_bf16 v[128:143], v[72:75], v[88:91], v[128:143]
    ds_read_b128 v[72:75], v6 offset:49152
    s_add_u32 m0, s27, 0
    s_mov_b32 s28, 65536
    buffer_load_dwordx4 v14, s[48:51], s28 offen nt lds
    v_mfma_f32_32x32x16_bf16 v[144:159], v[76:79], v[88:91], v[144:159]
    ds_read_b128 v[76:79], v7 offset:49152
    v_mov_b32 v80, v163
    v_mov_b32 v81, v163
    v_mov_b32 v82, v163
    v_mov_b32 v83, v163
    v_mov_b32 v84, v163
    v_mov_b32 v85, v163
    v_mov_b32 v86, v163
    v_mov_b32 v87, v163
    v_mov_b32 v88, v163
    v_mov_b32 v89, v163
    v_mov_b32 v90, v163
    v_mov_b32 v91, v163
    v_mov_b32 v92, v163
    v_mov_b32 v93, v163
    v_mov_b32 v94, v163
    v_mov_b32 v95, v163
    s_setprio 1
    s_waitcnt lgkmcnt(7)
    v_mfma_f32_32x32x16_bf16 v[80:95], v[48:51], v[16:19], v[80:95]
    ds_read_b64_tr_b16 v[48:49], v8 offset:40960
    ds_read_b64_tr_b16 v[50:51], v8 offset:43008
    s_waitcnt lgkmcnt(8)
    v_mfma_f32_32x32x16_bf16 v[80:95], v[52:55], v[20:23], v[80:95]
    ds_read_b64_tr_b16 v[52:53], v9 offset:40960
    ds_read_b64_tr_b16 v[54:55], v9 offset:43008
    s_add_u32 m0, s27, 8192
    s_mov_b32 s28, 65664
    buffer_load_dwordx4 v14, s[48:51], s28 offen nt lds
    s_waitcnt lgkmcnt(9)
    v_mfma_f32_32x32x16_bf16 v[80:95], v[56:59], v[24:27], v[80:95]
    ds_read_b64_tr_b16 v[56:57], v10 offset:40960
    ds_read_b64_tr_b16 v[58:59], v10 offset:43008
    s_waitcnt lgkmcnt(10)
    v_mfma_f32_32x32x16_bf16 v[80:95], v[60:63], v[28:31], v[80:95]
    ds_read_b64_tr_b16 v[60:61], v11 offset:40960
    ds_read_b64_tr_b16 v[62:63], v11 offset:43008
    s_waitcnt lgkmcnt(11)
    v_mfma_f32_32x32x16_bf16 v[80:95], v[64:67], v[32:35], v[80:95]
    ds_read_b64_tr_b16 v[64:65], v8 offset:45056
    ds_read_b64_tr_b16 v[66:67], v8 offset:47104
    s_waitcnt lgkmcnt(12)
    v_mfma_f32_32x32x16_bf16 v[80:95], v[68:71], v[36:39], v[80:95]
    ds_read_b64_tr_b16 v[68:69], v9 offset:45056
    ds_read_b64_tr_b16 v[70:71], v9 offset:47104
    s_add_u32 m0, s27, 16384
    s_mov_b32 s28, 65536
    buffer_load_dwordx4 v15, s[52:55], s28 offen nt lds
    s_waitcnt lgkmcnt(13)
    v_mfma_f32_32x32x16_bf16 v[80:95], v[72:75], v[40:43], v[80:95]
    ds_read_b64_tr_b16 v[72:73], v10 offset:45056
    ds_read_b64_tr_b16 v[74:75], v10 offset:47104
    s_waitcnt lgkmcnt(14)
    v_mfma_f32_32x32x16_bf16 v[80:95], v[76:79], v[44:47], v[80:95]
    ds_read_b64_tr_b16 v[76:77], v11 offset:45056
    ds_read_b64_tr_b16 v[78:79], v11 offset:47104
    s_setprio 0
    s_nop 8
    v_exp_f32 v80, v80
    v_exp_f32 v81, v81
    v_exp_f32 v82, v82
    v_exp_f32 v83, v83
    v_exp_f32 v84, v84
    v_exp_f32 v85, v85
    v_exp_f32 v86, v86
    v_exp_f32 v87, v87
    v_add_f32 v12, v12, v80
    v_add_f32 v13, v13, v81
    v_add_f32 v12, v12, v82
    v_add_f32 v13, v13, v83
    v_add_f32 v12, v12, v84
    v_add_f32 v13, v13, v85
    v_add_f32 v12, v12, v86
    v_add_f32 v13, v13, v87
    v_cvt_pk_bf16_f32 v80, v80, v81
    v_cvt_pk_bf16_f32 v81, v82, v83
    v_cvt_pk_bf16_f32 v82, v84, v85
    v_cvt_pk_bf16_f32 v83, v86, v87
    v_exp_f32 v88, v88
    v_exp_f32 v89, v89
    s_waitcnt lgkmcnt(14)
    v_mfma_f32_32x32x16_bf16 v[96:111], v[48:51], v[80:83], v[96:111]
    v_add_f32 v12, v12, v88
    v_add_f32 v13, v13, v89
    v_cvt_pk_bf16_f32 v88, v88, v89
    v_exp_f32 v90, v90
    v_exp_f32 v91, v91
    s_waitcnt lgkmcnt(12)
    v_mfma_f32_32x32x16_bf16 v[112:127], v[52:55], v[80:83], v[112:127]
    v_add_f32 v12, v12, v90
    v_add_f32 v13, v13, v91
    v_cvt_pk_bf16_f32 v89, v90, v91
    v_exp_f32 v92, v92
    v_exp_f32 v93, v93
    s_waitcnt lgkmcnt(10)
    v_mfma_f32_32x32x16_bf16 v[128:143], v[56:59], v[80:83], v[128:143]
    v_add_f32 v12, v12, v92
    v_add_f32 v13, v13, v93
    v_cvt_pk_bf16_f32 v90, v92, v93
    s_add_u32 m0, s27, 24576
    s_mov_b32 s28, 73728
    buffer_load_dwordx4 v15, s[52:55], s28 offen nt lds
    v_exp_f32 v94, v94
    v_exp_f32 v95, v95
    s_waitcnt lgkmcnt(8)
    v_mfma_f32_32x32x16_bf16 v[144:159], v[60:63], v[80:83], v[144:159]
    v_add_f32 v12, v12, v94
    v_add_f32 v13, v13, v95
    v_cvt_pk_bf16_f32 v91, v94, v95
    s_waitcnt lgkmcnt(6)
    s_nop 0
    v_mfma_f32_32x32x16_bf16 v[96:111], v[64:67], v[88:91], v[96:111]
    s_waitcnt lgkmcnt(4)
    v_mfma_f32_32x32x16_bf16 v[112:127], v[68:71], v[88:91], v[112:127]
    s_waitcnt vmcnt(4) lgkmcnt(0)
    s_barrier
    ds_read_b128 v[48:51], v4 offset:0
    ds_read_b128 v[52:55], v5 offset:0
    ds_read_b128 v[56:59], v6 offset:0
    ds_read_b128 v[60:63], v7 offset:0
    ds_read_b128 v[64:67], v4 offset:8192
    ds_read_b128 v[68:71], v5 offset:8192
    v_mfma_f32_32x32x16_bf16 v[128:143], v[72:75], v[88:91], v[128:143]
    ds_read_b128 v[72:75], v6 offset:8192
    s_add_u32 m0, s27, 40960
    s_mov_b32 s28, 81920
    buffer_load_dwordx4 v14, s[48:51], s28 offen nt lds
    v_mfma_f32_32x32x16_bf16 v[144:159], v[76:79], v[88:91], v[144:159]
    ds_read_b128 v[76:79], v7 offset:8192
    v_mov_b32 v80, v163
    v_mov_b32 v81, v163
    v_mov_b32 v82, v163
    v_mov_b32 v83, v163
    v_mov_b32 v84, v163
    v_mov_b32 v85, v163
    v_mov_b32 v86, v163
    v_mov_b32 v87, v163
    v_mov_b32 v88, v163
    v_mov_b32 v89, v163
    v_mov_b32 v90, v163
    v_mov_b32 v91, v163
    v_mov_b32 v92, v163
    v_mov_b32 v93, v163
    v_mov_b32 v94, v163
    v_mov_b32 v95, v163
    s_setprio 1
    s_waitcnt lgkmcnt(7)
    v_mfma_f32_32x32x16_bf16 v[80:95], v[48:51], v[16:19], v[80:95]
    ds_read_b64_tr_b16 v[48:49], v8 offset:0
    ds_read_b64_tr_b16 v[50:51], v8 offset:2048
    s_waitcnt lgkmcnt(8)
    v_mfma_f32_32x32x16_bf16 v[80:95], v[52:55], v[20:23], v[80:95]
    ds_read_b64_tr_b16 v[52:53], v9 offset:0
    ds_read_b64_tr_b16 v[54:55], v9 offset:2048
    s_add_u32 m0, s27, 49152
    s_mov_b32 s28, 82048
    buffer_load_dwordx4 v14, s[48:51], s28 offen nt lds
    s_waitcnt lgkmcnt(9)
    v_mfma_f32_32x32x16_bf16 v[80:95], v[56:59], v[24:27], v[80:95]
    ds_read_b64_tr_b16 v[56:57], v10 offset:0
    ds_read_b64_tr_b16 v[58:59], v10 offset:2048
    s_waitcnt lgkmcnt(10)
    v_mfma_f32_32x32x16_bf16 v[80:95], v[60:63], v[28:31], v[80:95]
    ds_read_b64_tr_b16 v[60:61], v11 offset:0
    ds_read_b64_tr_b16 v[62:63], v11 offset:2048
    s_waitcnt lgkmcnt(11)
    v_mfma_f32_32x32x16_bf16 v[80:95], v[64:67], v[32:35], v[80:95]
    ds_read_b64_tr_b16 v[64:65], v8 offset:4096
    ds_read_b64_tr_b16 v[66:67], v8 offset:6144
    s_waitcnt lgkmcnt(12)
    v_mfma_f32_32x32x16_bf16 v[80:95], v[68:71], v[36:39], v[80:95]
    ds_read_b64_tr_b16 v[68:69], v9 offset:4096
    ds_read_b64_tr_b16 v[70:71], v9 offset:6144
    s_add_u32 m0, s27, 57344
    s_mov_b32 s28, 81920
    buffer_load_dwordx4 v15, s[52:55], s28 offen nt lds
    s_waitcnt lgkmcnt(13)
    v_mfma_f32_32x32x16_bf16 v[80:95], v[72:75], v[40:43], v[80:95]
    ds_read_b64_tr_b16 v[72:73], v10 offset:4096
    ds_read_b64_tr_b16 v[74:75], v10 offset:6144
    s_waitcnt lgkmcnt(14)
    v_mfma_f32_32x32x16_bf16 v[80:95], v[76:79], v[44:47], v[80:95]
    ds_read_b64_tr_b16 v[76:77], v11 offset:4096
    ds_read_b64_tr_b16 v[78:79], v11 offset:6144
    s_setprio 0
    v_subrev_u32 v4, 73728, v4
    v_subrev_u32 v5, 73728, v5
    v_subrev_u32 v6, 73728, v6
    v_subrev_u32 v7, 73728, v7
    v_subrev_u32 v8, 73728, v8
    v_subrev_u32 v9, 73728, v9
    v_subrev_u32 v10, 73728, v10
    v_subrev_u32 v11, 73728, v11
    s_nop 0
    v_exp_f32 v80, v80
    v_exp_f32 v81, v81
    v_exp_f32 v82, v82
    v_exp_f32 v83, v83
    v_exp_f32 v84, v84
    v_exp_f32 v85, v85
    v_exp_f32 v86, v86
    v_exp_f32 v87, v87
    v_add_f32 v12, v12, v80
    v_add_f32 v13, v13, v81
    v_add_f32 v12, v12, v82
    v_add_f32 v13, v13, v83
    v_add_f32 v12, v12, v84
    v_add_f32 v13, v13, v85
    v_add_f32 v12, v12, v86
    v_add_f32 v13, v13, v87
    v_cvt_pk_bf16_f32 v80, v80, v81
    v_cvt_pk_bf16_f32 v81, v82, v83
    v_cvt_pk_bf16_f32 v82, v84, v85
    v_cvt_pk_bf16_f32 v83, v86, v87
    v_exp_f32 v88, v88
    v_exp_f32 v89, v89
    s_waitcnt lgkmcnt(14)
    v_mfma_f32_32x32x16_bf16 v[96:111], v[48:51], v[80:83], v[96:111]
    v_add_f32 v12, v12, v88
    v_add_f32 v13, v13, v89
    v_cvt_pk_bf16_f32 v88, v88, v89
    v_exp_f32 v90, v90
    v_exp_f32 v91, v91
    s_waitcnt lgkmcnt(12)
    v_mfma_f32_32x32x16_bf16 v[112:127], v[52:55], v[80:83], v[112:127]
    v_add_f32 v12, v12, v90
    v_add_f32 v13, v13, v91
    v_cvt_pk_bf16_f32 v89, v90, v91
    v_exp_f32 v92, v92
    v_exp_f32 v93, v93
    s_waitcnt lgkmcnt(10)
    v_mfma_f32_32x32x16_bf16 v[128:143], v[56:59], v[80:83], v[128:143]
    v_add_f32 v12, v12, v92
    v_add_f32 v13, v13, v93
    v_cvt_pk_bf16_f32 v90, v92, v93
    s_add_u32 m0, s27, 65536
    s_mov_b32 s28, 90112
    buffer_load_dwordx4 v15, s[52:55], s28 offen nt lds
    v_exp_f32 v94, v94
    v_exp_f32 v95, v95
    s_waitcnt lgkmcnt(8)
    v_mfma_f32_32x32x16_bf16 v[144:159], v[60:63], v[80:83], v[144:159]
    v_add_f32 v12, v12, v94
    v_add_f32 v13, v13, v95
    v_cvt_pk_bf16_f32 v91, v94, v95
    s_waitcnt lgkmcnt(6)
    s_nop 0
    v_mfma_f32_32x32x16_bf16 v[96:111], v[64:67], v[88:91], v[96:111]
    s_waitcnt lgkmcnt(4)
    v_mfma_f32_32x32x16_bf16 v[112:127], v[68:71], v[88:91], v[112:127]
    s_waitcnt vmcnt(4) lgkmcnt(0)
    s_barrier
    ds_read_b128 v[48:51], v4 offset:0
    ds_read_b128 v[52:55], v5 offset:0
    ds_read_b128 v[56:59], v6 offset:0
    ds_read_b128 v[60:63], v7 offset:0
    ds_read_b128 v[64:67], v4 offset:8192
    ds_read_b128 v[68:71], v5 offset:8192
    v_mfma_f32_32x32x16_bf16 v[128:143], v[72:75], v[88:91], v[128:143]
    ds_read_b128 v[72:75], v6 offset:8192
    s_add_u32 m0, s27, 114688
    s_mov_b32 s28, 98304
    buffer_load_dwordx4 v14, s[48:51], s28 offen nt lds
    v_mfma_f32_32x32x16_bf16 v[144:159], v[76:79], v[88:91], v[144:159]
    ds_read_b128 v[76:79], v7 offset:8192
    v_mov_b32 v80, v163
    v_mov_b32 v81, v163
    v_mov_b32 v82, v163
    v_mov_b32 v83, v163
    v_mov_b32 v84, v163
    v_mov_b32 v85, v163
    v_mov_b32 v86, v163
    v_mov_b32 v87, v163
    v_mov_b32 v88, v163
    v_mov_b32 v89, v163
    v_mov_b32 v90, v163
    v_mov_b32 v91, v163
    v_mov_b32 v92, v163
    v_mov_b32 v93, v163
    v_mov_b32 v94, v163
    v_mov_b32 v95, v163
    s_setprio 1
    s_waitcnt lgkmcnt(7)
    v_mfma_f32_32x32x16_bf16 v[80:95], v[48:51], v[16:19], v[80:95]
    ds_read_b64_tr_b16 v[48:49], v8 offset:0
    ds_read_b64_tr_b16 v[50:51], v8 offset:2048
    s_waitcnt lgkmcnt(8)
    v_mfma_f32_32x32x16_bf16 v[80:95], v[52:55], v[20:23], v[80:95]
    ds_read_b64_tr_b16 v[52:53], v9 offset:0
    ds_read_b64_tr_b16 v[54:55], v9 offset:2048
    s_add_u32 m0, s27, 122880
    s_mov_b32 s28, 98432
    buffer_load_dwordx4 v14, s[48:51], s28 offen nt lds
    s_waitcnt lgkmcnt(9)
    v_mfma_f32_32x32x16_bf16 v[80:95], v[56:59], v[24:27], v[80:95]
    ds_read_b64_tr_b16 v[56:57], v10 offset:0
    ds_read_b64_tr_b16 v[58:59], v10 offset:2048
    s_waitcnt lgkmcnt(10)
    v_mfma_f32_32x32x16_bf16 v[80:95], v[60:63], v[28:31], v[80:95]
    ds_read_b64_tr_b16 v[60:61], v11 offset:0
    ds_read_b64_tr_b16 v[62:63], v11 offset:2048
    s_waitcnt lgkmcnt(11)
    v_mfma_f32_32x32x16_bf16 v[80:95], v[64:67], v[32:35], v[80:95]
    ds_read_b64_tr_b16 v[64:65], v8 offset:4096
    ds_read_b64_tr_b16 v[66:67], v8 offset:6144
    s_waitcnt lgkmcnt(12)
    v_mfma_f32_32x32x16_bf16 v[80:95], v[68:71], v[36:39], v[80:95]
    ds_read_b64_tr_b16 v[68:69], v9 offset:4096
    ds_read_b64_tr_b16 v[70:71], v9 offset:6144
    s_add_u32 m0, s27, 131072
    s_mov_b32 s28, 98304
    buffer_load_dwordx4 v15, s[52:55], s28 offen nt lds
    s_waitcnt lgkmcnt(13)
    v_mfma_f32_32x32x16_bf16 v[80:95], v[72:75], v[40:43], v[80:95]
    ds_read_b64_tr_b16 v[72:73], v10 offset:4096
    ds_read_b64_tr_b16 v[74:75], v10 offset:6144
    s_waitcnt lgkmcnt(14)
    v_mfma_f32_32x32x16_bf16 v[80:95], v[76:79], v[44:47], v[80:95]
    ds_read_b64_tr_b16 v[76:77], v11 offset:4096
    ds_read_b64_tr_b16 v[78:79], v11 offset:6144
    s_setprio 0
    s_nop 8
    v_exp_f32 v80, v80
    v_exp_f32 v81, v81
    v_exp_f32 v82, v82
    v_exp_f32 v83, v83
    v_exp_f32 v84, v84
    v_exp_f32 v85, v85
    v_exp_f32 v86, v86
    v_exp_f32 v87, v87
    v_add_f32 v12, v12, v80
    v_add_f32 v13, v13, v81
    v_add_f32 v12, v12, v82
    v_add_f32 v13, v13, v83
    v_add_f32 v12, v12, v84
    v_add_f32 v13, v13, v85
    v_add_f32 v12, v12, v86
    v_add_f32 v13, v13, v87
    v_cvt_pk_bf16_f32 v80, v80, v81
    v_cvt_pk_bf16_f32 v81, v82, v83
    v_cvt_pk_bf16_f32 v82, v84, v85
    v_cvt_pk_bf16_f32 v83, v86, v87
    v_exp_f32 v88, v88
    v_exp_f32 v89, v89
    s_waitcnt lgkmcnt(14)
    v_mfma_f32_32x32x16_bf16 v[96:111], v[48:51], v[80:83], v[96:111]
    v_add_f32 v12, v12, v88
    v_add_f32 v13, v13, v89
    v_cvt_pk_bf16_f32 v88, v88, v89
    v_exp_f32 v90, v90
    v_exp_f32 v91, v91
    s_waitcnt lgkmcnt(12)
    v_mfma_f32_32x32x16_bf16 v[112:127], v[52:55], v[80:83], v[112:127]
    v_add_f32 v12, v12, v90
    v_add_f32 v13, v13, v91
    v_cvt_pk_bf16_f32 v89, v90, v91
    v_exp_f32 v92, v92
    v_exp_f32 v93, v93
    s_waitcnt lgkmcnt(10)
    v_mfma_f32_32x32x16_bf16 v[128:143], v[56:59], v[80:83], v[128:143]
    v_add_f32 v12, v12, v92
    v_add_f32 v13, v13, v93
    v_cvt_pk_bf16_f32 v90, v92, v93
    s_add_u32 m0, s27, 139264
    s_mov_b32 s28, 106496
    buffer_load_dwordx4 v15, s[52:55], s28 offen nt lds
    v_exp_f32 v94, v94
    v_exp_f32 v95, v95
    s_waitcnt lgkmcnt(8)
    v_mfma_f32_32x32x16_bf16 v[144:159], v[60:63], v[80:83], v[144:159]
    v_add_f32 v12, v12, v94
    v_add_f32 v13, v13, v95
    v_cvt_pk_bf16_f32 v91, v94, v95
    s_waitcnt lgkmcnt(6)
    s_nop 0
    v_mfma_f32_32x32x16_bf16 v[96:111], v[64:67], v[88:91], v[96:111]
    s_waitcnt lgkmcnt(4)
    v_mfma_f32_32x32x16_bf16 v[112:127], v[68:71], v[88:91], v[112:127]
    s_waitcnt vmcnt(4) lgkmcnt(0)
    s_barrier
    ds_read_b128 v[48:51], v4 offset:40960
    ds_read_b128 v[52:55], v5 offset:40960
    ds_read_b128 v[56:59], v6 offset:40960
    ds_read_b128 v[60:63], v7 offset:40960
    ds_read_b128 v[64:67], v4 offset:49152
    ds_read_b128 v[68:71], v5 offset:49152
    v_mfma_f32_32x32x16_bf16 v[128:143], v[72:75], v[88:91], v[128:143]
    ds_read_b128 v[72:75], v6 offset:49152
    s_add_u32 m0, s27, 73728
    s_mov_b32 s28, 114688
    buffer_load_dwordx4 v14, s[48:51], s28 offen nt lds
    v_mfma_f32_32x32x16_bf16 v[144:159], v[76:79], v[88:91], v[144:159]
    ds_read_b128 v[76:79], v7 offset:49152
    v_mov_b32 v80, v163
    v_mov_b32 v81, v163
    v_mov_b32 v82, v163
    v_mov_b32 v83, v163
    v_mov_b32 v84, v163
    v_mov_b32 v85, v163
    v_mov_b32 v86, v163
    v_mov_b32 v87, v163
    v_mov_b32 v88, v163
    v_mov_b32 v89, v163
    v_mov_b32 v90, v163
    v_mov_b32 v91, v163
    v_mov_b32 v92, v163
    v_mov_b32 v93, v163
    v_mov_b32 v94, v163
    v_mov_b32 v95, v163
    s_setprio 1
    s_waitcnt lgkmcnt(7)
    v_mfma_f32_32x32x16_bf16 v[80:95], v[48:51], v[16:19], v[80:95]
    ds_read_b64_tr_b16 v[48:49], v8 offset:40960
    ds_read_b64_tr_b16 v[50:51], v8 offset:43008
    s_waitcnt lgkmcnt(8)
    v_mfma_f32_32x32x16_bf16 v[80:95], v[52:55], v[20:23], v[80:95]
    ds_read_b64_tr_b16 v[52:53], v9 offset:40960
    ds_read_b64_tr_b16 v[54:55], v9 offset:43008
    s_add_u32 m0, s27, 81920
    s_mov_b32 s28, 114816
    buffer_load_dwordx4 v14, s[48:51], s28 offen nt lds
    s_waitcnt lgkmcnt(9)
    v_mfma_f32_32x32x16_bf16 v[80:95], v[56:59], v[24:27], v[80:95]
    ds_read_b64_tr_b16 v[56:57], v10 offset:40960
    ds_read_b64_tr_b16 v[58:59], v10 offset:43008
    s_waitcnt lgkmcnt(10)
    v_mfma_f32_32x32x16_bf16 v[80:95], v[60:63], v[28:31], v[80:95]
    ds_read_b64_tr_b16 v[60:61], v11 offset:40960
    ds_read_b64_tr_b16 v[62:63], v11 offset:43008
    s_waitcnt lgkmcnt(11)
    v_mfma_f32_32x32x16_bf16 v[80:95], v[64:67], v[32:35], v[80:95]
    ds_read_b64_tr_b16 v[64:65], v8 offset:45056
    ds_read_b64_tr_b16 v[66:67], v8 offset:47104
    s_waitcnt lgkmcnt(12)
    v_mfma_f32_32x32x16_bf16 v[80:95], v[68:71], v[36:39], v[80:95]
    ds_read_b64_tr_b16 v[68:69], v9 offset:45056
    ds_read_b64_tr_b16 v[70:71], v9 offset:47104
    s_waitcnt lgkmcnt(13)
    v_mfma_f32_32x32x16_bf16 v[80:95], v[72:75], v[40:43], v[80:95]
    ds_read_b64_tr_b16 v[72:73], v10 offset:45056
    ds_read_b64_tr_b16 v[74:75], v10 offset:47104
    s_add_u32 m0, s27, 90112
    s_mov_b32 s28, 114688
    buffer_load_dwordx4 v15, s[52:55], s28 offen nt lds
    s_waitcnt lgkmcnt(14)
    v_mfma_f32_32x32x16_bf16 v[80:95], v[76:79], v[44:47], v[80:95]
    ds_read_b64_tr_b16 v[76:77], v11 offset:45056
    ds_read_b64_tr_b16 v[78:79], v11 offset:47104
    s_setprio 0
    v_add_u32 v4, 73728, v4
    v_add_u32 v5, 73728, v5
    v_add_u32 v6, 73728, v6
    v_add_u32 v7, 73728, v7
    v_add_u32 v8, 73728, v8
    v_add_u32 v9, 73728, v9
    v_add_u32 v10, 73728, v10
    v_add_u32 v11, 73728, v11
    s_nop 0
    v_exp_f32 v80, v80
    v_exp_f32 v81, v81
    v_exp_f32 v82, v82
    v_exp_f32 v83, v83
    v_exp_f32 v84, v84
    v_exp_f32 v85, v85
    v_exp_f32 v86, v86
    v_exp_f32 v87, v87
    v_add_f32 v12, v12, v80
    v_add_f32 v13, v13, v81
    v_add_f32 v12, v12, v82
    v_add_f32 v13, v13, v83
    v_add_f32 v12, v12, v84
    v_add_f32 v13, v13, v85
    v_add_f32 v12, v12, v86
    v_add_f32 v13, v13, v87
    v_cvt_pk_bf16_f32 v80, v80, v81
    v_cvt_pk_bf16_f32 v81, v82, v83
    v_cvt_pk_bf16_f32 v82, v84, v85
    v_cvt_pk_bf16_f32 v83, v86, v87
    v_exp_f32 v88, v88
    v_exp_f32 v89, v89
    s_waitcnt lgkmcnt(14)
    v_mfma_f32_32x32x16_bf16 v[96:111], v[48:51], v[80:83], v[96:111]
    v_add_f32 v12, v12, v88
    v_add_f32 v13, v13, v89
    v_cvt_pk_bf16_f32 v88, v88, v89
    v_exp_f32 v90, v90
    v_exp_f32 v91, v91
    s_waitcnt lgkmcnt(12)
    v_mfma_f32_32x32x16_bf16 v[112:127], v[52:55], v[80:83], v[112:127]
    v_add_f32 v12, v12, v90
    v_add_f32 v13, v13, v91
    v_cvt_pk_bf16_f32 v89, v90, v91
    v_exp_f32 v92, v92
    v_exp_f32 v93, v93
    s_waitcnt lgkmcnt(10)
    v_mfma_f32_32x32x16_bf16 v[128:143], v[56:59], v[80:83], v[128:143]
    v_add_f32 v12, v12, v92
    v_add_f32 v13, v13, v93
    v_cvt_pk_bf16_f32 v90, v92, v93
    v_exp_f32 v94, v94
    v_exp_f32 v95, v95
    s_waitcnt lgkmcnt(8)
    v_mfma_f32_32x32x16_bf16 v[144:159], v[60:63], v[80:83], v[144:159]
    v_add_f32 v12, v12, v94
    v_add_f32 v13, v13, v95
    v_cvt_pk_bf16_f32 v91, v94, v95
    s_add_u32 m0, s27, 98304
    s_mov_b32 s28, 122880
    buffer_load_dwordx4 v15, s[52:55], s28 offen nt lds
    s_waitcnt lgkmcnt(6)
    v_mfma_f32_32x32x16_bf16 v[96:111], v[64:67], v[88:91], v[96:111]
    s_waitcnt lgkmcnt(4)
    v_mfma_f32_32x32x16_bf16 v[112:127], v[68:71], v[88:91], v[112:127]
    s_waitcnt vmcnt(4) lgkmcnt(0)
    s_barrier
    ds_read_b128 v[48:51], v4 offset:40960
    ds_read_b128 v[52:55], v5 offset:40960
    ds_read_b128 v[56:59], v6 offset:40960
    ds_read_b128 v[60:63], v7 offset:40960
    ds_read_b128 v[64:67], v4 offset:49152
    ds_read_b128 v[68:71], v5 offset:49152
    v_mfma_f32_32x32x16_bf16 v[128:143], v[72:75], v[88:91], v[128:143]
    ds_read_b128 v[72:75], v6 offset:49152
    s_mov_b64 exec, 0xffff
    buffer_load_dword v165, v164, s[56:59], s39 offen
    s_mov_b64 exec, -1
    v_mfma_f32_32x32x16_bf16 v[144:159], v[76:79], v[88:91], v[144:159]
    ds_read_b128 v[76:79], v7 offset:49152
    v_mov_b32 v80, v163
    v_mov_b32 v81, v163
    v_mov_b32 v82, v163
    v_mov_b32 v83, v163
    v_mov_b32 v84, v163
    v_mov_b32 v85, v163
    v_mov_b32 v86, v163
    v_mov_b32 v87, v163
    v_mov_b32 v88, v163
    v_mov_b32 v89, v163
    v_mov_b32 v90, v163
    v_mov_b32 v91, v163
    v_mov_b32 v92, v163
    v_mov_b32 v93, v163
    v_mov_b32 v94, v163
    v_mov_b32 v95, v163
    s_setprio 1
    s_waitcnt lgkmcnt(7)
    v_mfma_f32_32x32x16_bf16 v[80:95], v[48:51], v[16:19], v[80:95]
    ds_read_b64_tr_b16 v[48:49], v8 offset:40960
    ds_read_b64_tr_b16 v[50:51], v8 offset:43008
    s_waitcnt lgkmcnt(8)
    v_mfma_f32_32x32x16_bf16 v[80:95], v[52:55], v[20:23], v[80:95]
    ds_read_b64_tr_b16 v[52:53], v9 offset:40960
    ds_read_b64_tr_b16 v[54:55], v9 offset:43008
    s_add_u32 m0, s79, 0
    s_add_u32 s28, s72, 0
    buffer_load_dwordx4 v160, s[56:59], s28 offen lds
    s_waitcnt lgkmcnt(9)
    v_mfma_f32_32x32x16_bf16 v[80:95], v[56:59], v[24:27], v[80:95]
    ds_read_b64_tr_b16 v[56:57], v10 offset:40960
    ds_read_b64_tr_b16 v[58:59], v10 offset:43008
    s_waitcnt lgkmcnt(10)
    v_mfma_f32_32x32x16_bf16 v[80:95], v[60:63], v[28:31], v[80:95]
    ds_read_b64_tr_b16 v[60:61], v11 offset:40960
    ds_read_b64_tr_b16 v[62:63], v11 offset:43008
    s_waitcnt lgkmcnt(11)
    v_mfma_f32_32x32x16_bf16 v[80:95], v[64:67], v[32:35], v[80:95]
    ds_read_b64_tr_b16 v[64:65], v8 offset:45056
    ds_read_b64_tr_b16 v[66:67], v8 offset:47104
    s_waitcnt lgkmcnt(12)
    v_mfma_f32_32x32x16_bf16 v[80:95], v[68:71], v[36:39], v[80:95]
    ds_read_b64_tr_b16 v[68:69], v9 offset:45056
    ds_read_b64_tr_b16 v[70:71], v9 offset:47104
    s_waitcnt lgkmcnt(13)
    v_mfma_f32_32x32x16_bf16 v[80:95], v[72:75], v[40:43], v[80:95]
    ds_read_b64_tr_b16 v[72:73], v10 offset:45056
    ds_read_b64_tr_b16 v[74:75], v10 offset:47104
    s_add_u32 m0, s79, 1024
    s_add_u32 s28, s72, 0
    buffer_load_dwordx4 v161, s[56:59], s28 offen lds
    s_waitcnt lgkmcnt(14)
    v_mfma_f32_32x32x16_bf16 v[80:95], v[76:79], v[44:47], v[80:95]
    ds_read_b64_tr_b16 v[76:77], v11 offset:45056
    ds_read_b64_tr_b16 v[78:79], v11 offset:47104
    s_setprio 0
    s_nop 8
    v_exp_f32 v80, v80
    v_exp_f32 v81, v81
    v_exp_f32 v82, v82
    v_exp_f32 v83, v83
    v_exp_f32 v84, v84
    v_exp_f32 v85, v85
    v_exp_f32 v86, v86
    v_exp_f32 v87, v87
    v_add_f32 v12, v12, v80
    v_add_f32 v13, v13, v81
    v_add_f32 v12, v12, v82
    v_add_f32 v13, v13, v83
    v_add_f32 v12, v12, v84
    v_add_f32 v13, v13, v85
    v_add_f32 v12, v12, v86
    v_add_f32 v13, v13, v87
    v_cvt_pk_bf16_f32 v80, v80, v81
    v_cvt_pk_bf16_f32 v81, v82, v83
    v_cvt_pk_bf16_f32 v82, v84, v85
    v_cvt_pk_bf16_f32 v83, v86, v87
    v_exp_f32 v88, v88
    v_exp_f32 v89, v89
    s_waitcnt lgkmcnt(14)
    v_mfma_f32_32x32x16_bf16 v[96:111], v[48:51], v[80:83], v[96:111]
    v_add_f32 v12, v12, v88
    v_add_f32 v13, v13, v89
    v_cvt_pk_bf16_f32 v88, v88, v89
    v_exp_f32 v90, v90
    v_exp_f32 v91, v91
    s_waitcnt lgkmcnt(12)
    v_mfma_f32_32x32x16_bf16 v[112:127], v[52:55], v[80:83], v[112:127]
    v_add_f32 v12, v12, v90
    v_add_f32 v13, v13, v91
    v_cvt_pk_bf16_f32 v89, v90, v91
    v_exp_f32 v92, v92
    v_exp_f32 v93, v93
    s_waitcnt lgkmcnt(10)
    v_mfma_f32_32x32x16_bf16 v[128:143], v[56:59], v[80:83], v[128:143]
    v_add_f32 v12, v12, v92
    v_add_f32 v13, v13, v93
    v_cvt_pk_bf16_f32 v90, v92, v93
    v_exp_f32 v94, v94
    v_exp_f32 v95, v95
    s_waitcnt lgkmcnt(8)
    v_mfma_f32_32x32x16_bf16 v[144:159], v[60:63], v[80:83], v[144:159]
    v_add_f32 v12, v12, v94
    v_add_f32 v13, v13, v95
    v_cvt_pk_bf16_f32 v91, v94, v95
    s_waitcnt lgkmcnt(6)
    s_nop 0
    v_mfma_f32_32x32x16_bf16 v[96:111], v[64:67], v[88:91], v[96:111]
    s_waitcnt lgkmcnt(4)
    v_mfma_f32_32x32x16_bf16 v[112:127], v[68:71], v[88:91], v[112:127]
    s_waitcnt vmcnt(3) lgkmcnt(0)
    s_barrier
    ds_read_b128 v[48:51], v4 offset:0
    ds_read_b128 v[52:55], v5 offset:0
    ds_read_b128 v[56:59], v6 offset:0
    ds_read_b128 v[60:63], v7 offset:0
    ds_read_b128 v[64:67], v4 offset:8192
    ds_read_b128 v[68:71], v5 offset:8192
    v_mfma_f32_32x32x16_bf16 v[128:143], v[72:75], v[88:91], v[128:143]
    ds_read_b128 v[72:75], v6 offset:8192
    s_add_u32 m0, s79, 2048
    s_add_u32 s28, s72, 0
    buffer_load_dwordx4 v162, s[56:59], s28 offen lds
    v_mfma_f32_32x32x16_bf16 v[144:159], v[76:79], v[88:91], v[144:159]
    ds_read_b128 v[76:79], v7 offset:8192
    v_mov_b32 v80, v163
    v_mov_b32 v81, v163
    v_mov_b32 v82, v163
    v_mov_b32 v83, v163
    v_mov_b32 v84, v163
    v_mov_b32 v85, v163
    v_mov_b32 v86, v163
    v_mov_b32 v87, v163
    v_mov_b32 v88, v163
    v_mov_b32 v89, v163
    v_mov_b32 v90, v163
    v_mov_b32 v91, v163
    v_mov_b32 v92, v163
    v_mov_b32 v93, v163
    v_mov_b32 v94, v163
    v_mov_b32 v95, v163
    s_setprio 1
    s_waitcnt lgkmcnt(7)
    v_mfma_f32_32x32x16_bf16 v[80:95], v[48:51], v[16:19], v[80:95]
    ds_read_b64_tr_b16 v[48:49], v8 offset:0
    ds_read_b64_tr_b16 v[50:51], v8 offset:2048
    s_waitcnt lgkmcnt(8)
    v_mfma_f32_32x32x16_bf16 v[80:95], v[52:55], v[20:23], v[80:95]
    ds_read_b64_tr_b16 v[52:53], v9 offset:0
    ds_read_b64_tr_b16 v[54:55], v9 offset:2048
    s_add_u32 m0, s79, 36864
    s_add_u32 s28, s72, 73728
    buffer_load_dwordx4 v160, s[56:59], s28 offen lds
    s_waitcnt lgkmcnt(9)
    v_mfma_f32_32x32x16_bf16 v[80:95], v[56:59], v[24:27], v[80:95]
    ds_read_b64_tr_b16 v[56:57], v10 offset:0
    ds_read_b64_tr_b16 v[58:59], v10 offset:2048
    s_waitcnt lgkmcnt(10)
    v_mfma_f32_32x32x16_bf16 v[80:95], v[60:63], v[28:31], v[80:95]
    ds_read_b64_tr_b16 v[60:61], v11 offset:0
    ds_read_b64_tr_b16 v[62:63], v11 offset:2048
    s_waitcnt lgkmcnt(11)
    v_mfma_f32_32x32x16_bf16 v[80:95], v[64:67], v[32:35], v[80:95]
    ds_read_b64_tr_b16 v[64:65], v8 offset:4096
    ds_read_b64_tr_b16 v[66:67], v8 offset:6144
    s_add_u32 m0, s79, 37888
    s_add_u32 s28, s72, 73728
    buffer_load_dwordx4 v161, s[56:59], s28 offen lds
    s_waitcnt lgkmcnt(12)
    v_mfma_f32_32x32x16_bf16 v[80:95], v[68:71], v[36:39], v[80:95]
    ds_read_b64_tr_b16 v[68:69], v9 offset:4096
    ds_read_b64_tr_b16 v[70:71], v9 offset:6144
    s_waitcnt lgkmcnt(13)
    v_mfma_f32_32x32x16_bf16 v[80:95], v[72:75], v[40:43], v[80:95]
    ds_read_b64_tr_b16 v[72:73], v10 offset:4096
    ds_read_b64_tr_b16 v[74:75], v10 offset:6144
    s_waitcnt lgkmcnt(14)
    v_mfma_f32_32x32x16_bf16 v[80:95], v[76:79], v[44:47], v[80:95]
    ds_read_b64_tr_b16 v[76:77], v11 offset:4096
    ds_read_b64_tr_b16 v[78:79], v11 offset:6144
    s_add_u32 m0, s79, 38912
    s_add_u32 s28, s72, 73728
    buffer_load_dwordx4 v162, s[56:59], s28 offen lds
    s_setprio 0
    s_nop 5
    v_exp_f32 v80, v80
    v_exp_f32 v81, v81
    v_exp_f32 v82, v82
    v_exp_f32 v83, v83
    v_exp_f32 v84, v84
    v_exp_f32 v85, v85
    v_exp_f32 v86, v86
    v_exp_f32 v87, v87
    v_add_f32 v12, v12, v80
    v_add_f32 v13, v13, v81
    v_add_f32 v12, v12, v82
    v_add_f32 v13, v13, v83
    v_add_f32 v12, v12, v84
    v_add_f32 v13, v13, v85
    v_add_f32 v12, v12, v86
    v_add_f32 v13, v13, v87
    v_cvt_pk_bf16_f32 v80, v80, v81
    v_cvt_pk_bf16_f32 v81, v82, v83
    v_cvt_pk_bf16_f32 v82, v84, v85
    v_cvt_pk_bf16_f32 v83, v86, v87
    v_exp_f32 v88, v88
    v_exp_f32 v89, v89
    s_waitcnt lgkmcnt(14)
    v_mfma_f32_32x32x16_bf16 v[96:111], v[48:51], v[80:83], v[96:111]
    v_add_f32 v12, v12, v88
    v_add_f32 v13, v13, v89
    v_cvt_pk_bf16_f32 v88, v88, v89
    v_exp_f32 v90, v90
    v_exp_f32 v91, v91
    s_waitcnt lgkmcnt(12)
    v_mfma_f32_32x32x16_bf16 v[112:127], v[52:55], v[80:83], v[112:127]
    v_add_f32 v12, v12, v90
    v_add_f32 v13, v13, v91
    v_cvt_pk_bf16_f32 v89, v90, v91
    v_exp_f32 v92, v92
    v_exp_f32 v93, v93
    s_waitcnt lgkmcnt(10)
    v_mfma_f32_32x32x16_bf16 v[128:143], v[56:59], v[80:83], v[128:143]
    v_add_f32 v12, v12, v92
    v_add_f32 v13, v13, v93
    v_cvt_pk_bf16_f32 v90, v92, v93
    v_exp_f32 v94, v94
    v_exp_f32 v95, v95
    s_waitcnt lgkmcnt(8)
    v_mfma_f32_32x32x16_bf16 v[144:159], v[60:63], v[80:83], v[144:159]
    v_add_f32 v12, v12, v94
    v_add_f32 v13, v13, v95
    v_cvt_pk_bf16_f32 v91, v94, v95
    s_waitcnt lgkmcnt(6)
    s_nop 0
    v_mfma_f32_32x32x16_bf16 v[96:111], v[64:67], v[88:91], v[96:111]
    s_waitcnt lgkmcnt(4)
    v_mfma_f32_32x32x16_bf16 v[112:127], v[68:71], v[88:91], v[112:127]
    s_waitcnt lgkmcnt(2)
    v_mfma_f32_32x32x16_bf16 v[128:143], v[72:75], v[88:91], v[128:143]
    s_waitcnt lgkmcnt(0)
    v_mfma_f32_32x32x16_bf16 v[144:159], v[76:79], v[88:91], v[144:159]
    s_nop 11
    s_branch L_fin
L_slow_n:
    ds_read_b128 v[16:19], v3 offset:0
    ds_read_b128 v[20:23], v3 offset:1024
    ds_read_b128 v[24:27], v3 offset:2048
    ds_read_b128 v[28:31], v3 offset:3072
    ds_read_b128 v[32:35], v3 offset:4096
    ds_read_b128 v[36:39], v3 offset:5120
    ds_read_b128 v[40:43], v3 offset:6144
    ds_read_b128 v[44:47], v3 offset:7168
    v_and_b32 v1, 31, v0
    v_lshlrev_b32 v1, 8, v1
    v_lshrrev_b32 v2, 5, v0
    v_lshl_add_u32 v1, v2, 4, v1
    v_mov_b32 v163, 0xff800000
    s_mov_b32 s28, 0
    s_waitcnt lgkmcnt(0)
L_max_n:
    buffer_load_dwordx4 v[48:51], v1, s[48:51], s28 offen offset:0
    buffer_load_dwordx4 v[52:55], v1, s[48:51], s28 offen offset:32
    buffer_load_dwordx4 v[56:59], v1, s[48:51], s28 offen offset:64
    buffer_load_dwordx4 v[60:63], v1, s[48:51], s28 offen offset:96
    buffer_load_dwordx4 v[64:67], v1, s[48:51], s28 offen offset:128
    buffer_load_dwordx4 v[68:71], v1, s[48:51], s28 offen offset:160
    buffer_load_dwordx4 v[72:75], v1, s[48:51], s28 offen offset:192
    buffer_load_dwordx4 v[76:79], v1, s[48:51], s28 offen offset:224
    s_waitcnt vmcnt(7)
    v_mfma_f32_32x32x16_bf16 v[80:95], v[48:51], v[16:19], 0
    s_waitcnt vmcnt(6)
    v_mfma_f32_32x32x16_bf16 v[80:95], v[52:55], v[20:23], v[80:95]
    s_waitcnt vmcnt(5)
    v_mfma_f32_32x32x16_bf16 v[80:95], v[56:59], v[24:27], v[80:95]
    s_waitcnt vmcnt(4)
    v_mfma_f32_32x32x16_bf16 v[80:95], v[60:63], v[28:31], v[80:95]
    s_waitcnt vmcnt(3)
    v_mfma_f32_32x32x16_bf16 v[80:95], v[64:67], v[32:35], v[80:95]
    s_waitcnt vmcnt(2)
    v_mfma_f32_32x32x16_bf16 v[80:95], v[68:71], v[36:39], v[80:95]
    s_waitcnt vmcnt(1)
    v_mfma_f32_32x32x16_bf16 v[80:95], v[72:75], v[40:43], v[80:95]
    s_waitcnt vmcnt(0)
    v_mfma_f32_32x32x16_bf16 v[80:95], v[76:79], v[44:47], v[80:95]
    s_nop 11
    v_max_f32 v163, v163, v80
    v_max_f32 v163, v163, v81
    v_max_f32 v163, v163, v82
    v_max_f32 v163, v163, v83
    v_max_f32 v163, v163, v84
    v_max_f32 v163, v163, v85
    v_max_f32 v163, v163, v86
    v_max_f32 v163, v163, v87
    v_max_f32 v163, v163, v88
    v_max_f32 v163, v163, v89
    v_max_f32 v163, v163, v90
    v_max_f32 v163, v163, v91
    v_max_f32 v163, v163, v92
    v_max_f32 v163, v163, v93
    v_max_f32 v163, v163, v94
    v_max_f32 v163, v163, v95
    s_add_u32 s28, s28, 8192
    s_cmp_lt_u32 s28, 131072
    s_cbranch_scc1 L_max_n
    v_mov_b32 v1, v163
    s_nop 1
    v_permlane32_swap_b32 v1, v163
    v_max_f32 v163, v163, v1
    v_sub_f32 v163, 0, v163
    ds_read_b128 v[48:51], v4 offset:0
    ds_read_b128 v[52:55], v5 offset:0
    ds_read_b128 v[56:59], v6 offset:0
    ds_read_b128 v[60:63], v7 offset:0
    ds_read_b128 v[64:67], v4 offset:8192
    ds_read_b128 v[68:71], v5 offset:8192
    ds_read_b128 v[72:75], v6 offset:8192
    ds_read_b128 v[76:79], v7 offset:8192
    v_mov_b32 v12, 0
    v_mov_b32 v13, 0
    v_mov_b32 v80, v163
    v_mov_b32 v81, v163
    v_mov_b32 v82, v163
    v_mov_b32 v83, v163
    v_mov_b32 v84, v163
    v_mov_b32 v85, v163
    v_mov_b32 v86, v163
    v_mov_b32 v87, v163
    v_mov_b32 v88, v163
    v_mov_b32 v89, v163
    v_mov_b32 v90, v163
    v_mov_b32 v91, v163
    v_mov_b32 v92, v163
    v_mov_b32 v93, v163
    v_mov_b32 v94, v163
    v_mov_b32 v95, v163
    s_setprio 1
    s_waitcnt lgkmcnt(7)
    v_mfma_f32_32x32x16_bf16 v[80:95], v[48:51], v[16:19], v[80:95]
    ds_read_b64_tr_b16 v[48:49], v8 offset:0
    ds_read_b64_tr_b16 v[50:51], v8 offset:2048
    s_waitcnt lgkmcnt(8)
    v_mfma_f32_32x32x16_bf16 v[80:95], v[52:55], v[20:23], v[80:95]
    ds_read_b64_tr_b16 v[52:53], v9 offset:0
    ds_read_b64_tr_b16 v[54:55], v9 offset:2048
    s_waitcnt lgkmcnt(9)
    v_mfma_f32_32x32x16_bf16 v[80:95], v[56:59], v[24:27], v[80:95]
    ds_read_b64_tr_b16 v[56:57], v10 offset:0
    ds_read_b64_tr_b16 v[58:59], v10 offset:2048
    s_waitcnt lgkmcnt(10)
    v_mfma_f32_32x32x16_bf16 v[80:95], v[60:63], v[28:31], v[80:95]
    ds_read_b64_tr_b16 v[60:61], v11 offset:0
    ds_read_b64_tr_b16 v[62:63], v11 offset:2048
    s_waitcnt lgkmcnt(11)
    v_mfma_f32_32x32x16_bf16 v[80:95], v[64:67], v[32:35], v[80:95]
    ds_read_b64_tr_b16 v[64:65], v8 offset:4096
    ds_read_b64_tr_b16 v[66:67], v8 offset:6144
    s_waitcnt lgkmcnt(12)
    v_mfma_f32_32x32x16_bf16 v[80:95], v[68:71], v[36:39], v[80:95]
    ds_read_b64_tr_b16 v[68:69], v9 offset:4096
    ds_read_b64_tr_b16 v[70:71], v9 offset:6144
    s_waitcnt lgkmcnt(13)
    v_mfma_f32_32x32x16_bf16 v[80:95], v[72:75], v[40:43], v[80:95]
    ds_read_b64_tr_b16 v[72:73], v10 offset:4096
    ds_read_b64_tr_b16 v[74:75], v10 offset:6144
    s_waitcnt lgkmcnt(14)
    v_mfma_f32_32x32x16_bf16 v[80:95], v[76:79], v[44:47], v[80:95]
    ds_read_b64_tr_b16 v[76:77], v11 offset:4096
    ds_read_b64_tr_b16 v[78:79], v11 offset:6144
    s_setprio 0
    s_nop 8
    v_exp_f32 v80, v80
    v_exp_f32 v81, v81
    v_exp_f32 v82, v82
    v_exp_f32 v83, v83
    v_exp_f32 v84, v84
    v_exp_f32 v85, v85
    v_exp_f32 v86, v86
    v_exp_f32 v87, v87
    v_add_f32 v12, v12, v80
    v_add_f32 v13, v13, v81
    v_add_f32 v12, v12, v82
    v_add_f32 v13, v13, v83
    v_add_f32 v12, v12, v84
    v_add_f32 v13, v13, v85
    v_add_f32 v12, v12, v86
    v_add_f32 v13, v13, v87
    v_cvt_pk_bf16_f32 v80, v80, v81
    v_cvt_pk_bf16_f32 v81, v82, v83
    v_cvt_pk_bf16_f32 v82, v84, v85
    v_cvt_pk_bf16_f32 v83, v86, v87
    v_exp_f32 v88, v88
    v_exp_f32 v89, v89
    s_waitcnt lgkmcnt(14)
    v_mfma_f32_32x32x16_bf16 v[96:111], v[48:51], v[80:83], 0
    v_add_f32 v12, v12, v88
    v_add_f32 v13, v13, v89
    v_cvt_pk_bf16_f32 v88, v88, v89
    v_exp_f32 v90, v90
    v_exp_f32 v91, v91
    s_waitcnt lgkmcnt(12)
    v_mfma_f32_32x32x16_bf16 v[112:127], v[52:55], v[80:83], 0
    v_add_f32 v12, v12, v90
    v_add_f32 v13, v13, v91
    v_cvt_pk_bf16_f32 v89, v90, v91
    v_exp_f32 v92, v92
    v_exp_f32 v93, v93
    s_waitcnt lgkmcnt(10)
    v_mfma_f32_32x32x16_bf16 v[128:143], v[56:59], v[80:83], 0
    v_add_f32 v12, v12, v92
    v_add_f32 v13, v13, v93
    v_cvt_pk_bf16_f32 v90, v92, v93
    v_exp_f32 v94, v94
    v_exp_f32 v95, v95
    s_waitcnt lgkmcnt(8)
    v_mfma_f32_32x32x16_bf16 v[144:159], v[60:63], v[80:83], 0
    v_add_f32 v12, v12, v94
    v_add_f32 v13, v13, v95
    v_cvt_pk_bf16_f32 v91, v94, v95
    s_waitcnt lgkmcnt(6)
    s_nop 0
    v_mfma_f32_32x32x16_bf16 v[96:111], v[64:67], v[88:91], v[96:111]
    s_waitcnt lgkmcnt(4)
    v_mfma_f32_32x32x16_bf16 v[112:127], v[68:71], v[88:91], v[112:127]
    s_waitcnt lgkmcnt(0)
    s_barrier
    ds_read_b128 v[48:51], v4 offset:40960
    ds_read_b128 v[52:55], v5 offset:40960
    ds_read_b128 v[56:59], v6 offset:40960
    ds_read_b128 v[60:63], v7 offset:40960
    ds_read_b128 v[64:67], v4 offset:49152
    ds_read_b128 v[68:71], v5 offset:49152
    v_mfma_f32_32x32x16_bf16 v[128:143], v[72:75], v[88:91], v[128:143]
    ds_read_b128 v[72:75], v6 offset:49152
    v_mfma_f32_32x32x16_bf16 v[144:159], v[76:79], v[88:91], v[144:159]
    ds_read_b128 v[76:79], v7 offset:49152
    v_mov_b32 v80, v163
    v_mov_b32 v81, v163
    v_mov_b32 v82, v163
    v_mov_b32 v83, v163
    v_mov_b32 v84, v163
    v_mov_b32 v85, v163
    v_mov_b32 v86, v163
    v_mov_b32 v87, v163
    v_mov_b32 v88, v163
    v_mov_b32 v89, v163
    v_mov_b32 v90, v163
    v_mov_b32 v91, v163
    v_mov_b32 v92, v163
    v_mov_b32 v93, v163
    v_mov_b32 v94, v163
    v_mov_b32 v95, v163
    s_setprio 1
    s_waitcnt lgkmcnt(7)
    v_mfma_f32_32x32x16_bf16 v[80:95], v[48:51], v[16:19], v[80:95]
    ds_read_b64_tr_b16 v[48:49], v8 offset:40960
    ds_read_b64_tr_b16 v[50:51], v8 offset:43008
    s_waitcnt lgkmcnt(8)
    v_mfma_f32_32x32x16_bf16 v[80:95], v[52:55], v[20:23], v[80:95]
    ds_read_b64_tr_b16 v[52:53], v9 offset:40960
    ds_read_b64_tr_b16 v[54:55], v9 offset:43008
    s_waitcnt lgkmcnt(9)
    v_mfma_f32_32x32x16_bf16 v[80:95], v[56:59], v[24:27], v[80:95]
    ds_read_b64_tr_b16 v[56:57], v10 offset:40960
    ds_read_b64_tr_b16 v[58:59], v10 offset:43008
    s_waitcnt lgkmcnt(10)
    v_mfma_f32_32x32x16_bf16 v[80:95], v[60:63], v[28:31], v[80:95]
    ds_read_b64_tr_b16 v[60:61], v11 offset:40960
    ds_read_b64_tr_b16 v[62:63], v11 offset:43008
    s_waitcnt lgkmcnt(11)
    v_mfma_f32_32x32x16_bf16 v[80:95], v[64:67], v[32:35], v[80:95]
    ds_read_b64_tr_b16 v[64:65], v8 offset:45056
    ds_read_b64_tr_b16 v[66:67], v8 offset:47104
    s_waitcnt lgkmcnt(12)
    v_mfma_f32_32x32x16_bf16 v[80:95], v[68:71], v[36:39], v[80:95]
    ds_read_b64_tr_b16 v[68:69], v9 offset:45056
    ds_read_b64_tr_b16 v[70:71], v9 offset:47104
    s_waitcnt lgkmcnt(13)
    v_mfma_f32_32x32x16_bf16 v[80:95], v[72:75], v[40:43], v[80:95]
    ds_read_b64_tr_b16 v[72:73], v10 offset:45056
    ds_read_b64_tr_b16 v[74:75], v10 offset:47104
    s_waitcnt lgkmcnt(14)
    v_mfma_f32_32x32x16_bf16 v[80:95], v[76:79], v[44:47], v[80:95]
    ds_read_b64_tr_b16 v[76:77], v11 offset:45056
    ds_read_b64_tr_b16 v[78:79], v11 offset:47104
    s_setprio 0
    v_add_u32 v4, 73728, v4
    v_add_u32 v5, 73728, v5
    v_add_u32 v6, 73728, v6
    v_add_u32 v7, 73728, v7
    v_add_u32 v8, 73728, v8
    v_add_u32 v9, 73728, v9
    v_add_u32 v10, 73728, v10
    v_add_u32 v11, 73728, v11
    s_nop 0
    v_exp_f32 v80, v80
    v_exp_f32 v81, v81
    v_exp_f32 v82, v82
    v_exp_f32 v83, v83
    v_exp_f32 v84, v84
    v_exp_f32 v85, v85
    v_exp_f32 v86, v86
    v_exp_f32 v87, v87
    v_add_f32 v12, v12, v80
    v_add_f32 v13, v13, v81
    v_add_f32 v12, v12, v82
    v_add_f32 v13, v13, v83
    v_add_f32 v12, v12, v84
    v_add_f32 v13, v13, v85
    v_add_f32 v12, v12, v86
    v_add_f32 v13, v13, v87
    v_cvt_pk_bf16_f32 v80, v80, v81
    v_cvt_pk_bf16_f32 v81, v82, v83
    v_cvt_pk_bf16_f32 v82, v84, v85
    v_cvt_pk_bf16_f32 v83, v86, v87
    v_exp_f32 v88, v88
    v_exp_f32 v89, v89
    s_waitcnt lgkmcnt(14)
    v_mfma_f32_32x32x16_bf16 v[96:111], v[48:51], v[80:83], v[96:111]
    v_add_f32 v12, v12, v88
    v_add_f32 v13, v13, v89
    v_cvt_pk_bf16_f32 v88, v88, v89
    v_exp_f32 v90, v90
    v_exp_f32 v91, v91
    s_waitcnt lgkmcnt(12)
    v_mfma_f32_32x32x16_bf16 v[112:127], v[52:55], v[80:83], v[112:127]
    v_add_f32 v12, v12, v90
    v_add_f32 v13, v13, v91
    v_cvt_pk_bf16_f32 v89, v90, v91
    v_exp_f32 v92, v92
    v_exp_f32 v93, v93
    s_waitcnt lgkmcnt(10)
    v_mfma_f32_32x32x16_bf16 v[128:143], v[56:59], v[80:83], v[128:143]
    v_add_f32 v12, v12, v92
    v_add_f32 v13, v13, v93
    v_cvt_pk_bf16_f32 v90, v92, v93
    v_exp_f32 v94, v94
    v_exp_f32 v95, v95
    s_waitcnt lgkmcnt(8)
    v_mfma_f32_32x32x16_bf16 v[144:159], v[60:63], v[80:83], v[144:159]
    v_add_f32 v12, v12, v94
    v_add_f32 v13, v13, v95
    v_cvt_pk_bf16_f32 v91, v94, v95
    s_waitcnt lgkmcnt(6)
    s_nop 0
    v_mfma_f32_32x32x16_bf16 v[96:111], v[64:67], v[88:91], v[96:111]
    s_waitcnt lgkmcnt(4)
    v_mfma_f32_32x32x16_bf16 v[112:127], v[68:71], v[88:91], v[112:127]
    s_waitcnt lgkmcnt(0)
    s_barrier
    ds_read_b128 v[48:51], v4 offset:40960
    ds_read_b128 v[52:55], v5 offset:40960
    ds_read_b128 v[56:59], v6 offset:40960
    ds_read_b128 v[60:63], v7 offset:40960
    ds_read_b128 v[64:67], v4 offset:49152
    ds_read_b128 v[68:71], v5 offset:49152
    v_mfma_f32_32x32x16_bf16 v[128:143], v[72:75], v[88:91], v[128:143]
    ds_read_b128 v[72:75], v6 offset:49152
    v_mfma_f32_32x32x16_bf16 v[144:159], v[76:79], v[88:91], v[144:159]
    ds_read_b128 v[76:79], v7 offset:49152
    v_mov_b32 v80, v163
    v_mov_b32 v81, v163
    v_mov_b32 v82, v163
    v_mov_b32 v83, v163
    v_mov_b32 v84, v163
    v_mov_b32 v85, v163
    v_mov_b32 v86, v163
    v_mov_b32 v87, v163
    v_mov_b32 v88, v163
    v_mov_b32 v89, v163
    v_mov_b32 v90, v163
    v_mov_b32 v91, v163
    v_mov_b32 v92, v163
    v_mov_b32 v93, v163
    v_mov_b32 v94, v163
    v_mov_b32 v95, v163
    s_setprio 1
    s_waitcnt lgkmcnt(7)
    v_mfma_f32_32x32x16_bf16 v[80:95], v[48:51], v[16:19], v[80:95]
    ds_read_b64_tr_b16 v[48:49], v8 offset:40960
    ds_read_b64_tr_b16 v[50:51], v8 offset:43008
    s_waitcnt lgkmcnt(8)
    v_mfma_f32_32x32x16_bf16 v[80:95], v[52:55], v[20:23], v[80:95]
    ds_read_b64_tr_b16 v[52:53], v9 offset:40960
    ds_read_b64_tr_b16 v[54:55], v9 offset:43008
    s_waitcnt lgkmcnt(9)
    v_mfma_f32_32x32x16_bf16 v[80:95], v[56:59], v[24:27], v[80:95]
    ds_read_b64_tr_b16 v[56:57], v10 offset:40960
    ds_read_b64_tr_b16 v[58:59], v10 offset:43008
    s_waitcnt lgkmcnt(10)
    v_mfma_f32_32x32x16_bf16 v[80:95], v[60:63], v[28:31], v[80:95]
    ds_read_b64_tr_b16 v[60:61], v11 offset:40960
    ds_read_b64_tr_b16 v[62:63], v11 offset:43008
    s_waitcnt lgkmcnt(11)
    v_mfma_f32_32x32x16_bf16 v[80:95], v[64:67], v[32:35], v[80:95]
    ds_read_b64_tr_b16 v[64:65], v8 offset:45056
    ds_read_b64_tr_b16 v[66:67], v8 offset:47104
    s_waitcnt lgkmcnt(12)
    v_mfma_f32_32x32x16_bf16 v[80:95], v[68:71], v[36:39], v[80:95]
    ds_read_b64_tr_b16 v[68:69], v9 offset:45056
    ds_read_b64_tr_b16 v[70:71], v9 offset:47104
    s_waitcnt lgkmcnt(13)
    v_mfma_f32_32x32x16_bf16 v[80:95], v[72:75], v[40:43], v[80:95]
    ds_read_b64_tr_b16 v[72:73], v10 offset:45056
    ds_read_b64_tr_b16 v[74:75], v10 offset:47104
    s_waitcnt lgkmcnt(14)
    v_mfma_f32_32x32x16_bf16 v[80:95], v[76:79], v[44:47], v[80:95]
    ds_read_b64_tr_b16 v[76:77], v11 offset:45056
    ds_read_b64_tr_b16 v[78:79], v11 offset:47104
    s_setprio 0
    s_nop 8
    v_exp_f32 v80, v80
    v_exp_f32 v81, v81
    v_exp_f32 v82, v82
    v_exp_f32 v83, v83
    v_exp_f32 v84, v84
    v_exp_f32 v85, v85
    v_exp_f32 v86, v86
    v_exp_f32 v87, v87
    v_add_f32 v12, v12, v80
    v_add_f32 v13, v13, v81
    v_add_f32 v12, v12, v82
    v_add_f32 v13, v13, v83
    v_add_f32 v12, v12, v84
    v_add_f32 v13, v13, v85
    v_add_f32 v12, v12, v86
    v_add_f32 v13, v13, v87
    v_cvt_pk_bf16_f32 v80, v80, v81
    v_cvt_pk_bf16_f32 v81, v82, v83
    v_cvt_pk_bf16_f32 v82, v84, v85
    v_cvt_pk_bf16_f32 v83, v86, v87
    v_exp_f32 v88, v88
    v_exp_f32 v89, v89
    s_waitcnt lgkmcnt(14)
    v_mfma_f32_32x32x16_bf16 v[96:111], v[48:51], v[80:83], v[96:111]
    v_add_f32 v12, v12, v88
    v_add_f32 v13, v13, v89
    v_cvt_pk_bf16_f32 v88, v88, v89
    v_exp_f32 v90, v90
    v_exp_f32 v91, v91
    s_waitcnt lgkmcnt(12)
    v_mfma_f32_32x32x16_bf16 v[112:127], v[52:55], v[80:83], v[112:127]
    v_add_f32 v12, v12, v90
    v_add_f32 v13, v13, v91
    v_cvt_pk_bf16_f32 v89, v90, v91
    v_exp_f32 v92, v92
    v_exp_f32 v93, v93
    s_waitcnt lgkmcnt(10)
    v_mfma_f32_32x32x16_bf16 v[128:143], v[56:59], v[80:83], v[128:143]
    v_add_f32 v12, v12, v92
    v_add_f32 v13, v13, v93
    v_cvt_pk_bf16_f32 v90, v92, v93
    v_exp_f32 v94, v94
    v_exp_f32 v95, v95
    s_waitcnt lgkmcnt(8)
    v_mfma_f32_32x32x16_bf16 v[144:159], v[60:63], v[80:83], v[144:159]
    v_add_f32 v12, v12, v94
    v_add_f32 v13, v13, v95
    v_cvt_pk_bf16_f32 v91, v94, v95
    s_waitcnt lgkmcnt(6)
    s_nop 0
    v_mfma_f32_32x32x16_bf16 v[96:111], v[64:67], v[88:91], v[96:111]
    s_waitcnt lgkmcnt(4)
    v_mfma_f32_32x32x16_bf16 v[112:127], v[68:71], v[88:91], v[112:127]
    s_waitcnt lgkmcnt(0)
    s_barrier
    ds_read_b128 v[48:51], v4 offset:0
    ds_read_b128 v[52:55], v5 offset:0
    ds_read_b128 v[56:59], v6 offset:0
    ds_read_b128 v[60:63], v7 offset:0
    ds_read_b128 v[64:67], v4 offset:8192
    ds_read_b128 v[68:71], v5 offset:8192
    v_mfma_f32_32x32x16_bf16 v[128:143], v[72:75], v[88:91], v[128:143]
    ds_read_b128 v[72:75], v6 offset:8192
    v_mfma_f32_32x32x16_bf16 v[144:159], v[76:79], v[88:91], v[144:159]
    ds_read_b128 v[76:79], v7 offset:8192
    v_mov_b32 v80, v163
    v_mov_b32 v81, v163
    v_mov_b32 v82, v163
    v_mov_b32 v83, v163
    v_mov_b32 v84, v163
    v_mov_b32 v85, v163
    v_mov_b32 v86, v163
    v_mov_b32 v87, v163
    v_mov_b32 v88, v163
    v_mov_b32 v89, v163
    v_mov_b32 v90, v163
    v_mov_b32 v91, v163
    v_mov_b32 v92, v163
    v_mov_b32 v93, v163
    v_mov_b32 v94, v163
    v_mov_b32 v95, v163
    s_setprio 1
    s_waitcnt lgkmcnt(7)
    v_mfma_f32_32x32x16_bf16 v[80:95], v[48:51], v[16:19], v[80:95]
    ds_read_b64_tr_b16 v[48:49], v8 offset:0
    ds_read_b64_tr_b16 v[50:51], v8 offset:2048
    s_waitcnt lgkmcnt(8)
    v_mfma_f32_32x32x16_bf16 v[80:95], v[52:55], v[20:23], v[80:95]
    ds_read_b64_tr_b16 v[52:53], v9 offset:0
    ds_read_b64_tr_b16 v[54:55], v9 offset:2048
    s_waitcnt lgkmcnt(9)
    v_mfma_f32_32x32x16_bf16 v[80:95], v[56:59], v[24:27], v[80:95]
    ds_read_b64_tr_b16 v[56:57], v10 offset:0
    ds_read_b64_tr_b16 v[58:59], v10 offset:2048
    s_waitcnt lgkmcnt(10)
    v_mfma_f32_32x32x16_bf16 v[80:95], v[60:63], v[28:31], v[80:95]
    ds_read_b64_tr_b16 v[60:61], v11 offset:0
    ds_read_b64_tr_b16 v[62:63], v11 offset:2048
    s_waitcnt lgkmcnt(11)
    v_mfma_f32_32x32x16_bf16 v[80:95], v[64:67], v[32:35], v[80:95]
    ds_read_b64_tr_b16 v[64:65], v8 offset:4096
    ds_read_b64_tr_b16 v[66:67], v8 offset:6144
    s_waitcnt lgkmcnt(12)
    v_mfma_f32_32x32x16_bf16 v[80:95], v[68:71], v[36:39], v[80:95]
    ds_read_b64_tr_b16 v[68:69], v9 offset:4096
    ds_read_b64_tr_b16 v[70:71], v9 offset:6144
    s_waitcnt lgkmcnt(13)
    v_mfma_f32_32x32x16_bf16 v[80:95], v[72:75], v[40:43], v[80:95]
    ds_read_b64_tr_b16 v[72:73], v10 offset:4096
    ds_read_b64_tr_b16 v[74:75], v10 offset:6144
    s_waitcnt lgkmcnt(14)
    v_mfma_f32_32x32x16_bf16 v[80:95], v[76:79], v[44:47], v[80:95]
    ds_read_b64_tr_b16 v[76:77], v11 offset:4096
    ds_read_b64_tr_b16 v[78:79], v11 offset:6144
    s_setprio 0
    v_subrev_u32 v4, 73728, v4
    v_subrev_u32 v5, 73728, v5
    v_subrev_u32 v6, 73728, v6
    v_subrev_u32 v7, 73728, v7
    v_subrev_u32 v8, 73728, v8
    v_subrev_u32 v9, 73728, v9
    v_subrev_u32 v10, 73728, v10
    v_subrev_u32 v11, 73728, v11
    s_nop 0
    v_exp_f32 v80, v80
    v_exp_f32 v81, v81
    v_exp_f32 v82, v82
    v_exp_f32 v83, v83
    v_exp_f32 v84, v84
    v_exp_f32 v85, v85
    v_exp_f32 v86, v86
    v_exp_f32 v87, v87
    v_add_f32 v12, v12, v80
    v_add_f32 v13, v13, v81
    v_add_f32 v12, v12, v82
    v_add_f32 v13, v13, v83
    v_add_f32 v12, v12, v84
    v_add_f32 v13, v13, v85
    v_add_f32 v12, v12, v86
    v_add_f32 v13, v13, v87
    v_cvt_pk_bf16_f32 v80, v80, v81
    v_cvt_pk_bf16_f32 v81, v82, v83
    v_cvt_pk_bf16_f32 v82, v84, v85
    v_cvt_pk_bf16_f32 v83, v86, v87
    v_exp_f32 v88, v88
    v_exp_f32 v89, v89
    s_waitcnt lgkmcnt(14)
    v_mfma_f32_32x32x16_bf16 v[96:111], v[48:51], v[80:83], v[96:111]
    v_add_f32 v12, v12, v88
    v_add_f32 v13, v13, v89
    v_cvt_pk_bf16_f32 v88, v88, v89
    v_exp_f32 v90, v90
    v_exp_f32 v91, v91
    s_waitcnt lgkmcnt(12)
    v_mfma_f32_32x32x16_bf16 v[112:127], v[52:55], v[80:83], v[112:127]
    v_add_f32 v12, v12, v90
    v_add_f32 v13, v13, v91
    v_cvt_pk_bf16_f32 v89, v90, v91
    v_exp_f32 v92, v92
    v_exp_f32 v93, v93
    s_waitcnt lgkmcnt(10)
    v_mfma_f32_32x32x16_bf16 v[128:143], v[56:59], v[80:83], v[128:143]
    v_add_f32 v12, v12, v92
    v_add_f32 v13, v13, v93
    v_cvt_pk_bf16_f32 v90, v92, v93
    v_exp_f32 v94, v94
    v_exp_f32 v95, v95
    s_waitcnt lgkmcnt(8)
    v_mfma_f32_32x32x16_bf16 v[144:159], v[60:63], v[80:83], v[144:159]
    v_add_f32 v12, v12, v94
    v_add_f32 v13, v13, v95
    v_cvt_pk_bf16_f32 v91, v94, v95
    s_waitcnt lgkmcnt(6)
    s_nop 0
    v_mfma_f32_32x32x16_bf16 v[96:111], v[64:67], v[88:91], v[96:111]
    s_waitcnt lgkmcnt(4)
    v_mfma_f32_32x32x16_bf16 v[112:127], v[68:71], v[88:91], v[112:127]
    s_waitcnt lgkmcnt(0)
    s_barrier
    ds_read_b128 v[48:51], v4 offset:0
    ds_read_b128 v[52:55], v5 offset:0
    ds_read_b128 v[56:59], v6 offset:0
    ds_read_b128 v[60:63], v7 offset:0
    ds_read_b128 v[64:67], v4 offset:8192
    ds_read_b128 v[68:71], v5 offset:8192
    v_mfma_f32_32x32x16_bf16 v[128:143], v[72:75], v[88:91], v[128:143]
    ds_read_b128 v[72:75], v6 offset:8192
    v_mfma_f32_32x32x16_bf16 v[144:159], v[76:79], v[88:91], v[144:159]
    ds_read_b128 v[76:79], v7 offset:8192
    v_mov_b32 v80, v163
    v_mov_b32 v81, v163
    v_mov_b32 v82, v163
    v_mov_b32 v83, v163
    v_mov_b32 v84, v163
    v_mov_b32 v85, v163
    v_mov_b32 v86, v163
    v_mov_b32 v87, v163
    v_mov_b32 v88, v163
    v_mov_b32 v89, v163
    v_mov_b32 v90, v163
    v_mov_b32 v91, v163
    v_mov_b32 v92, v163
    v_mov_b32 v93, v163
    v_mov_b32 v94, v163
    v_mov_b32 v95, v163
    s_setprio 1
    s_waitcnt lgkmcnt(7)
    v_mfma_f32_32x32x16_bf16 v[80:95], v[48:51], v[16:19], v[80:95]
    ds_read_b64_tr_b16 v[48:49], v8 offset:0
    ds_read_b64_tr_b16 v[50:51], v8 offset:2048
    s_waitcnt lgkmcnt(8)
    v_mfma_f32_32x32x16_bf16 v[80:95], v[52:55], v[20:23], v[80:95]
    ds_read_b64_tr_b16 v[52:53], v9 offset:0
    ds_read_b64_tr_b16 v[54:55], v9 offset:2048
    s_waitcnt lgkmcnt(9)
    v_mfma_f32_32x32x16_bf16 v[80:95], v[56:59], v[24:27], v[80:95]
    ds_read_b64_tr_b16 v[56:57], v10 offset:0
    ds_read_b64_tr_b16 v[58:59], v10 offset:2048
    s_waitcnt lgkmcnt(10)
    v_mfma_f32_32x32x16_bf16 v[80:95], v[60:63], v[28:31], v[80:95]
    ds_read_b64_tr_b16 v[60:61], v11 offset:0
    ds_read_b64_tr_b16 v[62:63], v11 offset:2048
    s_waitcnt lgkmcnt(11)
    v_mfma_f32_32x32x16_bf16 v[80:95], v[64:67], v[32:35], v[80:95]
    ds_read_b64_tr_b16 v[64:65], v8 offset:4096
    ds_read_b64_tr_b16 v[66:67], v8 offset:6144
    s_waitcnt lgkmcnt(12)
    v_mfma_f32_32x32x16_bf16 v[80:95], v[68:71], v[36:39], v[80:95]
    ds_read_b64_tr_b16 v[68:69], v9 offset:4096
    ds_read_b64_tr_b16 v[70:71], v9 offset:6144
    s_waitcnt lgkmcnt(13)
    v_mfma_f32_32x32x16_bf16 v[80:95], v[72:75], v[40:43], v[80:95]
    ds_read_b64_tr_b16 v[72:73], v10 offset:4096
    ds_read_b64_tr_b16 v[74:75], v10 offset:6144
    s_waitcnt lgkmcnt(14)
    v_mfma_f32_32x32x16_bf16 v[80:95], v[76:79], v[44:47], v[80:95]
    ds_read_b64_tr_b16 v[76:77], v11 offset:4096
    ds_read_b64_tr_b16 v[78:79], v11 offset:6144
    s_setprio 0
    s_nop 8
    v_exp_f32 v80, v80
    v_exp_f32 v81, v81
    v_exp_f32 v82, v82
    v_exp_f32 v83, v83
    v_exp_f32 v84, v84
    v_exp_f32 v85, v85
    v_exp_f32 v86, v86
    v_exp_f32 v87, v87
    v_add_f32 v12, v12, v80
    v_add_f32 v13, v13, v81
    v_add_f32 v12, v12, v82
    v_add_f32 v13, v13, v83
    v_add_f32 v12, v12, v84
    v_add_f32 v13, v13, v85
    v_add_f32 v12, v12, v86
    v_add_f32 v13, v13, v87
    v_cvt_pk_bf16_f32 v80, v80, v81
    v_cvt_pk_bf16_f32 v81, v82, v83
    v_cvt_pk_bf16_f32 v82, v84, v85
    v_cvt_pk_bf16_f32 v83, v86, v87
    v_exp_f32 v88, v88
    v_exp_f32 v89, v89
    s_waitcnt lgkmcnt(14)
    v_mfma_f32_32x32x16_bf16 v[96:111], v[48:51], v[80:83], v[96:111]
    v_add_f32 v12, v12, v88
    v_add_f32 v13, v13, v89
    v_cvt_pk_bf16_f32 v88, v88, v89
    v_exp_f32 v90, v90
    v_exp_f32 v91, v91
    s_waitcnt lgkmcnt(12)
    v_mfma_f32_32x32x16_bf16 v[112:127], v[52:55], v[80:83], v[112:127]
    v_add_f32 v12, v12, v90
    v_add_f32 v13, v13, v91
    v_cvt_pk_bf16_f32 v89, v90, v91
    v_exp_f32 v92, v92
    v_exp_f32 v93, v93
    s_waitcnt lgkmcnt(10)
    v_mfma_f32_32x32x16_bf16 v[128:143], v[56:59], v[80:83], v[128:143]
    v_add_f32 v12, v12, v92
    v_add_f32 v13, v13, v93
    v_cvt_pk_bf16_f32 v90, v92, v93
    v_exp_f32 v94, v94
    v_exp_f32 v95, v95
    s_waitcnt lgkmcnt(8)
    v_mfma_f32_32x32x16_bf16 v[144:159], v[60:63], v[80:83], v[144:159]
    v_add_f32 v12, v12, v94
    v_add_f32 v13, v13, v95
    v_cvt_pk_bf16_f32 v91, v94, v95
    s_waitcnt lgkmcnt(6)
    s_nop 0
    v_mfma_f32_32x32x16_bf16 v[96:111], v[64:67], v[88:91], v[96:111]
    s_waitcnt lgkmcnt(4)
    v_mfma_f32_32x32x16_bf16 v[112:127], v[68:71], v[88:91], v[112:127]
    s_waitcnt lgkmcnt(0)
    s_barrier
    ds_read_b128 v[48:51], v4 offset:40960
    ds_read_b128 v[52:55], v5 offset:40960
    ds_read_b128 v[56:59], v6 offset:40960
    ds_read_b128 v[60:63], v7 offset:40960
    ds_read_b128 v[64:67], v4 offset:49152
    ds_read_b128 v[68:71], v5 offset:49152
    v_mfma_f32_32x32x16_bf16 v[128:143], v[72:75], v[88:91], v[128:143]
    ds_read_b128 v[72:75], v6 offset:49152
    v_mfma_f32_32x32x16_bf16 v[144:159], v[76:79], v[88:91], v[144:159]
    ds_read_b128 v[76:79], v7 offset:49152
    v_mov_b32 v80, v163
    v_mov_b32 v81, v163
    v_mov_b32 v82, v163
    v_mov_b32 v83, v163
    v_mov_b32 v84, v163
    v_mov_b32 v85, v163
    v_mov_b32 v86, v163
    v_mov_b32 v87, v163
    v_mov_b32 v88, v163
    v_mov_b32 v89, v163
    v_mov_b32 v90, v163
    v_mov_b32 v91, v163
    v_mov_b32 v92, v163
    v_mov_b32 v93, v163
    v_mov_b32 v94, v163
    v_mov_b32 v95, v163
    s_setprio 1
    s_waitcnt lgkmcnt(7)
    v_mfma_f32_32x32x16_bf16 v[80:95], v[48:51], v[16:19], v[80:95]
    ds_read_b64_tr_b16 v[48:49], v8 offset:40960
    ds_read_b64_tr_b16 v[50:51], v8 offset:43008
    s_waitcnt lgkmcnt(8)
    v_mfma_f32_32x32x16_bf16 v[80:95], v[52:55], v[20:23], v[80:95]
    ds_read_b64_tr_b16 v[52:53], v9 offset:40960
    ds_read_b64_tr_b16 v[54:55], v9 offset:43008
    s_waitcnt lgkmcnt(9)
    v_mfma_f32_32x32x16_bf16 v[80:95], v[56:59], v[24:27], v[80:95]
    ds_read_b64_tr_b16 v[56:57], v10 offset:40960
    ds_read_b64_tr_b16 v[58:59], v10 offset:43008
    s_waitcnt lgkmcnt(10)
    v_mfma_f32_32x32x16_bf16 v[80:95], v[60:63], v[28:31], v[80:95]
    ds_read_b64_tr_b16 v[60:61], v11 offset:40960
    ds_read_b64_tr_b16 v[62:63], v11 offset:43008
    s_waitcnt lgkmcnt(11)
    v_mfma_f32_32x32x16_bf16 v[80:95], v[64:67], v[32:35], v[80:95]
    ds_read_b64_tr_b16 v[64:65], v8 offset:45056
    ds_read_b64_tr_b16 v[66:67], v8 offset:47104
    s_waitcnt lgkmcnt(12)
    v_mfma_f32_32x32x16_bf16 v[80:95], v[68:71], v[36:39], v[80:95]
    ds_read_b64_tr_b16 v[68:69], v9 offset:45056
    ds_read_b64_tr_b16 v[70:71], v9 offset:47104
    s_waitcnt lgkmcnt(13)
    v_mfma_f32_32x32x16_bf16 v[80:95], v[72:75], v[40:43], v[80:95]
    ds_read_b64_tr_b16 v[72:73], v10 offset:45056
    ds_read_b64_tr_b16 v[74:75], v10 offset:47104
    s_waitcnt lgkmcnt(14)
    v_mfma_f32_32x32x16_bf16 v[80:95], v[76:79], v[44:47], v[80:95]
    ds_read_b64_tr_b16 v[76:77], v11 offset:45056
    ds_read_b64_tr_b16 v[78:79], v11 offset:47104
    s_setprio 0
    v_add_u32 v4, 73728, v4
    v_add_u32 v5, 73728, v5
    v_add_u32 v6, 73728, v6
    v_add_u32 v7, 73728, v7
    v_add_u32 v8, 73728, v8
    v_add_u32 v9, 73728, v9
    v_add_u32 v10, 73728, v10
    v_add_u32 v11, 73728, v11
    s_nop 0
    v_exp_f32 v80, v80
    v_exp_f32 v81, v81
    v_exp_f32 v82, v82
    v_exp_f32 v83, v83
    v_exp_f32 v84, v84
    v_exp_f32 v85, v85
    v_exp_f32 v86, v86
    v_exp_f32 v87, v87
    v_add_f32 v12, v12, v80
    v_add_f32 v13, v13, v81
    v_add_f32 v12, v12, v82
    v_add_f32 v13, v13, v83
    v_add_f32 v12, v12, v84
    v_add_f32 v13, v13, v85
    v_add_f32 v12, v12, v86
    v_add_f32 v13, v13, v87
    v_cvt_pk_bf16_f32 v80, v80, v81
    v_cvt_pk_bf16_f32 v81, v82, v83
    v_cvt_pk_bf16_f32 v82, v84, v85
    v_cvt_pk_bf16_f32 v83, v86, v87
    v_exp_f32 v88, v88
    v_exp_f32 v89, v89
    s_waitcnt lgkmcnt(14)
    v_mfma_f32_32x32x16_bf16 v[96:111], v[48:51], v[80:83], v[96:111]
    v_add_f32 v12, v12, v88
    v_add_f32 v13, v13, v89
    v_cvt_pk_bf16_f32 v88, v88, v89
    v_exp_f32 v90, v90
    v_exp_f32 v91, v91
    s_waitcnt lgkmcnt(12)
    v_mfma_f32_32x32x16_bf16 v[112:127], v[52:55], v[80:83], v[112:127]
    v_add_f32 v12, v12, v90
    v_add_f32 v13, v13, v91
    v_cvt_pk_bf16_f32 v89, v90, v91
    v_exp_f32 v92, v92
    v_exp_f32 v93, v93
    s_waitcnt lgkmcnt(10)
    v_mfma_f32_32x32x16_bf16 v[128:143], v[56:59], v[80:83], v[128:143]
    v_add_f32 v12, v12, v92
    v_add_f32 v13, v13, v93
    v_cvt_pk_bf16_f32 v90, v92, v93
    v_exp_f32 v94, v94
    v_exp_f32 v95, v95
    s_waitcnt lgkmcnt(8)
    v_mfma_f32_32x32x16_bf16 v[144:159], v[60:63], v[80:83], v[144:159]
    v_add_f32 v12, v12, v94
    v_add_f32 v13, v13, v95
    v_cvt_pk_bf16_f32 v91, v94, v95
    s_waitcnt lgkmcnt(6)
    s_nop 0
    v_mfma_f32_32x32x16_bf16 v[96:111], v[64:67], v[88:91], v[96:111]
    s_waitcnt lgkmcnt(4)
    v_mfma_f32_32x32x16_bf16 v[112:127], v[68:71], v[88:91], v[112:127]
    s_waitcnt lgkmcnt(0)
    s_barrier
    ds_read_b128 v[48:51], v4 offset:40960
    ds_read_b128 v[52:55], v5 offset:40960
    ds_read_b128 v[56:59], v6 offset:40960
    ds_read_b128 v[60:63], v7 offset:40960
    ds_read_b128 v[64:67], v4 offset:49152
    ds_read_b128 v[68:71], v5 offset:49152
    v_mfma_f32_32x32x16_bf16 v[128:143], v[72:75], v[88:91], v[128:143]
    ds_read_b128 v[72:75], v6 offset:49152
    v_mfma_f32_32x32x16_bf16 v[144:159], v[76:79], v[88:91], v[144:159]
    ds_read_b128 v[76:79], v7 offset:49152
    v_mov_b32 v80, v163
    v_mov_b32 v81, v163
    v_mov_b32 v82, v163
    v_mov_b32 v83, v163
    v_mov_b32 v84, v163
    v_mov_b32 v85, v163
    v_mov_b32 v86, v163
    v_mov_b32 v87, v163
    v_mov_b32 v88, v163
    v_mov_b32 v89, v163
    v_mov_b32 v90, v163
    v_mov_b32 v91, v163
    v_mov_b32 v92, v163
    v_mov_b32 v93, v163
    v_mov_b32 v94, v163
    v_mov_b32 v95, v163
    s_setprio 1
    s_waitcnt lgkmcnt(7)
    v_mfma_f32_32x32x16_bf16 v[80:95], v[48:51], v[16:19], v[80:95]
    ds_read_b64_tr_b16 v[48:49], v8 offset:40960
    ds_read_b64_tr_b16 v[50:51], v8 offset:43008
    s_waitcnt lgkmcnt(8)
    v_mfma_f32_32x32x16_bf16 v[80:95], v[52:55], v[20:23], v[80:95]
    ds_read_b64_tr_b16 v[52:53], v9 offset:40960
    ds_read_b64_tr_b16 v[54:55], v9 offset:43008
    s_add_u32 m0, s79, 0
    s_add_u32 s28, s72, 0
    buffer_load_dwordx4 v160, s[56:59], s28 offen lds
    s_waitcnt lgkmcnt(9)
    v_mfma_f32_32x32x16_bf16 v[80:95], v[56:59], v[24:27], v[80:95]
    ds_read_b64_tr_b16 v[56:57], v10 offset:40960
    ds_read_b64_tr_b16 v[58:59], v10 offset:43008
    s_waitcnt lgkmcnt(10)
    v_mfma_f32_32x32x16_bf16 v[80:95], v[60:63], v[28:31], v[80:95]
    ds_read_b64_tr_b16 v[60:61], v11 offset:40960
    ds_read_b64_tr_b16 v[62:63], v11 offset:43008
    s_waitcnt lgkmcnt(11)
    v_mfma_f32_32x32x16_bf16 v[80:95], v[64:67], v[32:35], v[80:95]
    ds_read_b64_tr_b16 v[64:65], v8 offset:45056
    ds_read_b64_tr_b16 v[66:67], v8 offset:47104
    s_waitcnt lgkmcnt(12)
    v_mfma_f32_32x32x16_bf16 v[80:95], v[68:71], v[36:39], v[80:95]
    ds_read_b64_tr_b16 v[68:69], v9 offset:45056
    ds_read_b64_tr_b16 v[70:71], v9 offset:47104
    s_waitcnt lgkmcnt(13)
    v_mfma_f32_32x32x16_bf16 v[80:95], v[72:75], v[40:43], v[80:95]
    ds_read_b64_tr_b16 v[72:73], v10 offset:45056
    ds_read_b64_tr_b16 v[74:75], v10 offset:47104
    s_add_u32 m0, s79, 1024
    s_add_u32 s28, s72, 0
    buffer_load_dwordx4 v161, s[56:59], s28 offen lds
    s_waitcnt lgkmcnt(14)
    v_mfma_f32_32x32x16_bf16 v[80:95], v[76:79], v[44:47], v[80:95]
    ds_read_b64_tr_b16 v[76:77], v11 offset:45056
    ds_read_b64_tr_b16 v[78:79], v11 offset:47104
    s_setprio 0
    s_nop 8
    v_exp_f32 v80, v80
    v_exp_f32 v81, v81
    v_exp_f32 v82, v82
    v_exp_f32 v83, v83
    v_exp_f32 v84, v84
    v_exp_f32 v85, v85
    v_exp_f32 v86, v86
    v_exp_f32 v87, v87
    v_add_f32 v12, v12, v80
    v_add_f32 v13, v13, v81
    v_add_f32 v12, v12, v82
    v_add_f32 v13, v13, v83
    v_add_f32 v12, v12, v84
    v_add_f32 v13, v13, v85
    v_add_f32 v12, v12, v86
    v_add_f32 v13, v13, v87
    v_cvt_pk_bf16_f32 v80, v80, v81
    v_cvt_pk_bf16_f32 v81, v82, v83
    v_cvt_pk_bf16_f32 v82, v84, v85
    v_cvt_pk_bf16_f32 v83, v86, v87
    v_exp_f32 v88, v88
    v_exp_f32 v89, v89
    s_waitcnt lgkmcnt(14)
    v_mfma_f32_32x32x16_bf16 v[96:111], v[48:51], v[80:83], v[96:111]
    v_add_f32 v12, v12, v88
    v_add_f32 v13, v13, v89
    v_cvt_pk_bf16_f32 v88, v88, v89
    v_exp_f32 v90, v90
    v_exp_f32 v91, v91
    s_waitcnt lgkmcnt(12)
    v_mfma_f32_32x32x16_bf16 v[112:127], v[52:55], v[80:83], v[112:127]
    v_add_f32 v12, v12, v90
    v_add_f32 v13, v13, v91
    v_cvt_pk_bf16_f32 v89, v90, v91
    v_exp_f32 v92, v92
    v_exp_f32 v93, v93
    s_waitcnt lgkmcnt(10)
    v_mfma_f32_32x32x16_bf16 v[128:143], v[56:59], v[80:83], v[128:143]
    v_add_f32 v12, v12, v92
    v_add_f32 v13, v13, v93
    v_cvt_pk_bf16_f32 v90, v92, v93
    v_exp_f32 v94, v94
    v_exp_f32 v95, v95
    s_waitcnt lgkmcnt(8)
    v_mfma_f32_32x32x16_bf16 v[144:159], v[60:63], v[80:83], v[144:159]
    v_add_f32 v12, v12, v94
    v_add_f32 v13, v13, v95
    v_cvt_pk_bf16_f32 v91, v94, v95
    s_waitcnt lgkmcnt(6)
    s_nop 0
    v_mfma_f32_32x32x16_bf16 v[96:111], v[64:67], v[88:91], v[96:111]
    s_waitcnt lgkmcnt(4)
    v_mfma_f32_32x32x16_bf16 v[112:127], v[68:71], v[88:91], v[112:127]
    s_waitcnt lgkmcnt(0)
    s_barrier
    ds_read_b128 v[48:51], v4 offset:0
    ds_read_b128 v[52:55], v5 offset:0
    ds_read_b128 v[56:59], v6 offset:0
    ds_read_b128 v[60:63], v7 offset:0
    ds_read_b128 v[64:67], v4 offset:8192
    ds_read_b128 v[68:71], v5 offset:8192
    v_mfma_f32_32x32x16_bf16 v[128:143], v[72:75], v[88:91], v[128:143]
    ds_read_b128 v[72:75], v6 offset:8192
    s_add_u32 m0, s79, 2048
    s_add_u32 s28, s72, 0
    buffer_load_dwordx4 v162, s[56:59], s28 offen lds
    v_mfma_f32_32x32x16_bf16 v[144:159], v[76:79], v[88:91], v[144:159]
    ds_read_b128 v[76:79], v7 offset:8192
    v_mov_b32 v80, v163
    v_mov_b32 v81, v163
    v_mov_b32 v82, v163
    v_mov_b32 v83, v163
    v_mov_b32 v84, v163
    v_mov_b32 v85, v163
    v_mov_b32 v86, v163
    v_mov_b32 v87, v163
    v_mov_b32 v88, v163
    v_mov_b32 v89, v163
    v_mov_b32 v90, v163
    v_mov_b32 v91, v163
    v_mov_b32 v92, v163
    v_mov_b32 v93, v163
    v_mov_b32 v94, v163
    v_mov_b32 v95, v163
    s_setprio 1
    s_waitcnt lgkmcnt(7)
    v_mfma_f32_32x32x16_bf16 v[80:95], v[48:51], v[16:19], v[80:95]
    ds_read_b64_tr_b16 v[48:49], v8 offset:0
    ds_read_b64_tr_b16 v[50:51], v8 offset:2048
    s_waitcnt lgkmcnt(8)
    v_mfma_f32_32x32x16_bf16 v[80:95], v[52:55], v[20:23], v[80:95]
    ds_read_b64_tr_b16 v[52:53], v9 offset:0
    ds_read_b64_tr_b16 v[54:55], v9 offset:2048
    s_add_u32 m0, s79, 36864
    s_add_u32 s28, s72, 73728
    buffer_load_dwordx4 v160, s[56:59], s28 offen lds
    s_waitcnt lgkmcnt(9)
    v_mfma_f32_32x32x16_bf16 v[80:95], v[56:59], v[24:27], v[80:95]
    ds_read_b64_tr_b16 v[56:57], v10 offset:0
    ds_read_b64_tr_b16 v[58:59], v10 offset:2048
    s_waitcnt lgkmcnt(10)
    v_mfma_f32_32x32x16_bf16 v[80:95], v[60:63], v[28:31], v[80:95]
    ds_read_b64_tr_b16 v[60:61], v11 offset:0
    ds_read_b64_tr_b16 v[62:63], v11 offset:2048
    s_waitcnt lgkmcnt(11)
    v_mfma_f32_32x32x16_bf16 v[80:95], v[64:67], v[32:35], v[80:95]
    ds_read_b64_tr_b16 v[64:65], v8 offset:4096
    ds_read_b64_tr_b16 v[66:67], v8 offset:6144
    s_add_u32 m0, s79, 37888
    s_add_u32 s28, s72, 73728
    buffer_load_dwordx4 v161, s[56:59], s28 offen lds
    s_waitcnt lgkmcnt(12)
    v_mfma_f32_32x32x16_bf16 v[80:95], v[68:71], v[36:39], v[80:95]
    ds_read_b64_tr_b16 v[68:69], v9 offset:4096
    ds_read_b64_tr_b16 v[70:71], v9 offset:6144
    s_waitcnt lgkmcnt(13)
    v_mfma_f32_32x32x16_bf16 v[80:95], v[72:75], v[40:43], v[80:95]
    ds_read_b64_tr_b16 v[72:73], v10 offset:4096
    ds_read_b64_tr_b16 v[74:75], v10 offset:6144
    s_waitcnt lgkmcnt(14)
    v_mfma_f32_32x32x16_bf16 v[80:95], v[76:79], v[44:47], v[80:95]
    ds_read_b64_tr_b16 v[76:77], v11 offset:4096
    ds_read_b64_tr_b16 v[78:79], v11 offset:6144
    s_add_u32 m0, s79, 38912
    s_add_u32 s28, s72, 73728
    buffer_load_dwordx4 v162, s[56:59], s28 offen lds
    s_setprio 0
    s_nop 5
    v_exp_f32 v80, v80
    v_exp_f32 v81, v81
    v_exp_f32 v82, v82
    v_exp_f32 v83, v83
    v_exp_f32 v84, v84
    v_exp_f32 v85, v85
    v_exp_f32 v86, v86
    v_exp_f32 v87, v87
    v_add_f32 v12, v12, v80
    v_add_f32 v13, v13, v81
    v_add_f32 v12, v12, v82
    v_add_f32 v13, v13, v83
    v_add_f32 v12, v12, v84
    v_add_f32 v13, v13, v85
    v_add_f32 v12, v12, v86
    v_add_f32 v13, v13, v87
    v_cvt_pk_bf16_f32 v80, v80, v81
    v_cvt_pk_bf16_f32 v81, v82, v83
    v_cvt_pk_bf16_f32 v82, v84, v85
    v_cvt_pk_bf16_f32 v83, v86, v87
    v_exp_f32 v88, v88
    v_exp_f32 v89, v89
    s_waitcnt lgkmcnt(14)
    v_mfma_f32_32x32x16_bf16 v[96:111], v[48:51], v[80:83], v[96:111]
    v_add_f32 v12, v12, v88
    v_add_f32 v13, v13, v89
    v_cvt_pk_bf16_f32 v88, v88, v89
    v_exp_f32 v90, v90
    v_exp_f32 v91, v91
    s_waitcnt lgkmcnt(12)
    v_mfma_f32_32x32x16_bf16 v[112:127], v[52:55], v[80:83], v[112:127]
    v_add_f32 v12, v12, v90
    v_add_f32 v13, v13, v91
    v_cvt_pk_bf16_f32 v89, v90, v91
    v_exp_f32 v92, v92
    v_exp_f32 v93, v93
    s_waitcnt lgkmcnt(10)
    v_mfma_f32_32x32x16_bf16 v[128:143], v[56:59], v[80:83], v[128:143]
    v_add_f32 v12, v12, v92
    v_add_f32 v13, v13, v93
    v_cvt_pk_bf16_f32 v90, v92, v93
    v_exp_f32 v94, v94
    v_exp_f32 v95, v95
    s_waitcnt lgkmcnt(8)
    v_mfma_f32_32x32x16_bf16 v[144:159], v[60:63], v[80:83], v[144:159]
    v_add_f32 v12, v12, v94
    v_add_f32 v13, v13, v95
    v_cvt_pk_bf16_f32 v91, v94, v95
    s_waitcnt lgkmcnt(6)
    s_nop 0
    v_mfma_f32_32x32x16_bf16 v[96:111], v[64:67], v[88:91], v[96:111]
    s_waitcnt lgkmcnt(4)
    v_mfma_f32_32x32x16_bf16 v[112:127], v[68:71], v[88:91], v[112:127]
    s_waitcnt lgkmcnt(2)
    v_mfma_f32_32x32x16_bf16 v[128:143], v[72:75], v[88:91], v[128:143]
    s_waitcnt lgkmcnt(0)
    v_mfma_f32_32x32x16_bf16 v[144:159], v[76:79], v[88:91], v[144:159]
    s_nop 11
    s_branch L_fin
.section .rodata,"a"
.p2align 6
.amdhsa_kernel standalone__mha_block_cached__near_ridge_kernel
  .amdhsa_next_free_vgpr 168
  .amdhsa_next_free_sgpr 102
  .amdhsa_accum_offset 168
  .amdhsa_group_segment_fixed_size 0
  .amdhsa_kernarg_size 64
  .amdhsa_user_sgpr_count 2
  .amdhsa_user_sgpr_kernarg_segment_ptr 1
  .amdhsa_system_sgpr_workgroup_id_x 1
.end_amdhsa_kernel
```
